```python
import torch

def _softmax(x, axis=-1):
    return torch.softmax(x, dim=axis)
def _gelu(x):
    return torch.nn.functional.gelu(x, approximate="tanh")
def _silu(x):
    return torch.nn.functional.silu(x)
def _sigmoid(x):
    return torch.sigmoid(x)
def _layernorm(x, axis=-1, eps=1e-5):
    m = x.mean(dim=axis, keepdim=True)
    v = x.var(dim=axis, keepdim=True, unbiased=False)
    return (x - m) / torch.sqrt(v + eps)
def _scatter_add(tgt, idx, src, axis=0):
    return tgt.clone().index_add_(axis, idx, src)
def _segment_sum(src, seg, n):
    out = torch.zeros((n,) + src.shape[1:], dtype=src.dtype)
    return out.index_add_(0, seg, src)
def _pad(x, pw):
    flat = tuple(v for pair in reversed(pw) for v in pair)
    return torch.nn.functional.pad(x, flat)

kernel_name = 'sequential_preLN__ssm_conv_h3__mixer_s_mlp__prompt'

def setup_inputs():

    _w = (lambda a: (lambda t: t.to(torch.bfloat16) if t.is_floating_point() else t)(torch.as_tensor(a)))
    def _A_setup():
        B, S, D = 1, 2048, 640
        ks = 4
        return {
            "q": _w((lambda *s: torch.randn(*s, dtype=torch.bfloat16) * 0.05)(B, S, D)),
            "k": _w((lambda *s: torch.randn(*s, dtype=torch.bfloat16) * 0.4)(B, S, D)),
            "v": _w((lambda *s: torch.randn(*s, dtype=torch.bfloat16) * 0.4)(B, S, D)),
            "shift_k": _w((lambda *s: torch.randn(*s, dtype=torch.bfloat16) * 0.4)(D, ks) * 0.5),
            "ssm_k": _w((lambda *s: torch.randn(*s, dtype=torch.bfloat16) * 0.4)(D, S) * (1.0 / S ** 0.5)),
            "ssm_D": _w((lambda *s: torch.randn(*s, dtype=torch.bfloat16) * 0.4)(D)),
        }
    _A_in = _A_setup()

    def _B_setup():
        B, S, D, F = 1, 2048, 640, 1728
        return {
            "x":  _w((lambda *s: torch.randn(*s, dtype=torch.bfloat16) * 0.05)(B, S, D)),
            "w1": _w((lambda *s: torch.randn(*s, dtype=torch.bfloat16) * 3.2)(D, D) * (D ** -0.5)),
            "w2": _w((lambda *s: torch.randn(*s, dtype=torch.bfloat16) * 3.2)(D, D) * (D ** -0.5)),
            "w3": _w((lambda *s: torch.randn(*s, dtype=torch.bfloat16) * 3.2)(D, F) * (D ** -0.5)),
            "w4": _w((lambda *s: torch.randn(*s, dtype=torch.bfloat16) * 3.2)(F, D) * (F ** -0.5)),
        }
    _B_in = _B_setup()

    return {
        "A_q": _A_in["q"],
        "A_k": _A_in["k"],
        "A_v": _A_in["v"],
        "A_shift_k": _A_in["shift_k"],
        "A_ssm_k": _A_in["ssm_k"],
        "A_ssm_D": _A_in["ssm_D"],
        "B_x": _B_in["x"],
        "B_w1": _B_in["w1"],
        "B_w2": _B_in["w2"],
        "B_w3": _B_in["w3"],
        "B_w4": _B_in["w4"],
    }

def reference(A_q, A_k, A_v, A_shift_k, A_ssm_k, A_ssm_D, B_x, B_w1, B_w2, B_w3, B_w4):
    def _A_ref(q, k, v, shift_k, ssm_k, ssm_D):
        B, S, D = q.shape
        ks = shift_k.shape[-1]
        k_pad = _pad(k, ((0, 0), (ks - 1, 0), (0, 0)))
        k_shift = torch.zeros_like(k)
        for t in range(ks):
            k_shift = k_shift + k_pad[:, t:t + S, :] * shift_k[:, ks - 1 - t][None, None, :]
        kv = k_shift * v
        L = 2 * S
        kv_pad = _pad(kv, ((0, 0), (0, S), (0, 0)))
        kf_pad = _pad(ssm_k, ((0, 0), (0, S)))
        kv_f = (lambda x, axes=(-2,-1): torch.fft.rfft2(x.float(), dim=axes))(kv_pad[:, None, :, :], axes=(1, 2))
        kf_f = (lambda x, axes=(-2,-1): torch.fft.rfft2(x.float(), dim=axes))(kf_pad[:, None, :], axes=(1, 2))
        kf_f = (lambda x, *d: x.permute(*d))(kf_f, 1, 2, 0)
        y_f = kv_f * kf_f[None, :, :, :]
        y = (lambda x, s, axes=(-2,-1): torch.fft.irfft2(x, s=s, dim=axes).to(torch.bfloat16))(y_f, (1, L), axes=(1, 2))[:, 0, :S, :]
        y = y + kv * ssm_D[None, None, :]
        return q * y

    def _B_ref(x, w1, w2, w3, w4):
        B, S, D = x.shape
        h = _gelu(_layernorm(x, axis=-1) @ w1)
        c = D // 4
        g0 = _pad(h[:, :, 0*c:1*c], ((0, 0), (1, 0), (0, 0)))[:, :S, :]
        g1 = _pad(h[:, :, 1*c:2*c], ((0, 0), (0, 1), (0, 0)))[:, 1:, :]
        g2 = _pad(h[:, :, 2*c:3*c], ((0, 0), (2, 0), (0, 0)))[:, :S, :]
        g3 = _pad(h[:, :, 3*c:   ], ((0, 0), (0, 2), (0, 0)))[:, 2:, :]
        hs = torch.concatenate([g0, g1, g2, g3], axis=-1) @ w2
        x1 = x + hs
        h2 = _gelu(_layernorm(x1, axis=-1) @ w3) @ w4
        return x1 + h2

    x = A_q
    h = x + _A_ref(_layernorm(x, axis=-1), A_k, A_v, A_shift_k, A_ssm_k, A_ssm_D)
    h2 = h + _B_ref(_layernorm(h, axis=-1), B_w1, B_w2, B_w3, B_w4)
    return h2
```

```asm
; @launch grid=(256,1,1) block=(256,1,1) lds=163840
.amdgcn_target "amdgcn-amd-amdhsa--gfx950"
.text
.globl sequential_preLN__ssm_conv_h3__mixer_s_mlp__prompt_kernel
.p2align 8
.type sequential_preLN__ssm_conv_h3__mixer_s_mlp__prompt_kernel,@function
sequential_preLN__ssm_conv_h3__mixer_s_mlp__prompt_kernel:
    s_cmp_ge_u32 s2, 256
    s_cbranch_scc1 L_end
    s_load_dwordx16 s[64:79], s[0:1], 0
    s_load_dwordx8 s[80:87], s[0:1], 64
    s_load_dwordx4 s[88:91], s[0:1], 96
    s_getpc_b64 s[32:33]
L_pc:
    s_sub_u32 s32, s32, L_pc-sequential_preLN__ssm_conv_h3__mixer_s_mlp__prompt_kernel
    s_subb_u32 s33, s33, 0
    s_lshr_b32 s34, s2, 3
    s_mul_i32 s34, s34, 2048
    s_mov_b32 s35, L_end-sequential_preLN__ssm_conv_h3__mixer_s_mlp__prompt_kernel-12
    v_lshlrev_b32 v241, 4, v0
    v_add_u32 v240, s34, v241
    v_min_u32 v240, s35, v240
    global_load_dwordx4 v[244:247], v240, s[32:33]
    s_add_u32 s34, s34, 4096
    v_lshrrev_b32 v30, 6, v0
    v_and_b32 v1, 63, v0
    v_readfirstlane_b32 s3, v30
    v_and_b32 v2, 15, v1
    v_lshrrev_b32 v3, 4, v1
    v_lshlrev_b32 v4, 4, v1
    s_and_b32 s3, s3, 3
    v_add_u32 v5, 0x10000, v4
    v_add_u32 v6, 0x20000, v4
    s_and_b32 s29, s2, 7
    s_lshr_b32 s30, s2, 3
    s_lshr_b32 s31, s30, 3
    s_lshl_b32 s4, s29, 2
    s_add_u32 s4, s4, s31
    s_and_b32 s5, s30, 7
    s_lshl_b32 s28, s3, 10
    v_add_u32 v7, s28, v4
    s_lshl_b32 s6, s4, 2
    s_add_u32 s6, s6, s3
    s_mov_b32 s92, 0x05040100
    s_mov_b32 s93, 0x07060302
    s_mov_b32 s94, 0xffff0000
    v_mul_u32_u24 v32, 6554, v0
    v_lshrrev_b32 v32, 16, v32
    v_mul_u32_u24 v33, 10, v32
    v_sub_u32 v33, v0, v33
    s_mul_i32 s40, s4, 81920
    s_mul_i32 s41, s5, 160
    s_add_u32 s40, s40, s41
    v_mul_u32_u24 v34, 5120, v32
    v_lshl_add_u32 v34, v33, 4, v34
    v_add_u32 v34, s40, v34
    v_subrev_u32 v35, 3840, v34
    s_mul_i32 s41, s5, 640
    v_lshlrev_b32 v36, 6, v33
    v_add_u32 v36, s41, v36
    s_waitcnt lgkmcnt(0)
    s_cmp_eq_u32 s3, 3
    s_cbranch_scc1 L_p0w3_2
    s_mov_b32 s12, s66
    s_and_b32 s13, s67, 0xffff
    s_mov_b32 s14, 0x280000
    s_mov_b32 s15, 0x20000
    s_mov_b32 s24, s70
    s_and_b32 s25, s71, 0xffff
    s_mov_b32 s26, 0x1400
    s_mov_b32 s27, 0x20000
    s_mov_b32 s16, s68
    s_and_b32 s17, s69, 0xffff
    s_mov_b32 s18, 0x280000
    s_mov_b32 s19, 0x20000
    s_cmp_eq_u32 s3, 2
    s_cselect_b32 exec_hi, 0, -1
    buffer_load_dwordx4 v[40:43], v35, s[12:15], 0 offen offset:0
    buffer_load_dwordx4 v[44:47], v35, s[12:15], 0 offen offset:1280
    buffer_load_dwordx4 v[48:51], v35, s[12:15], 0 offen offset:2560
    buffer_load_dwordx4 v[52:55], v34, s[12:15], 0 offen offset:0
    buffer_load_dwordx4 v[56:59], v34, s[12:15], 0 offen offset:1280
    buffer_load_dwordx4 v[60:63], v34, s[12:15], 0 offen offset:2560
    buffer_load_dwordx4 v[64:67], v34, s[12:15], 0 offen offset:3840
    buffer_load_dwordx4 v[100:103], v36, s[24:27], 0 offen offset:0
    buffer_load_dwordx4 v[104:107], v36, s[24:27], 0 offen offset:16
    buffer_load_dwordx4 v[108:111], v36, s[24:27], 0 offen offset:32
    buffer_load_dwordx4 v[112:115], v36, s[24:27], 0 offen offset:48
    buffer_load_dwordx4 v[68:71], v34, s[16:19], 0 offen offset:0
    buffer_load_dwordx4 v[72:75], v34, s[16:19], 0 offen offset:1280
    buffer_load_dwordx4 v[76:79], v34, s[16:19], 0 offen offset:2560
    buffer_load_dwordx4 v[80:83], v34, s[16:19], 0 offen offset:3840
    s_mov_b64 exec, -1
    s_mov_b32 s20, s64
    s_and_b32 s21, s65, 0xffff
    s_mov_b32 s22, 0x280000
    s_mov_b32 s23, 0x20000
    s_mov_b32 s8, s90
    s_and_b32 s9, s91, 0xffff
    s_mov_b32 s10, 0x2000000
    s_mov_b32 s11, 0x20000
    s_mul_i32 s76, s5, 102400
    s_add_u32 s77, s76, 0x1408000
    s_add_u32 s76, s76, 0x1340000
    s_and_b32 s88, s30, 15
    s_mul_i32 s88, s88, 143360
    s_add_u32 s88, s88, 0x14d0000
    s_mul_i32 s89, s5, 276480
    s_add_u32 s89, s89, 0x1700000
    s_add_u32 s76, s76, s28
    s_add_u32 s77, s77, s28
    s_add_u32 s88, s88, s28
    s_add_u32 s89, s89, s28
    s_cmp_lg_u32 s30, 31
    s_cbranch_scc1 L_pret_4
    s_cmp_lg_u32 s3, 3
    s_cbranch_scc1 L_pret_4
    v_lshlrev_b32 v238, 7, v1
    s_mov_b32 s33, 0x1948000
    buffer_load_dword v239, v238, s[8:11], s33 offen
    s_mov_b32 s33, 0x194a000
    buffer_load_dword v239, v238, s[8:11], s33 offen
    s_mov_b32 s33, 0x194c000
    buffer_load_dword v239, v238, s[8:11], s33 offen
    s_mov_b32 s33, 0x194e000
    buffer_load_dword v239, v238, s[8:11], s33 offen
    s_mov_b32 s33, 0x1920000
    buffer_load_dword v239, v238, s[8:11], s33 offen
    s_mov_b32 s33, 0x1922000
    buffer_load_dword v239, v238, s[8:11], s33 offen
L_pret_4:
    v_mov_b32 v30, 0
    s_mov_b32 s31, 0x194d800
    buffer_load_dword v31, v30, s[8:11], s31 offen sc1
    s_cmp_eq_u32 s3, 2
    s_cselect_b32 exec_hi, 0, -1
    v_and_b32 v39, 7, v33
    v_lshrrev_b32 v116, 1, v32
    v_xor_b32 v116, v116, v39
    v_lshlrev_b32 v116, 4, v116
    v_and_b32 v117, 1, v32
    v_lshl_add_u32 v116, v117, 3, v116
    v_lshl_add_u32 v38, v33, 10, v116
    v_add_u32 v38, 10240, v38
    v_sub_u32 v118, 15, v32
    v_lshrrev_b32 v116, 1, v118
    v_xor_b32 v116, v116, v39
    v_lshlrev_b32 v116, 4, v116
    v_and_b32 v117, 1, v118
    v_lshl_add_u32 v116, v117, 3, v116
    v_lshl_add_u32 v37, v33, 10, v116
    v_mov_b32 v166, v38
    s_waitcnt vmcnt(0)
    s_barrier
    buffer_load_dwordx4 v[168:171], v34, s[20:23], 0 offen offset:0
    buffer_load_dwordx4 v[172:175], v34, s[20:23], 0 offen offset:1280
    buffer_load_dwordx4 v[176:179], v34, s[20:23], 0 offen offset:2560
    buffer_load_dwordx4 v[180:183], v34, s[20:23], 0 offen offset:3840
    v_lshlrev_b32 v116, 16, v40
    v_and_b32 v117, s94, v40
    v_lshlrev_b32 v118, 16, v44
    v_and_b32 v119, s94, v44
    v_lshlrev_b32 v120, 16, v48
    v_and_b32 v121, s94, v48
    v_lshlrev_b32 v122, 16, v52
    v_and_b32 v123, s94, v52
    v_lshlrev_b32 v124, 16, v56
    v_and_b32 v125, s94, v56
    v_lshlrev_b32 v126, 16, v60
    v_and_b32 v127, s94, v60
    v_lshlrev_b32 v128, 16, v64
    v_and_b32 v129, s94, v64
    v_lshlrev_b32 v130, 16, v100
    v_lshlrev_b32 v131, 16, v102
    v_and_b32 v132, s94, v100
    v_and_b32 v133, s94, v102
    v_lshlrev_b32 v134, 16, v101
    v_lshlrev_b32 v135, 16, v103
    v_and_b32 v136, s94, v101
    v_and_b32 v137, s94, v103
    v_pk_mul_f32 v[140:141], v[122:123], v[130:131]
    v_pk_fma_f32 v[140:141], v[120:121], v[132:133], v[140:141]
    v_pk_fma_f32 v[140:141], v[118:119], v[134:135], v[140:141]
    v_pk_fma_f32 v[140:141], v[116:117], v[136:137], v[140:141]
    v_lshlrev_b32 v138, 16, v68
    v_and_b32 v139, s94, v68
    v_pk_mul_f32 v[142:143], v[140:141], v[138:139]
    v_pk_mul_f32 v[140:141], v[124:125], v[130:131]
    v_pk_fma_f32 v[140:141], v[122:123], v[132:133], v[140:141]
    v_pk_fma_f32 v[140:141], v[120:121], v[134:135], v[140:141]
    v_pk_fma_f32 v[140:141], v[118:119], v[136:137], v[140:141]
    v_lshlrev_b32 v138, 16, v72
    v_and_b32 v139, s94, v72
    v_pk_mul_f32 v[144:145], v[140:141], v[138:139]
    v_pk_mul_f32 v[140:141], v[126:127], v[130:131]
    v_pk_fma_f32 v[140:141], v[124:125], v[132:133], v[140:141]
    v_pk_fma_f32 v[140:141], v[122:123], v[134:135], v[140:141]
    v_pk_fma_f32 v[140:141], v[120:121], v[136:137], v[140:141]
    v_lshlrev_b32 v138, 16, v76
    v_and_b32 v139, s94, v76
    v_pk_mul_f32 v[146:147], v[140:141], v[138:139]
    v_pk_mul_f32 v[140:141], v[128:129], v[130:131]
    v_pk_fma_f32 v[140:141], v[126:127], v[132:133], v[140:141]
    v_pk_fma_f32 v[140:141], v[124:125], v[134:135], v[140:141]
    v_pk_fma_f32 v[140:141], v[122:123], v[136:137], v[140:141]
    v_lshlrev_b32 v138, 16, v80
    v_and_b32 v139, s94, v80
    v_pk_mul_f32 v[148:149], v[140:141], v[138:139]
    v_cvt_pk_bf16_f32 v150, v148, v146
    v_cvt_pk_bf16_f32 v151, v144, v142
    ds_write_b64 v37, v[150:151] offset:0
    v_cvt_pk_bf16_f32 v152, v149, v147
    v_cvt_pk_bf16_f32 v153, v145, v143
    ds_write_b64 v37, v[152:153] offset:128
    v_lshlrev_b32 v116, 16, v41
    v_and_b32 v117, s94, v41
    v_lshlrev_b32 v118, 16, v45
    v_and_b32 v119, s94, v45
    v_lshlrev_b32 v120, 16, v49
    v_and_b32 v121, s94, v49
    v_lshlrev_b32 v122, 16, v53
    v_and_b32 v123, s94, v53
    v_lshlrev_b32 v124, 16, v57
    v_and_b32 v125, s94, v57
    v_lshlrev_b32 v126, 16, v61
    v_and_b32 v127, s94, v61
    v_lshlrev_b32 v128, 16, v65
    v_and_b32 v129, s94, v65
    v_lshlrev_b32 v130, 16, v104
    v_lshlrev_b32 v131, 16, v106
    v_and_b32 v132, s94, v104
    v_and_b32 v133, s94, v106
    v_lshlrev_b32 v134, 16, v105
    v_lshlrev_b32 v135, 16, v107
    v_and_b32 v136, s94, v105
    v_and_b32 v137, s94, v107
    v_pk_mul_f32 v[140:141], v[122:123], v[130:131]
    v_pk_fma_f32 v[140:141], v[120:121], v[132:133], v[140:141]
    v_pk_fma_f32 v[140:141], v[118:119], v[134:135], v[140:141]
    v_pk_fma_f32 v[140:141], v[116:117], v[136:137], v[140:141]
    v_lshlrev_b32 v138, 16, v69
    v_and_b32 v139, s94, v69
    v_pk_mul_f32 v[142:143], v[140:141], v[138:139]
    v_pk_mul_f32 v[140:141], v[124:125], v[130:131]
    v_pk_fma_f32 v[140:141], v[122:123], v[132:133], v[140:141]
    v_pk_fma_f32 v[140:141], v[120:121], v[134:135], v[140:141]
    v_pk_fma_f32 v[140:141], v[118:119], v[136:137], v[140:141]
    v_lshlrev_b32 v138, 16, v73
    v_and_b32 v139, s94, v73
    v_pk_mul_f32 v[144:145], v[140:141], v[138:139]
    v_pk_mul_f32 v[140:141], v[126:127], v[130:131]
    v_pk_fma_f32 v[140:141], v[124:125], v[132:133], v[140:141]
    v_pk_fma_f32 v[140:141], v[122:123], v[134:135], v[140:141]
    v_pk_fma_f32 v[140:141], v[120:121], v[136:137], v[140:141]
    v_lshlrev_b32 v138, 16, v77
    v_and_b32 v139, s94, v77
    v_pk_mul_f32 v[146:147], v[140:141], v[138:139]
    v_pk_mul_f32 v[140:141], v[128:129], v[130:131]
    v_pk_fma_f32 v[140:141], v[126:127], v[132:133], v[140:141]
    v_pk_fma_f32 v[140:141], v[124:125], v[134:135], v[140:141]
    v_pk_fma_f32 v[140:141], v[122:123], v[136:137], v[140:141]
    v_lshlrev_b32 v138, 16, v81
    v_and_b32 v139, s94, v81
    v_pk_mul_f32 v[148:149], v[140:141], v[138:139]
    v_cvt_pk_bf16_f32 v154, v148, v146
    v_cvt_pk_bf16_f32 v155, v144, v142
    ds_write_b64 v37, v[154:155] offset:256
    v_cvt_pk_bf16_f32 v156, v149, v147
    v_cvt_pk_bf16_f32 v157, v145, v143
    ds_write_b64 v37, v[156:157] offset:384
    v_lshlrev_b32 v116, 16, v42
    v_and_b32 v117, s94, v42
    v_lshlrev_b32 v118, 16, v46
    v_and_b32 v119, s94, v46
    v_lshlrev_b32 v120, 16, v50
    v_and_b32 v121, s94, v50
    v_lshlrev_b32 v122, 16, v54
    v_and_b32 v123, s94, v54
    v_lshlrev_b32 v124, 16, v58
    v_and_b32 v125, s94, v58
    v_lshlrev_b32 v126, 16, v62
    v_and_b32 v127, s94, v62
    v_lshlrev_b32 v128, 16, v66
    v_and_b32 v129, s94, v66
    v_lshlrev_b32 v130, 16, v108
    v_lshlrev_b32 v131, 16, v110
    v_and_b32 v132, s94, v108
    v_and_b32 v133, s94, v110
    v_lshlrev_b32 v134, 16, v109
    v_lshlrev_b32 v135, 16, v111
    v_and_b32 v136, s94, v109
    v_and_b32 v137, s94, v111
    v_pk_mul_f32 v[140:141], v[122:123], v[130:131]
    v_pk_fma_f32 v[140:141], v[120:121], v[132:133], v[140:141]
    v_pk_fma_f32 v[140:141], v[118:119], v[134:135], v[140:141]
    v_pk_fma_f32 v[140:141], v[116:117], v[136:137], v[140:141]
    v_lshlrev_b32 v138, 16, v70
    v_and_b32 v139, s94, v70
    v_pk_mul_f32 v[142:143], v[140:141], v[138:139]
    v_pk_mul_f32 v[140:141], v[124:125], v[130:131]
    v_pk_fma_f32 v[140:141], v[122:123], v[132:133], v[140:141]
    v_pk_fma_f32 v[140:141], v[120:121], v[134:135], v[140:141]
    v_pk_fma_f32 v[140:141], v[118:119], v[136:137], v[140:141]
    v_lshlrev_b32 v138, 16, v74
    v_and_b32 v139, s94, v74
    v_pk_mul_f32 v[144:145], v[140:141], v[138:139]
    v_pk_mul_f32 v[140:141], v[126:127], v[130:131]
    v_pk_fma_f32 v[140:141], v[124:125], v[132:133], v[140:141]
    v_pk_fma_f32 v[140:141], v[122:123], v[134:135], v[140:141]
    v_pk_fma_f32 v[140:141], v[120:121], v[136:137], v[140:141]
    v_lshlrev_b32 v138, 16, v78
    v_and_b32 v139, s94, v78
    v_pk_mul_f32 v[146:147], v[140:141], v[138:139]
    v_pk_mul_f32 v[140:141], v[128:129], v[130:131]
    v_pk_fma_f32 v[140:141], v[126:127], v[132:133], v[140:141]
    v_pk_fma_f32 v[140:141], v[124:125], v[134:135], v[140:141]
    v_pk_fma_f32 v[140:141], v[122:123], v[136:137], v[140:141]
    v_lshlrev_b32 v138, 16, v82
    v_and_b32 v139, s94, v82
    v_pk_mul_f32 v[148:149], v[140:141], v[138:139]
    v_cvt_pk_bf16_f32 v150, v148, v146
    v_cvt_pk_bf16_f32 v151, v144, v142
    ds_write_b64 v37, v[150:151] offset:512
    v_cvt_pk_bf16_f32 v152, v149, v147
    v_cvt_pk_bf16_f32 v153, v145, v143
    ds_write_b64 v37, v[152:153] offset:640
    v_lshlrev_b32 v116, 16, v43
    v_and_b32 v117, s94, v43
    v_lshlrev_b32 v118, 16, v47
    v_and_b32 v119, s94, v47
    v_lshlrev_b32 v120, 16, v51
    v_and_b32 v121, s94, v51
    v_lshlrev_b32 v122, 16, v55
    v_and_b32 v123, s94, v55
    v_lshlrev_b32 v124, 16, v59
    v_and_b32 v125, s94, v59
    v_lshlrev_b32 v126, 16, v63
    v_and_b32 v127, s94, v63
    v_lshlrev_b32 v128, 16, v67
    v_and_b32 v129, s94, v67
    v_lshlrev_b32 v130, 16, v112
    v_lshlrev_b32 v131, 16, v114
    v_and_b32 v132, s94, v112
    v_and_b32 v133, s94, v114
    v_lshlrev_b32 v134, 16, v113
    v_lshlrev_b32 v135, 16, v115
    v_and_b32 v136, s94, v113
    v_and_b32 v137, s94, v115
    v_pk_mul_f32 v[140:141], v[122:123], v[130:131]
    v_pk_fma_f32 v[140:141], v[120:121], v[132:133], v[140:141]
    v_pk_fma_f32 v[140:141], v[118:119], v[134:135], v[140:141]
    v_pk_fma_f32 v[140:141], v[116:117], v[136:137], v[140:141]
    v_lshlrev_b32 v138, 16, v71
    v_and_b32 v139, s94, v71
    v_pk_mul_f32 v[142:143], v[140:141], v[138:139]
    v_pk_mul_f32 v[140:141], v[124:125], v[130:131]
    v_pk_fma_f32 v[140:141], v[122:123], v[132:133], v[140:141]
    v_pk_fma_f32 v[140:141], v[120:121], v[134:135], v[140:141]
    v_pk_fma_f32 v[140:141], v[118:119], v[136:137], v[140:141]
    v_lshlrev_b32 v138, 16, v75
    v_and_b32 v139, s94, v75
    v_pk_mul_f32 v[144:145], v[140:141], v[138:139]
    v_pk_mul_f32 v[140:141], v[126:127], v[130:131]
    v_pk_fma_f32 v[140:141], v[124:125], v[132:133], v[140:141]
    v_pk_fma_f32 v[140:141], v[122:123], v[134:135], v[140:141]
    v_pk_fma_f32 v[140:141], v[120:121], v[136:137], v[140:141]
    v_lshlrev_b32 v138, 16, v79
    v_and_b32 v139, s94, v79
    v_pk_mul_f32 v[146:147], v[140:141], v[138:139]
    v_pk_mul_f32 v[140:141], v[128:129], v[130:131]
    v_pk_fma_f32 v[140:141], v[126:127], v[132:133], v[140:141]
    v_pk_fma_f32 v[140:141], v[124:125], v[134:135], v[140:141]
    v_pk_fma_f32 v[140:141], v[122:123], v[136:137], v[140:141]
    v_lshlrev_b32 v138, 16, v83
    v_and_b32 v139, s94, v83
    v_pk_mul_f32 v[148:149], v[140:141], v[138:139]
    v_cvt_pk_bf16_f32 v154, v148, v146
    v_cvt_pk_bf16_f32 v155, v144, v142
    ds_write_b64 v37, v[154:155] offset:768
    v_cvt_pk_bf16_f32 v156, v149, v147
    v_cvt_pk_bf16_f32 v157, v145, v143
    ds_write_b64 v37, v[156:157] offset:896
    s_mov_b64 exec, -1
    s_branch L_p0A_3
L_p0w3_2:
    s_mov_b32 s20, s64
    s_and_b32 s21, s65, 0xffff
    s_mov_b32 s22, 0x280000
    s_mov_b32 s23, 0x20000
    s_mov_b32 s8, s90
    s_and_b32 s9, s91, 0xffff
    s_mov_b32 s10, 0x2000000
    s_mov_b32 s11, 0x20000
    s_mul_i32 s76, s5, 102400
    s_add_u32 s77, s76, 0x1408000
    s_add_u32 s76, s76, 0x1340000
    s_and_b32 s88, s30, 15
    s_mul_i32 s88, s88, 143360
    s_add_u32 s88, s88, 0x14d0000
    s_mul_i32 s89, s5, 276480
    s_add_u32 s89, s89, 0x1700000
    s_add_u32 s76, s76, s28
    s_add_u32 s77, s77, s28
    s_add_u32 s88, s88, s28
    s_add_u32 s89, s89, s28
    s_cmp_lg_u32 s30, 31
    s_cbranch_scc1 L_pret_5
    s_cmp_lg_u32 s3, 3
    s_cbranch_scc1 L_pret_5
    v_lshlrev_b32 v238, 7, v1
    s_mov_b32 s33, 0x1948000
    buffer_load_dword v239, v238, s[8:11], s33 offen
    s_mov_b32 s33, 0x194a000
    buffer_load_dword v239, v238, s[8:11], s33 offen
    s_mov_b32 s33, 0x194c000
    buffer_load_dword v239, v238, s[8:11], s33 offen
    s_mov_b32 s33, 0x194e000
    buffer_load_dword v239, v238, s[8:11], s33 offen
    s_mov_b32 s33, 0x1920000
    buffer_load_dword v239, v238, s[8:11], s33 offen
    s_mov_b32 s33, 0x1922000
    buffer_load_dword v239, v238, s[8:11], s33 offen
L_pret_5:
    v_mov_b32 v30, 0
    s_mov_b32 s31, 0x194d800
    buffer_load_dword v31, v30, s[8:11], s31 offen sc1
    v_lshrrev_b32 v184, 3, v1
    v_and_b32 v33, 7, v1
    s_lshl_b32 s57, s4, 3
    s_add_u32 s57, s57, s5
    s_lshl_b32 s57, s57, 3
    s_mul_i32 s41, s57, 1280
    v_mul_u32_u24 v34, 1280, v184
    v_lshl_add_u32 v34, v33, 4, v34
    v_add_u32 v34, s41, v34
    s_mov_b32 s12, s78
    s_and_b32 s13, s79, 0xffff
    s_mov_b32 s14, 0xc8000
    s_mov_b32 s15, 0x20000
    s_mov_b32 s16, s80
    s_and_b32 s17, s81, 0xffff
    s_mov_b32 s18, 0xc8000
    s_mov_b32 s19, 0x20000
    s_mul_hi_u32 s50, s2, 429496730
    s_mul_i32 s51, s50, 10
    s_sub_u32 s51, s2, s51
    s_mov_b32 s52, 1280
    s_mov_b32 s53, 20480
    s_mov_b32 s54, 10240
    v_lshrrev_b32 v36, 3, v1
    v_mul_lo_u32 v36, v36, s52
    v_and_b32 v37, 7, v1
    v_lshl_add_u32 v36, v37, 4, v36
    v_lshrrev_b32 v37, 2, v1
    v_and_b32 v37, 3, v37
    v_lshl_add_u32 v37, v3, 3, v37
    v_lshlrev_b32 v37, 7, v37
    v_and_b32 v240, 3, v1
    v_lshl_add_u32 v37, v240, 3, v37
    v_add_u32 v37, s53, v37
    s_mul_i32 s55, s50, 40960
    s_lshl_b32 s56, s51, 7
    s_add_u32 s55, s55, s56
    s_lshl_b32 s40, s51, 2
    s_add_u32 s40, s40, 0
    s_mul_i32 s41, s40, 52
    s_lshr_b32 s41, s41, 8
    s_mul_i32 s42, s41, 5
    s_sub_u32 s42, s40, s42
    s_mul_i32 s41, s41, 20
    s_add_u32 s41, s41, s50
    s_mul_i32 s41, s41, 5
    s_add_u32 s41, s41, s42
    s_lshl_b32 s41, s41, 10
    s_add_u32 s96, s41, 0x1340000
    s_lshl_b32 s40, s51, 2
    s_add_u32 s40, s40, 1
    s_mul_i32 s41, s40, 52
    s_lshr_b32 s41, s41, 8
    s_mul_i32 s42, s41, 5
    s_sub_u32 s42, s40, s42
    s_mul_i32 s41, s41, 20
    s_add_u32 s41, s41, s50
    s_mul_i32 s41, s41, 5
    s_add_u32 s41, s41, s42
    s_lshl_b32 s41, s41, 10
    s_add_u32 s97, s41, 0x1340000
    s_lshl_b32 s40, s51, 2
    s_add_u32 s40, s40, 2
    s_mul_i32 s41, s40, 52
    s_lshr_b32 s41, s41, 8
    s_mul_i32 s42, s41, 5
    s_sub_u32 s42, s40, s42
    s_mul_i32 s41, s41, 20
    s_add_u32 s41, s41, s50
    s_mul_i32 s41, s41, 5
    s_add_u32 s41, s41, s42
    s_lshl_b32 s41, s41, 10
    s_add_u32 s98, s41, 0x1340000
    s_lshl_b32 s40, s51, 2
    s_add_u32 s40, s40, 3
    s_mul_i32 s41, s40, 52
    s_lshr_b32 s41, s41, 8
    s_mul_i32 s42, s41, 5
    s_sub_u32 s42, s40, s42
    s_mul_i32 s41, s41, 20
    s_add_u32 s41, s41, s50
    s_mul_i32 s41, s41, 5
    s_add_u32 s41, s41, s42
    s_lshl_b32 s41, s41, 10
    s_add_u32 s99, s41, 0x1340000
    s_barrier
    buffer_load_dwordx4 v[120:123], v34, s[20:23], 0 offen offset:0
    buffer_load_dwordx4 v[124:127], v34, s[20:23], 0 offen offset:128
    buffer_load_dwordx4 v[128:131], v34, s[20:23], 0 offen offset:256
    buffer_load_dwordx4 v[132:135], v34, s[20:23], 0 offen offset:384
    buffer_load_dwordx4 v[136:139], v34, s[20:23], 0 offen offset:512
    buffer_load_dwordx4 v[140:143], v34, s[20:23], 0 offen offset:640
    buffer_load_dwordx4 v[144:147], v34, s[20:23], 0 offen offset:768
    buffer_load_dwordx4 v[148:151], v34, s[20:23], 0 offen offset:896
    buffer_load_dwordx4 v[152:155], v34, s[20:23], 0 offen offset:1024
    buffer_load_dwordx4 v[156:159], v34, s[20:23], 0 offen offset:1152
    s_cmp_ge_u32 s2, 200
    s_cbranch_scc1 L_np_6
    s_mov_b32 s32, s55
    s_add_u32 m0, s53, 0
    s_nop 0
    buffer_load_dwordx4 v36, s[12:15], s32 offen lds
    s_add_u32 m0, s53, 1024
    s_add_u32 s32, s32, s54
    buffer_load_dwordx4 v36, s[12:15], s32 offen lds
    s_add_u32 m0, s53, 2048
    s_add_u32 s32, s32, s54
    buffer_load_dwordx4 v36, s[12:15], s32 offen lds
    s_add_u32 m0, s53, 3072
    s_add_u32 s32, s32, s54
    buffer_load_dwordx4 v36, s[12:15], s32 offen lds
    s_mov_b32 s32, s55
    s_add_u32 m0, s53, 4096
    s_nop 0
    buffer_load_dwordx4 v36, s[16:19], s32 offen lds
    s_add_u32 m0, s53, 5120
    s_add_u32 s32, s32, s54
    buffer_load_dwordx4 v36, s[16:19], s32 offen lds
    s_add_u32 m0, s53, 6144
    s_add_u32 s32, s32, s54
    buffer_load_dwordx4 v36, s[16:19], s32 offen lds
    s_add_u32 m0, s53, 7168
    s_add_u32 s32, s32, s54
    buffer_load_dwordx4 v36, s[16:19], s32 offen lds
L_np_6:
L_p0A_3:
    s_waitcnt lgkmcnt(0)
    s_barrier
    s_mul_i32 s40, s5, 327680
    s_lshl_b32 s41, s4, 7
    s_sub_u32 s42, 3968, s41
    s_add_u32 s42, s42, s40
    s_add_u32 s42, s42, 0x0
    s_add_u32 s58, s41, s40
    s_add_u32 s58, s58, 0x280000
    v_and_b32 v32, 7, v0
    v_lshrrev_b32 v33, 3, v0
    v_lshlrev_b32 v39, 4, v32
    v_add_u32 v40, 0, v33
    v_lshrrev_b32 v46, 3, v40
    v_and_b32 v46, 7, v46
    v_xor_b32 v46, v46, v32
    v_lshlrev_b32 v46, 4, v46
    v_lshl_add_u32 v41, v40, 7, v46
    v_lshl_add_u32 v50, v40, 12, v39
    v_add_u32 v50, s42, v50
    ds_read_b128 v[60:63], v41
    v_add_u32 v40, 32, v33
    v_lshrrev_b32 v46, 3, v40
    v_and_b32 v46, 7, v46
    v_xor_b32 v46, v46, v32
    v_lshlrev_b32 v46, 4, v46
    v_lshl_add_u32 v42, v40, 7, v46
    v_lshl_add_u32 v51, v40, 12, v39
    v_add_u32 v51, s42, v51
    ds_read_b128 v[64:67], v42
    v_add_u32 v40, 64, v33
    v_lshrrev_b32 v46, 3, v40
    v_and_b32 v46, 7, v46
    v_xor_b32 v46, v46, v32
    v_lshlrev_b32 v46, 4, v46
    v_lshl_add_u32 v43, v40, 7, v46
    v_lshl_add_u32 v52, v40, 12, v39
    v_add_u32 v52, s42, v52
    v_mov_b32 v46, 0x7f000000
    v_cmp_gt_u32 vcc, 128, v0
    s_nop 1
    v_cndmask_b32 v52, v46, v52, vcc
    ds_read_b128 v[68:71], v43
    s_waitcnt lgkmcnt(2)
    buffer_store_dwordx4 v[60:63], v50, s[8:11], 0 offen sc1
    s_waitcnt lgkmcnt(1)
    buffer_store_dwordx4 v[64:67], v51, s[8:11], 0 offen sc1
    s_waitcnt lgkmcnt(0)
    buffer_store_dwordx4 v[68:71], v52, s[8:11], 0 offen sc1
    s_cmp_eq_u32 s3, 3
    s_cbranch_scc1 L_noq_7
    s_waitcnt vmcnt(3)
    s_cmp_eq_u32 s3, 2
    s_cselect_b32 exec_hi, 0, -1
    v_perm_b32 v150, v172, v168, s92
    v_perm_b32 v151, v180, v176, s92
    ds_write_b64 v166, v[150:151] offset:0
    v_perm_b32 v152, v172, v168, s93
    v_perm_b32 v153, v180, v176, s93
    ds_write_b64 v166, v[152:153] offset:128
    v_perm_b32 v154, v173, v169, s92
    v_perm_b32 v155, v181, v177, s92
    ds_write_b64 v166, v[154:155] offset:256
    v_perm_b32 v156, v173, v169, s93
    v_perm_b32 v157, v181, v177, s93
    ds_write_b64 v166, v[156:157] offset:384
    v_perm_b32 v150, v174, v170, s92
    v_perm_b32 v151, v182, v178, s92
    ds_write_b64 v166, v[150:151] offset:512
    v_perm_b32 v152, v174, v170, s93
    v_perm_b32 v153, v182, v178, s93
    ds_write_b64 v166, v[152:153] offset:640
    v_perm_b32 v154, v175, v171, s92
    v_perm_b32 v155, v183, v179, s92
    ds_write_b64 v166, v[154:155] offset:768
    v_perm_b32 v156, v175, v171, s93
    v_perm_b32 v157, v183, v179, s93
    ds_write_b64 v166, v[156:157] offset:896
    s_mov_b64 exec, -1
L_noq_7:
    s_cmp_ge_u32 s30, 20
    s_cbranch_scc1 L_kc_8
    s_mul_i32 s44, s29, 20
    s_add_u32 s44, s44, s30
    s_lshl_b32 s44, s44, 2
    s_add_u32 s44, s44, s3
    s_mul_i32 s45, s3, 12992
    s_add_u32 s45, s45, 102400
    s_mov_b32 s24, s72
    s_and_b32 s25, s73, 0xffff
    s_mov_b32 s26, 0x280000
    s_mov_b32 s27, 0x20000
    s_lshl_b32 s46, s44, 12
    s_add_u32 s40, s72, s46
    s_addc_u32 s41, s73, 0
    s_load_dword s47, s[40:41], 0
    s_lshl_b32 s42, s44, 1
    s_and_b32 s42, s42, 0xfffffffc
    s_add_u32 s42, s74, s42
    s_addc_u32 s43, s75, 0
    s_load_dword s48, s[42:43], 0
    v_add_u32 v240, 2, v4
    s_add_u32 m0, s45, 32
    s_add_u32 s32, s46, 0
    buffer_load_dwordx4 v4, s[24:27], s32 offen lds
    s_add_u32 m0, s45, 1056
    s_add_u32 s32, s46, 1024
    buffer_load_dwordx4 v4, s[24:27], s32 offen lds
    s_add_u32 m0, s45, 2080
    s_add_u32 s32, s46, 2048
    buffer_load_dwordx4 v4, s[24:27], s32 offen lds
    s_add_u32 m0, s45, 3104
    s_add_u32 s32, s46, 3072
    buffer_load_dwordx4 v4, s[24:27], s32 offen lds
    s_add_u32 m0, s45, 4192
    s_add_u32 s32, s46, 0
    buffer_load_dwordx4 v240, s[24:27], s32 offen lds
    s_add_u32 m0, s45, 5216
    s_add_u32 s32, s46, 1024
    buffer_load_dwordx4 v240, s[24:27], s32 offen lds
    s_add_u32 m0, s45, 6240
    s_add_u32 s32, s46, 2048
    buffer_load_dwordx4 v240, s[24:27], s32 offen lds
    s_add_u32 m0, s45, 7264
    s_add_u32 s32, s46, 3072
    buffer_load_dwordx4 v240, s[24:27], s32 offen lds
    v_mov_b32 v242, 0
    v_mov_b32 v243, 0
    v_lshlrev_b32 v241, 3, v1
    v_add_u32 v241, s45, v241
    ds_write_b64 v241, v[242:243] offset:12416
    s_waitcnt lgkmcnt(0)
    s_lshl_b32 s47, s47, 16
    s_and_b32 s32, s44, 1
    s_lshl_b32 s32, s32, 4
    s_lshr_b32 s48, s48, s32
    s_lshl_b32 s48, s48, 16
    v_lshlrev_b32 v241, 2, v1
    v_add_u32 v241, s45, v241
    v_cmp_le_u32 vcc, 8, v1
    v_add_u32 v244, 4128, v241
    s_nop 0
    v_cndmask_b32 v241, v241, v244, vcc
    v_mov_b32 v244, s47
    v_cmp_eq_u32 vcc, 15, v1
    s_nop 1
    v_cndmask_b32 v242, v242, v244, vcc
    s_mov_b64 exec, 0xffff
    ds_write_b32 v241, v242
    s_mov_b64 exec, -1
    s_waitcnt vmcnt(8) lgkmcnt(0)
    s_branch L_kd_9
L_kc_8:
    s_waitcnt vmcnt(0) lgkmcnt(0)
L_kd_9:
    v_readfirstlane_b32 s7, v31
    s_nop 0
    s_add_u32 s7, s7, 0x9E3779B9
    s_barrier
    s_cmp_lg_u32 s3, 0
    s_cbranch_scc1 L_sig_10
    s_lshl_b32 s32, s2, 2
    s_add_u32 s32, s32, 0x1948000
    v_lshlrev_b32 v240, 10, v1
    v_mov_b32 v241, s7
    s_mov_b64 exec, 255
    buffer_store_dword v241, v240, s[8:11], s32 offen sc1
    s_mov_b64 exec, -1
L_sig_10:
    s_cmp_lg_u32 s3, 3
    s_cbranch_scc1 L_now3_11
    v_mov_b32 v80, 0
    v_mov_b32 v81, 0
    v_mov_b32 v82, 0
    v_mov_b32 v83, 0
    v_lshlrev_b32 v84, 16, v120
    v_and_b32 v85, s94, v120
    v_pk_add_f32 v[80:81], v[80:81], v[84:85]
    v_pk_fma_f32 v[82:83], v[84:85], v[84:85], v[82:83]
    v_lshlrev_b32 v86, 16, v121
    v_and_b32 v87, s94, v121
    v_pk_add_f32 v[80:81], v[80:81], v[86:87]
    v_pk_fma_f32 v[82:83], v[86:87], v[86:87], v[82:83]
    v_lshlrev_b32 v88, 16, v122
    v_and_b32 v89, s94, v122
    v_pk_add_f32 v[80:81], v[80:81], v[88:89]
    v_pk_fma_f32 v[82:83], v[88:89], v[88:89], v[82:83]
    v_lshlrev_b32 v90, 16, v123
    v_and_b32 v91, s94, v123
    v_pk_add_f32 v[80:81], v[80:81], v[90:91]
    v_pk_fma_f32 v[82:83], v[90:91], v[90:91], v[82:83]
    v_lshlrev_b32 v84, 16, v124
    v_and_b32 v85, s94, v124
    v_pk_add_f32 v[80:81], v[80:81], v[84:85]
    v_pk_fma_f32 v[82:83], v[84:85], v[84:85], v[82:83]
    v_lshlrev_b32 v86, 16, v125
    v_and_b32 v87, s94, v125
    v_pk_add_f32 v[80:81], v[80:81], v[86:87]
    v_pk_fma_f32 v[82:83], v[86:87], v[86:87], v[82:83]
    v_lshlrev_b32 v88, 16, v126
    v_and_b32 v89, s94, v126
    v_pk_add_f32 v[80:81], v[80:81], v[88:89]
    v_pk_fma_f32 v[82:83], v[88:89], v[88:89], v[82:83]
    v_lshlrev_b32 v90, 16, v127
    v_and_b32 v91, s94, v127
    v_pk_add_f32 v[80:81], v[80:81], v[90:91]
    v_pk_fma_f32 v[82:83], v[90:91], v[90:91], v[82:83]
    v_lshlrev_b32 v84, 16, v128
    v_and_b32 v85, s94, v128
    v_pk_add_f32 v[80:81], v[80:81], v[84:85]
    v_pk_fma_f32 v[82:83], v[84:85], v[84:85], v[82:83]
    v_lshlrev_b32 v86, 16, v129
    v_and_b32 v87, s94, v129
    v_pk_add_f32 v[80:81], v[80:81], v[86:87]
    v_pk_fma_f32 v[82:83], v[86:87], v[86:87], v[82:83]
    v_lshlrev_b32 v88, 16, v130
    v_and_b32 v89, s94, v130
    v_pk_add_f32 v[80:81], v[80:81], v[88:89]
    v_pk_fma_f32 v[82:83], v[88:89], v[88:89], v[82:83]
    v_lshlrev_b32 v90, 16, v131
    v_and_b32 v91, s94, v131
    v_pk_add_f32 v[80:81], v[80:81], v[90:91]
    v_pk_fma_f32 v[82:83], v[90:91], v[90:91], v[82:83]
    v_lshlrev_b32 v84, 16, v132
    v_and_b32 v85, s94, v132
    v_pk_add_f32 v[80:81], v[80:81], v[84:85]
    v_pk_fma_f32 v[82:83], v[84:85], v[84:85], v[82:83]
    v_lshlrev_b32 v86, 16, v133
    v_and_b32 v87, s94, v133
    v_pk_add_f32 v[80:81], v[80:81], v[86:87]
    v_pk_fma_f32 v[82:83], v[86:87], v[86:87], v[82:83]
    v_lshlrev_b32 v88, 16, v134
    v_and_b32 v89, s94, v134
    v_pk_add_f32 v[80:81], v[80:81], v[88:89]
    v_pk_fma_f32 v[82:83], v[88:89], v[88:89], v[82:83]
    v_lshlrev_b32 v90, 16, v135
    v_and_b32 v91, s94, v135
    v_pk_add_f32 v[80:81], v[80:81], v[90:91]
    v_pk_fma_f32 v[82:83], v[90:91], v[90:91], v[82:83]
    v_lshlrev_b32 v84, 16, v136
    v_and_b32 v85, s94, v136
    v_pk_add_f32 v[80:81], v[80:81], v[84:85]
    v_pk_fma_f32 v[82:83], v[84:85], v[84:85], v[82:83]
    v_lshlrev_b32 v86, 16, v137
    v_and_b32 v87, s94, v137
    v_pk_add_f32 v[80:81], v[80:81], v[86:87]
    v_pk_fma_f32 v[82:83], v[86:87], v[86:87], v[82:83]
    v_lshlrev_b32 v88, 16, v138
    v_and_b32 v89, s94, v138
    v_pk_add_f32 v[80:81], v[80:81], v[88:89]
    v_pk_fma_f32 v[82:83], v[88:89], v[88:89], v[82:83]
    v_lshlrev_b32 v90, 16, v139
    v_and_b32 v91, s94, v139
    v_pk_add_f32 v[80:81], v[80:81], v[90:91]
    v_pk_fma_f32 v[82:83], v[90:91], v[90:91], v[82:83]
    v_lshlrev_b32 v84, 16, v140
    v_and_b32 v85, s94, v140
    v_pk_add_f32 v[80:81], v[80:81], v[84:85]
    v_pk_fma_f32 v[82:83], v[84:85], v[84:85], v[82:83]
    v_lshlrev_b32 v86, 16, v141
    v_and_b32 v87, s94, v141
    v_pk_add_f32 v[80:81], v[80:81], v[86:87]
    v_pk_fma_f32 v[82:83], v[86:87], v[86:87], v[82:83]
    v_lshlrev_b32 v88, 16, v142
    v_and_b32 v89, s94, v142
    v_pk_add_f32 v[80:81], v[80:81], v[88:89]
    v_pk_fma_f32 v[82:83], v[88:89], v[88:89], v[82:83]
    v_lshlrev_b32 v90, 16, v143
    v_and_b32 v91, s94, v143
    v_pk_add_f32 v[80:81], v[80:81], v[90:91]
    v_pk_fma_f32 v[82:83], v[90:91], v[90:91], v[82:83]
    v_lshlrev_b32 v84, 16, v144
    v_and_b32 v85, s94, v144
    v_pk_add_f32 v[80:81], v[80:81], v[84:85]
    v_pk_fma_f32 v[82:83], v[84:85], v[84:85], v[82:83]
    v_lshlrev_b32 v86, 16, v145
    v_and_b32 v87, s94, v145
    v_pk_add_f32 v[80:81], v[80:81], v[86:87]
    v_pk_fma_f32 v[82:83], v[86:87], v[86:87], v[82:83]
    v_lshlrev_b32 v88, 16, v146
    v_and_b32 v89, s94, v146
    v_pk_add_f32 v[80:81], v[80:81], v[88:89]
    v_pk_fma_f32 v[82:83], v[88:89], v[88:89], v[82:83]
    v_lshlrev_b32 v90, 16, v147
    v_and_b32 v91, s94, v147
    v_pk_add_f32 v[80:81], v[80:81], v[90:91]
    v_pk_fma_f32 v[82:83], v[90:91], v[90:91], v[82:83]
    v_lshlrev_b32 v84, 16, v148
    v_and_b32 v85, s94, v148
    v_pk_add_f32 v[80:81], v[80:81], v[84:85]
    v_pk_fma_f32 v[82:83], v[84:85], v[84:85], v[82:83]
    v_lshlrev_b32 v86, 16, v149
    v_and_b32 v87, s94, v149
    v_pk_add_f32 v[80:81], v[80:81], v[86:87]
    v_pk_fma_f32 v[82:83], v[86:87], v[86:87], v[82:83]
    v_lshlrev_b32 v88, 16, v150
    v_and_b32 v89, s94, v150
    v_pk_add_f32 v[80:81], v[80:81], v[88:89]
    v_pk_fma_f32 v[82:83], v[88:89], v[88:89], v[82:83]
    v_lshlrev_b32 v90, 16, v151
    v_and_b32 v91, s94, v151
    v_pk_add_f32 v[80:81], v[80:81], v[90:91]
    v_pk_fma_f32 v[82:83], v[90:91], v[90:91], v[82:83]
    v_lshlrev_b32 v84, 16, v152
    v_and_b32 v85, s94, v152
    v_pk_add_f32 v[80:81], v[80:81], v[84:85]
    v_pk_fma_f32 v[82:83], v[84:85], v[84:85], v[82:83]
    v_lshlrev_b32 v86, 16, v153
    v_and_b32 v87, s94, v153
    v_pk_add_f32 v[80:81], v[80:81], v[86:87]
    v_pk_fma_f32 v[82:83], v[86:87], v[86:87], v[82:83]
    v_lshlrev_b32 v88, 16, v154
    v_and_b32 v89, s94, v154
    v_pk_add_f32 v[80:81], v[80:81], v[88:89]
    v_pk_fma_f32 v[82:83], v[88:89], v[88:89], v[82:83]
    v_lshlrev_b32 v90, 16, v155
    v_and_b32 v91, s94, v155
    v_pk_add_f32 v[80:81], v[80:81], v[90:91]
    v_pk_fma_f32 v[82:83], v[90:91], v[90:91], v[82:83]
    v_lshlrev_b32 v84, 16, v156
    v_and_b32 v85, s94, v156
    v_pk_add_f32 v[80:81], v[80:81], v[84:85]
    v_pk_fma_f32 v[82:83], v[84:85], v[84:85], v[82:83]
    v_lshlrev_b32 v86, 16, v157
    v_and_b32 v87, s94, v157
    v_pk_add_f32 v[80:81], v[80:81], v[86:87]
    v_pk_fma_f32 v[82:83], v[86:87], v[86:87], v[82:83]
    v_lshlrev_b32 v88, 16, v158
    v_and_b32 v89, s94, v158
    v_pk_add_f32 v[80:81], v[80:81], v[88:89]
    v_pk_fma_f32 v[82:83], v[88:89], v[88:89], v[82:83]
    v_lshlrev_b32 v90, 16, v159
    v_and_b32 v91, s94, v159
    v_pk_add_f32 v[80:81], v[80:81], v[90:91]
    v_pk_fma_f32 v[82:83], v[90:91], v[90:91], v[82:83]
    v_add_f32 v80, v80, v81
    v_add_f32 v82, v82, v83
    s_nop 0
    v_add_f32_dpp v80, v80, v80 quad_perm:[1,0,3,2] row_mask:0xf bank_mask:0xf
    v_add_f32_dpp v82, v82, v82 quad_perm:[1,0,3,2] row_mask:0xf bank_mask:0xf
    s_nop 0
    v_add_f32_dpp v80, v80, v80 quad_perm:[2,3,0,1] row_mask:0xf bank_mask:0xf
    v_add_f32_dpp v82, v82, v82 quad_perm:[2,3,0,1] row_mask:0xf bank_mask:0xf
    s_nop 0
    v_add_f32_dpp v80, v80, v80 row_half_mirror row_mask:0xf bank_mask:0xf
    v_add_f32_dpp v82, v82, v82 row_half_mirror row_mask:0xf bank_mask:0xf
    v_mul_f32 v80, 0x3acccccd, v80
    v_mul_f32 v82, 0x3acccccd, v82
    v_fma_f32 v82, -v80, v80, v82
    v_max_f32 v82, 0, v82
    v_add_f32 v82, 0x3727c5ac, v82
    v_rsq_f32 v82, v82
    s_nop 0
    v_mul_f32 v83, v80, v82
    v_sub_f32 v83, 0, v83
    v_lshlrev_b32 v84, 2, v184
    s_lshl_b32 s41, s57, 2
    s_add_u32 s42, s41, 0x1920000
    s_add_u32 s43, s41, 0x1922000
    s_mov_b32 exec_lo, 0x01010101
    s_mov_b32 exec_hi, 0x01010101
    buffer_store_dword v82, v84, s[8:11], s42 offen sc1
    buffer_store_dword v83, v84, s[8:11], s43 offen sc1
    s_mov_b64 exec, -1
    s_cmp_ge_u32 s2, 200
    s_cbranch_scc1 L_now3_11
    ds_read_b64_tr_b16 v[88:89], v37 offset:0
    ds_read_b64_tr_b16 v[90:91], v37 offset:512
    ds_read_b64_tr_b16 v[92:93], v37 offset:32
    ds_read_b64_tr_b16 v[94:95], v37 offset:544
    ds_read_b64_tr_b16 v[96:97], v37 offset:64
    ds_read_b64_tr_b16 v[98:99], v37 offset:576
    ds_read_b64_tr_b16 v[100:101], v37 offset:96
    ds_read_b64_tr_b16 v[102:103], v37 offset:608
    ds_read_b64_tr_b16 v[108:109], v37 offset:4096
    ds_read_b64_tr_b16 v[110:111], v37 offset:4608
    ds_read_b64_tr_b16 v[112:113], v37 offset:4128
    ds_read_b64_tr_b16 v[114:115], v37 offset:4640
    ds_read_b64_tr_b16 v[116:117], v37 offset:4160
    ds_read_b64_tr_b16 v[118:119], v37 offset:4672
    ds_read_b64_tr_b16 v[120:121], v37 offset:4192
    ds_read_b64_tr_b16 v[122:123], v37 offset:4704
    s_waitcnt lgkmcnt(14)
    buffer_store_dwordx4 v[88:91], v4, s[8:11], s96 offen sc1
    s_waitcnt lgkmcnt(12)
    buffer_store_dwordx4 v[92:95], v4, s[8:11], s97 offen sc1
    s_waitcnt lgkmcnt(10)
    buffer_store_dwordx4 v[96:99], v4, s[8:11], s98 offen sc1
    s_waitcnt lgkmcnt(8)
    buffer_store_dwordx4 v[100:103], v4, s[8:11], s99 offen sc1
    s_add_u32 s41, s96, 0xc8000
    s_waitcnt lgkmcnt(6)
    buffer_store_dwordx4 v[108:111], v4, s[8:11], s41 offen sc1
    s_add_u32 s41, s97, 0xc8000
    s_waitcnt lgkmcnt(4)
    buffer_store_dwordx4 v[112:115], v4, s[8:11], s41 offen sc1
    s_add_u32 s41, s98, 0xc8000
    s_waitcnt lgkmcnt(2)
    buffer_store_dwordx4 v[116:119], v4, s[8:11], s41 offen sc1
    s_add_u32 s41, s99, 0xc8000
    s_waitcnt lgkmcnt(0)
    buffer_store_dwordx4 v[120:123], v4, s[8:11], s41 offen sc1
L_now3_11:
    v_and_b32 v32, 7, v0
    v_lshrrev_b32 v33, 3, v0
    v_lshlrev_b32 v39, 4, v32
    v_add_u32 v40, 0, v33
    v_lshrrev_b32 v46, 3, v40
    v_and_b32 v46, 7, v46
    v_xor_b32 v46, v46, v32
    v_lshlrev_b32 v46, 4, v46
    v_lshl_add_u32 v41, v40, 7, v46
    v_add_u32 v41, 10240, v41
    v_lshl_add_u32 v50, v40, 12, v39
    v_add_u32 v50, s58, v50
    ds_read_b128 v[60:63], v41
    v_add_u32 v40, 32, v33
    v_lshrrev_b32 v46, 3, v40
    v_and_b32 v46, 7, v46
    v_xor_b32 v46, v46, v32
    v_lshlrev_b32 v46, 4, v46
    v_lshl_add_u32 v42, v40, 7, v46
    v_add_u32 v42, 10240, v42
    v_lshl_add_u32 v51, v40, 12, v39
    v_add_u32 v51, s58, v51
    ds_read_b128 v[64:67], v42
    v_add_u32 v40, 64, v33
    v_lshrrev_b32 v46, 3, v40
    v_and_b32 v46, 7, v46
    v_xor_b32 v46, v46, v32
    v_lshlrev_b32 v46, 4, v46
    v_lshl_add_u32 v43, v40, 7, v46
    v_add_u32 v43, 10240, v43
    v_lshl_add_u32 v52, v40, 12, v39
    v_add_u32 v52, s58, v52
    v_mov_b32 v46, 0x7f000000
    v_cmp_gt_u32 vcc, 128, v0
    s_nop 1
    v_cndmask_b32 v52, v46, v52, vcc
    ds_read_b128 v[68:71], v43
    s_waitcnt lgkmcnt(2)
    buffer_store_dwordx4 v[60:63], v50, s[8:11], 0 offen sc1
    s_waitcnt lgkmcnt(1)
    buffer_store_dwordx4 v[64:67], v51, s[8:11], 0 offen sc1
    s_waitcnt lgkmcnt(0)
    buffer_store_dwordx4 v[68:71], v52, s[8:11], 0 offen sc1
    s_lshl_b32 s95, s29, 5
    s_add_u32 s95, s95, s30
    s_cmp_ge_u32 s30, 20
    s_cbranch_scc1 L_aux_12
    s_waitcnt vmcnt(0)
    s_barrier
    s_cmp_lg_u32 s3, 0
    s_cbranch_scc1 L_sig_14
    s_lshl_b32 s32, s2, 2
    s_add_u32 s32, s32, 0x194e000
    v_lshlrev_b32 v240, 10, v1
    v_mov_b32 v241, s7
    s_mov_b64 exec, 255
    buffer_store_dword v241, v240, s[8:11], s32 offen sc1
    s_mov_b64 exec, -1
L_sig_14:
    s_cmp_lg_u32 s3, 0
    s_cbranch_scc1 L_pskip_15
    v_mov_b32 v240, v4
    s_mov_b32 s32, 0x1948000
    s_lshl_b32 s33, s29, 10
    s_add_u32 s32, s32, s33
    s_mov_b32 s31, 0
L_ploop_16:
    buffer_load_dwordx4 v[244:247], v240, s[8:11], s32 offen sc1
    s_waitcnt vmcnt(0)
    v_xor_b32 v244, s7, v244
    v_xor_b32 v245, s7, v245
    v_xor_b32 v246, s7, v246
    v_xor_b32 v247, s7, v247
    v_or3_b32 v244, v244, v245, v246
    v_or_b32 v244, v244, v247
    v_cmp_ne_u32 vcc, 0, v244
    s_add_u32 s31, s31, 1
    s_cmp_ge_u32 s31, 40000
    s_cbranch_scc1 L_pdone_17
    s_cbranch_vccnz L_ploop_16
L_pdone_17:
L_pskip_15:
    s_waitcnt vmcnt(0)
    s_barrier
    s_cmp_lg_u32 s2, 0
    s_cbranch_scc1 L_ne_18
    s_cmp_lg_u32 s3, 0
    s_cbranch_scc1 L_ne_18
    v_mov_b32 v240, 0
    v_mov_b32 v241, s7
    s_mov_b32 s32, 0x194d800
    s_mov_b64 exec, 1
    buffer_store_dword v241, v240, s[8:11], s32 offen sc1
    s_mov_b64 exec, -1
L_ne_18:
    s_add_u32 s33, s46, 0x0
    s_add_u32 m0, s45, 8320
    s_nop 0
    buffer_load_dwordx4 v4, s[8:11], s33 offen sc1 lds
    s_add_u32 m0, s45, 9344
    s_add_u32 s33, s33, 1024
    buffer_load_dwordx4 v4, s[8:11], s33 offen sc1 lds
    s_add_u32 m0, s45, 10368
    s_add_u32 s33, s33, 1024
    buffer_load_dwordx4 v4, s[8:11], s33 offen sc1 lds
    s_add_u32 m0, s45, 11392
    s_add_u32 s33, s33, 1024
    buffer_load_dwordx4 v4, s[8:11], s33 offen sc1 lds
    v_lshlrev_b32 v190, 5, v2
    v_lshl_add_u32 v190, v3, 3, v190
    v_lshlrev_b32 v191, 6, v2
    v_lshl_add_u32 v191, v3, 4, v191
    s_add_u32 s49, s46, 0x280000
    v_lshlrev_b32 v238, 7, v1
    s_mul_i32 s50, s30, 4
    s_add_u32 s50, s50, s3
    s_mul_i32 s51, s50, 9363
    s_lshr_b32 s51, s51, 16
    s_mul_i32 s52, s51, 7
    s_sub_u32 s52, s50, s52
    s_mul_i32 s51, s51, 102400
    s_lshl_b32 s52, s52, 13
    s_min_u32 s52, s52, 43008
    s_add_u32 s51, s51, s52
    s_add_u32 s51, s51, 0x1414800
    s_mov_b32 s52, 0x7f000000
    s_cmp_lt_u32 s50, 56
    s_cselect_b32 s51, s51, s52
    v_add_u32 v240, 1, v2
    v_lshrrev_b32 v240, 1, v240
    v_lshl_add_u32 v240, v3, 2, v240
    v_lshlrev_b32 v240, 2, v240
    v_add_u32 v240, s45, v240
    v_and_b32 v241, 1, v2
    v_add_u32 v242, 4160, v240
    v_cmp_eq_u32 vcc, 0, v241
    s_nop 1
    v_cndmask_b32 v144, v240, v242, vcc
    v_add_u32 v145, 1024, v144
    v_add_u32 v146, 2048, v144
    v_add_u32 v147, 3072, v144
    v_lshlrev_b32 v240, 5, v2
    v_lshlrev_b32 v241, 4, v3
    v_sub_u32 v241, v241, v240
    s_add_u32 s33, s45, 8800
    v_add_u32 v148, s33, v241
    v_lshlrev_b32 v241, 3, v3
    v_add_u32 v241, v241, v240
    s_add_u32 s33, s45, 8824
    v_sub_u32 v149, s33, v241
    v_lshlrev_b32 v166, 4, v2
    v_lshl_add_u32 v166, v3, 2, v166
    v_add_u32 v166, s45, v166
    v_lshrrev_b32 v240, 2, v2
    v_mul_u32_u24 v240, 12992, v240
    v_lshl_add_u32 v240, v3, 5, v240
    v_and_b32 v241, 3, v1
    v_lshl_add_u32 v240, v241, 3, v240
    s_lshl_b32 s33, s3, 8
    s_add_u32 s33, s33, 102400
    v_add_u32 v192, s33, v240
    v_lshrrev_b32 v240, 3, v2
    v_lshl_add_u32 v240, v3, 1, v240
    v_mul_u32_u24 v240, 20480, v240
    v_and_b32 v241, 7, v2
    v_lshl_add_u32 v193, v241, 4, v240
    s_lshr_b32 s53, s44, 2
    s_lshl_b32 s53, s53, 7
    s_mul_i32 s32, s3, 327680
    s_add_u32 s53, s53, s32
    s_add_u32 s53, s53, 0x500000
    ds_read2_b32 a[0:1], v144 offset0:0 offset1:1
    ds_read2_b32 a[2:3], v144 offset0:2 offset1:3
    ds_read2_b32 a[4:5], v144 offset0:128 offset1:129
    ds_read2_b32 a[6:7], v144 offset0:130 offset1:131
    ds_read2_b32 a[8:9], v145 offset0:0 offset1:1
    ds_read2_b32 a[10:11], v145 offset0:2 offset1:3
    ds_read2_b32 a[12:13], v145 offset0:128 offset1:129
    ds_read2_b32 a[14:15], v145 offset0:130 offset1:131
    ds_read2_b32 a[16:17], v146 offset0:0 offset1:1
    ds_read2_b32 a[18:19], v146 offset0:2 offset1:3
    ds_read2_b32 a[20:21], v146 offset0:128 offset1:129
    ds_read2_b32 a[22:23], v146 offset0:130 offset1:131
    s_waitcnt lgkmcnt(6)
    ds_read2_b32 a[24:25], v147 offset0:0 offset1:1
    ds_read2_b32 a[26:27], v147 offset0:2 offset1:3
    ds_read2_b32 a[28:29], v147 offset0:128 offset1:129
    ds_read2_b32 a[30:31], v147 offset0:130 offset1:131
    s_waitcnt vmcnt(0)
    s_waitcnt lgkmcnt(6)
    ds_read_b128 a[32:35], v148 offset:3584
    ds_read_b128 a[36:39], v148 offset:3072
    ds_read_b128 a[40:43], v148 offset:2560
    ds_read_b128 a[44:47], v148 offset:2048
    ds_read_b128 a[48:51], v148 offset:1536
    ds_read_b128 a[52:55], v148 offset:1024
    ds_read_b128 a[56:59], v148 offset:512
    ds_read_b128 a[60:63], v148 offset:0
    s_waitcnt lgkmcnt(0)
    s_lshl_b32 s33, s29, 10
    s_add_u32 s32, s33, 0x194e000
    buffer_load_dwordx4 v[200:203], v4, s[8:11], s32 offen sc1
    v_mfma_f32_16x16x32_bf16 v[32:35], a[0:3], a[32:35], 0
    ds_read_b128 a[96:99], v148 offset:3648
    v_mfma_f32_16x16x32_bf16 v[36:39], a[0:3], a[36:39], 0
    ds_read2_b32 a[64:65], v144 offset0:16 offset1:17
    v_mfma_f32_16x16x32_bf16 v[40:43], a[0:3], a[40:43], 0
    ds_read2_b32 a[66:67], v144 offset0:18 offset1:19
    v_mfma_f32_16x16x32_bf16 v[44:47], a[0:3], a[44:47], 0
    ds_read_b128 a[100:103], v148 offset:3136
    v_mfma_f32_16x16x32_bf16 v[48:51], a[0:3], a[48:51], 0
    v_mfma_f32_16x16x32_bf16 v[52:55], a[0:3], a[52:55], 0
    ds_read2_b32 a[68:69], v144 offset0:144 offset1:145
    v_mfma_f32_16x16x32_bf16 v[56:59], a[0:3], a[56:59], 0
    ds_read2_b32 a[70:71], v144 offset0:146 offset1:147
    v_mfma_f32_16x16x32_bf16 v[60:63], a[0:3], a[60:63], 0
    ds_read_b128 a[104:107], v148 offset:2624
    v_mfma_f32_16x16x32_bf16 v[36:39], a[4:7], a[32:35], v[36:39]
    v_mfma_f32_16x16x32_bf16 v[40:43], a[4:7], a[36:39], v[40:43]
    ds_read2_b32 a[72:73], v145 offset0:16 offset1:17
    v_mfma_f32_16x16x32_bf16 v[44:47], a[4:7], a[40:43], v[44:47]
    ds_read2_b32 a[74:75], v145 offset0:18 offset1:19
    v_mfma_f32_16x16x32_bf16 v[48:51], a[4:7], a[44:47], v[48:51]
    ds_read_b128 a[108:111], v148 offset:2112
    v_mfma_f32_16x16x32_bf16 v[52:55], a[4:7], a[48:51], v[52:55]
    ds_read2_b32 a[76:77], v145 offset0:144 offset1:145
    v_mfma_f32_16x16x32_bf16 v[56:59], a[4:7], a[52:55], v[56:59]
    v_mfma_f32_16x16x32_bf16 v[60:63], a[4:7], a[56:59], v[60:63]
    ds_read2_b32 a[78:79], v145 offset0:146 offset1:147
    v_mfma_f32_16x16x32_bf16 v[40:43], a[8:11], a[32:35], v[40:43]
    ds_read_b128 a[112:115], v148 offset:1600
    v_mfma_f32_16x16x32_bf16 v[44:47], a[8:11], a[36:39], v[44:47]
    ds_read2_b32 a[80:81], v146 offset0:16 offset1:17
    v_mfma_f32_16x16x32_bf16 v[48:51], a[8:11], a[40:43], v[48:51]
    v_mfma_f32_16x16x32_bf16 v[52:55], a[8:11], a[44:47], v[52:55]
    ds_read2_b32 a[82:83], v146 offset0:18 offset1:19
    v_mfma_f32_16x16x32_bf16 v[56:59], a[8:11], a[48:51], v[56:59]
    ds_read_b128 a[116:119], v148 offset:1088
    v_mfma_f32_16x16x32_bf16 v[60:63], a[8:11], a[52:55], v[60:63]
    ds_read2_b32 a[84:85], v146 offset0:144 offset1:145
    v_mfma_f32_16x16x32_bf16 v[44:47], a[12:15], a[32:35], v[44:47]
    ds_read2_b32 a[86:87], v146 offset0:146 offset1:147
    v_mfma_f32_16x16x32_bf16 v[48:51], a[12:15], a[36:39], v[48:51]
    v_mfma_f32_16x16x32_bf16 v[52:55], a[12:15], a[40:43], v[52:55]
    ds_read_b128 a[120:123], v148 offset:576
    v_mfma_f32_16x16x32_bf16 v[56:59], a[12:15], a[44:47], v[56:59]
    ds_read2_b32 a[88:89], v147 offset0:16 offset1:17
    v_mfma_f32_16x16x32_bf16 v[60:63], a[12:15], a[48:51], v[60:63]
    ds_read2_b32 a[90:91], v147 offset0:18 offset1:19
    v_mfma_f32_16x16x32_bf16 v[48:51], a[16:19], a[32:35], v[48:51]
    v_mfma_f32_16x16x32_bf16 v[52:55], a[16:19], a[36:39], v[52:55]
    ds_read_b128 a[124:127], v148 offset:64
    v_mfma_f32_16x16x32_bf16 v[56:59], a[16:19], a[40:43], v[56:59]
    ds_read2_b32 a[92:93], v147 offset0:144 offset1:145
    v_mfma_f32_16x16x32_bf16 v[60:63], a[16:19], a[44:47], v[60:63]
    ds_read2_b32 a[94:95], v147 offset0:146 offset1:147
    v_mfma_f32_16x16x32_bf16 v[52:55], a[20:23], a[32:35], v[52:55]
    v_mfma_f32_16x16x32_bf16 v[56:59], a[20:23], a[36:39], v[56:59]
    v_mfma_f32_16x16x32_bf16 v[60:63], a[20:23], a[40:43], v[60:63]
    v_mfma_f32_16x16x32_bf16 v[56:59], a[24:27], a[32:35], v[56:59]
    v_mfma_f32_16x16x32_bf16 v[60:63], a[24:27], a[36:39], v[60:63]
    v_mfma_f32_16x16x32_bf16 v[60:63], a[28:31], a[32:35], v[60:63]
    s_waitcnt lgkmcnt(0)
    s_mov_b32 s31, 0
    s_waitcnt vmcnt(0)
L_fspin_20:
    v_xor_b32 v200, s7, v200
    v_xor_b32 v201, s7, v201
    v_xor_b32 v202, s7, v202
    v_xor_b32 v203, s7, v203
    v_or3_b32 v200, v200, v201, v202
    v_or_b32 v200, v200, v203
    v_cmp_ne_u32 vcc, 0, v200
    s_nop 4
    s_cbranch_vccz L_fok_19
    s_add_u32 s31, s31, 1
    s_cmp_ge_u32 s31, 40000
    s_cbranch_scc1 L_fok_19
    s_lshl_b32 s33, s29, 10
    s_add_u32 s32, s33, 0x194e000
    buffer_load_dwordx4 v[200:203], v4, s[8:11], s32 offen sc1
    s_waitcnt vmcnt(0)
    s_branch L_fspin_20
L_fok_19:
    v_mfma_f32_16x16x32_bf16 v[32:35], a[64:67], a[96:99], v[32:35]
    ds_read_b128 a[32:35], v148 offset:3712
    v_mfma_f32_16x16x32_bf16 v[36:39], a[64:67], a[100:103], v[36:39]
    ds_read2_b32 a[0:1], v144 offset0:32 offset1:33
    v_mfma_f32_16x16x32_bf16 v[40:43], a[64:67], a[104:107], v[40:43]
    ds_read2_b32 a[2:3], v144 offset0:34 offset1:35
    v_mfma_f32_16x16x32_bf16 v[44:47], a[64:67], a[108:111], v[44:47]
    ds_read_b128 a[36:39], v148 offset:3200
    v_mfma_f32_16x16x32_bf16 v[48:51], a[64:67], a[112:115], v[48:51]
    buffer_load_dwordx2 v[64:65], v190, s[8:11], s49 offen offset:0 sc1
    v_mfma_f32_16x16x32_bf16 v[52:55], a[64:67], a[116:119], v[52:55]
    ds_read2_b32 a[4:5], v144 offset0:160 offset1:161
    v_mfma_f32_16x16x32_bf16 v[56:59], a[64:67], a[120:123], v[56:59]
    ds_read2_b32 a[6:7], v144 offset0:162 offset1:163
    v_mfma_f32_16x16x32_bf16 v[60:63], a[64:67], a[124:127], v[60:63]
    ds_read_b128 a[40:43], v148 offset:2688
    v_mfma_f32_16x16x32_bf16 v[36:39], a[68:71], a[96:99], v[36:39]
    v_mfma_f32_16x16x32_bf16 v[40:43], a[68:71], a[100:103], v[40:43]
    ds_read2_b32 a[8:9], v145 offset0:32 offset1:33
    buffer_load_dwordx2 v[66:67], v190, s[8:11], s49 offen offset:512 sc1
    v_mfma_f32_16x16x32_bf16 v[44:47], a[68:71], a[104:107], v[44:47]
    ds_read2_b32 a[10:11], v145 offset0:34 offset1:35
    v_mfma_f32_16x16x32_bf16 v[48:51], a[68:71], a[108:111], v[48:51]
    ds_read_b128 a[44:47], v148 offset:2176
    v_mfma_f32_16x16x32_bf16 v[52:55], a[68:71], a[112:115], v[52:55]
    ds_read2_b32 a[12:13], v145 offset0:160 offset1:161
    v_mfma_f32_16x16x32_bf16 v[56:59], a[68:71], a[116:119], v[56:59]
    v_mfma_f32_16x16x32_bf16 v[60:63], a[68:71], a[120:123], v[60:63]
    ds_read2_b32 a[14:15], v145 offset0:162 offset1:163
    buffer_load_dwordx2 v[68:69], v190, s[8:11], s49 offen offset:1024 sc1
    v_mfma_f32_16x16x32_bf16 v[40:43], a[72:75], a[96:99], v[40:43]
    ds_read_b128 a[48:51], v148 offset:1664
    v_mfma_f32_16x16x32_bf16 v[44:47], a[72:75], a[100:103], v[44:47]
    ds_read2_b32 a[16:17], v146 offset0:32 offset1:33
    v_mfma_f32_16x16x32_bf16 v[48:51], a[72:75], a[104:107], v[48:51]
    v_mfma_f32_16x16x32_bf16 v[52:55], a[72:75], a[108:111], v[52:55]
    ds_read2_b32 a[18:19], v146 offset0:34 offset1:35
    v_mfma_f32_16x16x32_bf16 v[56:59], a[72:75], a[112:115], v[56:59]
    ds_read_b128 a[52:55], v148 offset:1152
    buffer_load_dwordx2 v[70:71], v190, s[8:11], s49 offen offset:1536 sc1
    v_mfma_f32_16x16x32_bf16 v[60:63], a[72:75], a[116:119], v[60:63]
    ds_read2_b32 a[20:21], v146 offset0:160 offset1:161
    v_mfma_f32_16x16x32_bf16 v[44:47], a[76:79], a[96:99], v[44:47]
    ds_read2_b32 a[22:23], v146 offset0:162 offset1:163
    v_mfma_f32_16x16x32_bf16 v[48:51], a[76:79], a[100:103], v[48:51]
    v_mfma_f32_16x16x32_bf16 v[52:55], a[76:79], a[104:107], v[52:55]
    ds_read_b128 a[56:59], v148 offset:640
    v_mfma_f32_16x16x32_bf16 v[56:59], a[76:79], a[108:111], v[56:59]
    ds_read2_b32 a[24:25], v147 offset0:32 offset1:33
    buffer_load_dwordx2 v[72:73], v190, s[8:11], s49 offen offset:2048 sc1
    v_mfma_f32_16x16x32_bf16 v[60:63], a[76:79], a[112:115], v[60:63]
    ds_read2_b32 a[26:27], v147 offset0:34 offset1:35
    v_mfma_f32_16x16x32_bf16 v[48:51], a[80:83], a[96:99], v[48:51]
    v_mfma_f32_16x16x32_bf16 v[52:55], a[80:83], a[100:103], v[52:55]
    ds_read_b128 a[60:63], v148 offset:128
    v_mfma_f32_16x16x32_bf16 v[56:59], a[80:83], a[104:107], v[56:59]
    ds_read2_b32 a[28:29], v147 offset0:160 offset1:161
    v_mfma_f32_16x16x32_bf16 v[60:63], a[80:83], a[108:111], v[60:63]
    ds_read2_b32 a[30:31], v147 offset0:162 offset1:163
    buffer_load_dwordx2 v[74:75], v190, s[8:11], s49 offen offset:2560 sc1
    v_mfma_f32_16x16x32_bf16 v[52:55], a[84:87], a[96:99], v[52:55]
    v_mfma_f32_16x16x32_bf16 v[56:59], a[84:87], a[100:103], v[56:59]
    v_mfma_f32_16x16x32_bf16 v[60:63], a[84:87], a[104:107], v[60:63]
    v_mfma_f32_16x16x32_bf16 v[56:59], a[88:91], a[96:99], v[56:59]
    v_mfma_f32_16x16x32_bf16 v[60:63], a[88:91], a[100:103], v[60:63]
    buffer_load_dwordx2 v[76:77], v190, s[8:11], s49 offen offset:3072 sc1
    v_mfma_f32_16x16x32_bf16 v[60:63], a[92:95], a[96:99], v[60:63]
    s_waitcnt lgkmcnt(0)
    v_mfma_f32_16x16x32_bf16 v[32:35], a[0:3], a[32:35], v[32:35]
    ds_read_b128 a[96:99], v148 offset:3776
    v_mfma_f32_16x16x32_bf16 v[36:39], a[0:3], a[36:39], v[36:39]
    ds_read2_b32 a[64:65], v144 offset0:48 offset1:49
    v_mfma_f32_16x16x32_bf16 v[40:43], a[0:3], a[40:43], v[40:43]
    ds_read2_b32 a[66:67], v144 offset0:50 offset1:51
    v_mfma_f32_16x16x32_bf16 v[44:47], a[0:3], a[44:47], v[44:47]
    ds_read_b128 a[100:103], v148 offset:3264
    v_mfma_f32_16x16x32_bf16 v[48:51], a[0:3], a[48:51], v[48:51]
    buffer_load_dwordx2 v[78:79], v190, s[8:11], s49 offen offset:3584 sc1
    v_mfma_f32_16x16x32_bf16 v[52:55], a[0:3], a[52:55], v[52:55]
    ds_read2_b32 a[68:69], v144 offset0:176 offset1:177
    v_mfma_f32_16x16x32_bf16 v[56:59], a[0:3], a[56:59], v[56:59]
    ds_read2_b32 a[70:71], v144 offset0:178 offset1:179
    v_mfma_f32_16x16x32_bf16 v[60:63], a[0:3], a[60:63], v[60:63]
    ds_read_b128 a[104:107], v148 offset:2752
    v_mfma_f32_16x16x32_bf16 v[36:39], a[4:7], a[32:35], v[36:39]
    v_mfma_f32_16x16x32_bf16 v[40:43], a[4:7], a[36:39], v[40:43]
    ds_read2_b32 a[72:73], v145 offset0:48 offset1:49
    s_mov_b32 s63, 0x1920000
    buffer_load_dwordx4 v[80:83], v191, s[8:11], s63 offen offset:0 sc1
    v_mfma_f32_16x16x32_bf16 v[44:47], a[4:7], a[40:43], v[44:47]
    ds_read2_b32 a[74:75], v145 offset0:50 offset1:51
    v_mfma_f32_16x16x32_bf16 v[48:51], a[4:7], a[44:47], v[48:51]
    ds_read_b128 a[108:111], v148 offset:2240
    v_mfma_f32_16x16x32_bf16 v[52:55], a[4:7], a[48:51], v[52:55]
    ds_read2_b32 a[76:77], v145 offset0:176 offset1:177
    v_mfma_f32_16x16x32_bf16 v[56:59], a[4:7], a[52:55], v[56:59]
    v_mfma_f32_16x16x32_bf16 v[60:63], a[4:7], a[56:59], v[60:63]
    ds_read2_b32 a[78:79], v145 offset0:178 offset1:179
    s_mov_b32 s63, 0x1920000
    buffer_load_dwordx4 v[84:87], v191, s[8:11], s63 offen offset:1024 sc1
    v_mfma_f32_16x16x32_bf16 v[40:43], a[8:11], a[32:35], v[40:43]
    ds_read_b128 a[112:115], v148 offset:1728
    v_mfma_f32_16x16x32_bf16 v[44:47], a[8:11], a[36:39], v[44:47]
    ds_read2_b32 a[80:81], v146 offset0:48 offset1:49
    v_mfma_f32_16x16x32_bf16 v[48:51], a[8:11], a[40:43], v[48:51]
    v_mfma_f32_16x16x32_bf16 v[52:55], a[8:11], a[44:47], v[52:55]
    ds_read2_b32 a[82:83], v146 offset0:50 offset1:51
    v_mfma_f32_16x16x32_bf16 v[56:59], a[8:11], a[48:51], v[56:59]
    ds_read_b128 a[116:119], v148 offset:1216
    s_mov_b32 s63, 0x1920000
    buffer_load_dwordx4 v[88:91], v191, s[8:11], s63 offen offset:2048 sc1
    v_mfma_f32_16x16x32_bf16 v[60:63], a[8:11], a[52:55], v[60:63]
    ds_read2_b32 a[84:85], v146 offset0:176 offset1:177
    v_mfma_f32_16x16x32_bf16 v[44:47], a[12:15], a[32:35], v[44:47]
    ds_read2_b32 a[86:87], v146 offset0:178 offset1:179
    v_mfma_f32_16x16x32_bf16 v[48:51], a[12:15], a[36:39], v[48:51]
    v_mfma_f32_16x16x32_bf16 v[52:55], a[12:15], a[40:43], v[52:55]
    ds_read_b128 a[120:123], v148 offset:704
    v_mfma_f32_16x16x32_bf16 v[56:59], a[12:15], a[44:47], v[56:59]
    ds_read2_b32 a[88:89], v147 offset0:48 offset1:49
    s_mov_b32 s63, 0x1920000
    buffer_load_dwordx4 v[92:95], v191, s[8:11], s63 offen offset:3072 sc1
    v_mfma_f32_16x16x32_bf16 v[60:63], a[12:15], a[48:51], v[60:63]
    ds_read2_b32 a[90:91], v147 offset0:50 offset1:51
    v_mfma_f32_16x16x32_bf16 v[48:51], a[16:19], a[32:35], v[48:51]
    v_mfma_f32_16x16x32_bf16 v[52:55], a[16:19], a[36:39], v[52:55]
    ds_read_b128 a[124:127], v148 offset:192
    v_mfma_f32_16x16x32_bf16 v[56:59], a[16:19], a[40:43], v[56:59]
    ds_read2_b32 a[92:93], v147 offset0:176 offset1:177
    v_mfma_f32_16x16x32_bf16 v[60:63], a[16:19], a[44:47], v[60:63]
    ds_read2_b32 a[94:95], v147 offset0:178 offset1:179
    s_mov_b32 s63, 0x1921000
    buffer_load_dwordx4 v[96:99], v191, s[8:11], s63 offen offset:0 sc1
    v_mfma_f32_16x16x32_bf16 v[52:55], a[20:23], a[32:35], v[52:55]
    v_mfma_f32_16x16x32_bf16 v[56:59], a[20:23], a[36:39], v[56:59]
    v_mfma_f32_16x16x32_bf16 v[60:63], a[20:23], a[40:43], v[60:63]
    v_mfma_f32_16x16x32_bf16 v[56:59], a[24:27], a[32:35], v[56:59]
    v_mfma_f32_16x16x32_bf16 v[60:63], a[24:27], a[36:39], v[60:63]
    s_mov_b32 s63, 0x1921000
    buffer_load_dwordx4 v[100:103], v191, s[8:11], s63 offen offset:1024 sc1
    v_mfma_f32_16x16x32_bf16 v[60:63], a[28:31], a[32:35], v[60:63]
    s_waitcnt lgkmcnt(0)
    v_mfma_f32_16x16x32_bf16 v[32:35], a[64:67], a[96:99], v[32:35]
    ds_read_b128 a[32:35], v148 offset:3840
    v_mfma_f32_16x16x32_bf16 v[36:39], a[64:67], a[100:103], v[36:39]
    ds_read2_b32 a[0:1], v144 offset0:64 offset1:65
    v_mfma_f32_16x16x32_bf16 v[40:43], a[64:67], a[104:107], v[40:43]
    ds_read2_b32 a[2:3], v144 offset0:66 offset1:67
    v_mfma_f32_16x16x32_bf16 v[44:47], a[64:67], a[108:111], v[44:47]
    ds_read_b128 a[36:39], v148 offset:3328
    v_mfma_f32_16x16x32_bf16 v[48:51], a[64:67], a[112:115], v[48:51]
    s_mov_b32 s63, 0x1921000
    buffer_load_dwordx4 v[104:107], v191, s[8:11], s63 offen offset:2048 sc1
    v_mfma_f32_16x16x32_bf16 v[52:55], a[64:67], a[116:119], v[52:55]
    ds_read2_b32 a[4:5], v144 offset0:192 offset1:193
    v_mfma_f32_16x16x32_bf16 v[56:59], a[64:67], a[120:123], v[56:59]
    ds_read2_b32 a[6:7], v144 offset0:194 offset1:195
    v_mfma_f32_16x16x32_bf16 v[60:63], a[64:67], a[124:127], v[60:63]
    ds_read_b128 a[40:43], v148 offset:2816
    v_mfma_f32_16x16x32_bf16 v[36:39], a[68:71], a[96:99], v[36:39]
    v_mfma_f32_16x16x32_bf16 v[40:43], a[68:71], a[100:103], v[40:43]
    ds_read2_b32 a[8:9], v145 offset0:64 offset1:65
    s_mov_b32 s63, 0x1921000
    buffer_load_dwordx4 v[108:111], v191, s[8:11], s63 offen offset:3072 sc1
    v_mfma_f32_16x16x32_bf16 v[44:47], a[68:71], a[104:107], v[44:47]
    ds_read2_b32 a[10:11], v145 offset0:66 offset1:67
    v_mfma_f32_16x16x32_bf16 v[48:51], a[68:71], a[108:111], v[48:51]
    ds_read_b128 a[44:47], v148 offset:2304
    v_mfma_f32_16x16x32_bf16 v[52:55], a[68:71], a[112:115], v[52:55]
    ds_read2_b32 a[12:13], v145 offset0:192 offset1:193
    v_mfma_f32_16x16x32_bf16 v[56:59], a[68:71], a[116:119], v[56:59]
    v_mfma_f32_16x16x32_bf16 v[60:63], a[68:71], a[120:123], v[60:63]
    ds_read2_b32 a[14:15], v145 offset0:194 offset1:195
    s_mov_b32 s63, 0x1922000
    buffer_load_dwordx4 v[112:115], v191, s[8:11], s63 offen offset:0 sc1
    v_mfma_f32_16x16x32_bf16 v[40:43], a[72:75], a[96:99], v[40:43]
    ds_read_b128 a[48:51], v148 offset:1792
    v_mfma_f32_16x16x32_bf16 v[44:47], a[72:75], a[100:103], v[44:47]
    ds_read2_b32 a[16:17], v146 offset0:64 offset1:65
    v_mfma_f32_16x16x32_bf16 v[48:51], a[72:75], a[104:107], v[48:51]
    v_mfma_f32_16x16x32_bf16 v[52:55], a[72:75], a[108:111], v[52:55]
    ds_read2_b32 a[18:19], v146 offset0:66 offset1:67
    v_mfma_f32_16x16x32_bf16 v[56:59], a[72:75], a[112:115], v[56:59]
    ds_read_b128 a[52:55], v148 offset:1280
    s_mov_b32 s63, 0x1922000
    buffer_load_dwordx4 v[116:119], v191, s[8:11], s63 offen offset:1024 sc1
    v_mfma_f32_16x16x32_bf16 v[60:63], a[72:75], a[116:119], v[60:63]
    ds_read2_b32 a[20:21], v146 offset0:192 offset1:193
    v_mfma_f32_16x16x32_bf16 v[44:47], a[76:79], a[96:99], v[44:47]
    ds_read2_b32 a[22:23], v146 offset0:194 offset1:195
    v_mfma_f32_16x16x32_bf16 v[48:51], a[76:79], a[100:103], v[48:51]
    v_mfma_f32_16x16x32_bf16 v[52:55], a[76:79], a[104:107], v[52:55]
    ds_read_b128 a[56:59], v148 offset:768
    v_mfma_f32_16x16x32_bf16 v[56:59], a[76:79], a[108:111], v[56:59]
    ds_read2_b32 a[24:25], v147 offset0:64 offset1:65
    s_mov_b32 s63, 0x1922000
    buffer_load_dwordx4 v[120:123], v191, s[8:11], s63 offen offset:2048 sc1
    v_mfma_f32_16x16x32_bf16 v[60:63], a[76:79], a[112:115], v[60:63]
    ds_read2_b32 a[26:27], v147 offset0:66 offset1:67
    v_mfma_f32_16x16x32_bf16 v[48:51], a[80:83], a[96:99], v[48:51]
    v_mfma_f32_16x16x32_bf16 v[52:55], a[80:83], a[100:103], v[52:55]
    ds_read_b128 a[60:63], v148 offset:256
    v_mfma_f32_16x16x32_bf16 v[56:59], a[80:83], a[104:107], v[56:59]
    ds_read2_b32 a[28:29], v147 offset0:192 offset1:193
    v_mfma_f32_16x16x32_bf16 v[60:63], a[80:83], a[108:111], v[60:63]
    ds_read2_b32 a[30:31], v147 offset0:194 offset1:195
    s_mov_b32 s63, 0x1922000
    buffer_load_dwordx4 v[124:127], v191, s[8:11], s63 offen offset:3072 sc1
    v_mfma_f32_16x16x32_bf16 v[52:55], a[84:87], a[96:99], v[52:55]
    v_mfma_f32_16x16x32_bf16 v[56:59], a[84:87], a[100:103], v[56:59]
    v_mfma_f32_16x16x32_bf16 v[60:63], a[84:87], a[104:107], v[60:63]
    v_mfma_f32_16x16x32_bf16 v[56:59], a[88:91], a[96:99], v[56:59]
    v_mfma_f32_16x16x32_bf16 v[60:63], a[88:91], a[100:103], v[60:63]
    s_mov_b32 s63, 0x1923000
    buffer_load_dwordx4 v[128:131], v191, s[8:11], s63 offen offset:0 sc1
    v_mfma_f32_16x16x32_bf16 v[60:63], a[92:95], a[96:99], v[60:63]
    s_waitcnt lgkmcnt(0)
    v_mfma_f32_16x16x32_bf16 v[32:35], a[0:3], a[32:35], v[32:35]
    ds_read_b128 a[96:99], v148 offset:3904
    v_mfma_f32_16x16x32_bf16 v[36:39], a[0:3], a[36:39], v[36:39]
    ds_read2_b32 a[64:65], v144 offset0:80 offset1:81
    v_mfma_f32_16x16x32_bf16 v[40:43], a[0:3], a[40:43], v[40:43]
    ds_read2_b32 a[66:67], v144 offset0:82 offset1:83
    v_mfma_f32_16x16x32_bf16 v[44:47], a[0:3], a[44:47], v[44:47]
    ds_read_b128 a[100:103], v148 offset:3392
    v_mfma_f32_16x16x32_bf16 v[48:51], a[0:3], a[48:51], v[48:51]
    s_mov_b32 s63, 0x1923000
    buffer_load_dwordx4 v[132:135], v191, s[8:11], s63 offen offset:1024 sc1
    v_mfma_f32_16x16x32_bf16 v[52:55], a[0:3], a[52:55], v[52:55]
    ds_read2_b32 a[68:69], v144 offset0:208 offset1:209
    v_mfma_f32_16x16x32_bf16 v[56:59], a[0:3], a[56:59], v[56:59]
    ds_read2_b32 a[70:71], v144 offset0:210 offset1:211
    v_mfma_f32_16x16x32_bf16 v[60:63], a[0:3], a[60:63], v[60:63]
    ds_read_b128 a[104:107], v148 offset:2880
    v_mfma_f32_16x16x32_bf16 v[36:39], a[4:7], a[32:35], v[36:39]
    v_mfma_f32_16x16x32_bf16 v[40:43], a[4:7], a[36:39], v[40:43]
    ds_read2_b32 a[72:73], v145 offset0:80 offset1:81
    s_mov_b32 s63, 0x1923000
    buffer_load_dwordx4 v[136:139], v191, s[8:11], s63 offen offset:2048 sc1
    v_mfma_f32_16x16x32_bf16 v[44:47], a[4:7], a[40:43], v[44:47]
    ds_read2_b32 a[74:75], v145 offset0:82 offset1:83
    v_mfma_f32_16x16x32_bf16 v[48:51], a[4:7], a[44:47], v[48:51]
    ds_read_b128 a[108:111], v148 offset:2368
    v_mfma_f32_16x16x32_bf16 v[52:55], a[4:7], a[48:51], v[52:55]
    ds_read2_b32 a[76:77], v145 offset0:208 offset1:209
    v_mfma_f32_16x16x32_bf16 v[56:59], a[4:7], a[52:55], v[56:59]
    v_mfma_f32_16x16x32_bf16 v[60:63], a[4:7], a[56:59], v[60:63]
    ds_read2_b32 a[78:79], v145 offset0:210 offset1:211
    s_mov_b32 s63, 0x1923000
    buffer_load_dwordx4 v[140:143], v191, s[8:11], s63 offen offset:3072 sc1
    v_mfma_f32_16x16x32_bf16 v[40:43], a[8:11], a[32:35], v[40:43]
    ds_read_b128 a[112:115], v148 offset:1856
    v_mfma_f32_16x16x32_bf16 v[44:47], a[8:11], a[36:39], v[44:47]
    ds_read2_b32 a[80:81], v146 offset0:80 offset1:81
    v_mfma_f32_16x16x32_bf16 v[48:51], a[8:11], a[40:43], v[48:51]
    v_mfma_f32_16x16x32_bf16 v[52:55], a[8:11], a[44:47], v[52:55]
    ds_read2_b32 a[82:83], v146 offset0:82 offset1:83
    v_mfma_f32_16x16x32_bf16 v[56:59], a[8:11], a[48:51], v[56:59]
    ds_read_b128 a[116:119], v148 offset:1344
    s_add_u32 m0, s28, 0
    s_add_u32 s63, s76, 0
    buffer_load_dwordx4 v4, s[8:11], s63 offen sc1 lds
    v_mfma_f32_16x16x32_bf16 v[60:63], a[8:11], a[52:55], v[60:63]
    ds_read2_b32 a[84:85], v146 offset0:208 offset1:209
    v_mfma_f32_16x16x32_bf16 v[44:47], a[12:15], a[32:35], v[44:47]
    ds_read2_b32 a[86:87], v146 offset0:210 offset1:211
    v_mfma_f32_16x16x32_bf16 v[48:51], a[12:15], a[36:39], v[48:51]
    v_mfma_f32_16x16x32_bf16 v[52:55], a[12:15], a[40:43], v[52:55]
    ds_read_b128 a[120:123], v148 offset:832
    v_mfma_f32_16x16x32_bf16 v[56:59], a[12:15], a[44:47], v[56:59]
    ds_read2_b32 a[88:89], v147 offset0:80 offset1:81
    s_add_u32 m0, s28, 4096
    s_add_u32 s63, s76, 4096
    buffer_load_dwordx4 v4, s[8:11], s63 offen sc1 lds
    v_mfma_f32_16x16x32_bf16 v[60:63], a[12:15], a[48:51], v[60:63]
    ds_read2_b32 a[90:91], v147 offset0:82 offset1:83
    v_mfma_f32_16x16x32_bf16 v[48:51], a[16:19], a[32:35], v[48:51]
    v_mfma_f32_16x16x32_bf16 v[52:55], a[16:19], a[36:39], v[52:55]
    ds_read_b128 a[124:127], v148 offset:320
    v_mfma_f32_16x16x32_bf16 v[56:59], a[16:19], a[40:43], v[56:59]
    ds_read2_b32 a[92:93], v147 offset0:208 offset1:209
    v_mfma_f32_16x16x32_bf16 v[60:63], a[16:19], a[44:47], v[60:63]
    ds_read2_b32 a[94:95], v147 offset0:210 offset1:211
    s_add_u32 m0, s28, 8192
    s_add_u32 s63, s76, 8192
    buffer_load_dwordx4 v4, s[8:11], s63 offen sc1 lds
    v_mfma_f32_16x16x32_bf16 v[52:55], a[20:23], a[32:35], v[52:55]
    v_mfma_f32_16x16x32_bf16 v[56:59], a[20:23], a[36:39], v[56:59]
    v_mfma_f32_16x16x32_bf16 v[60:63], a[20:23], a[40:43], v[60:63]
    v_mfma_f32_16x16x32_bf16 v[56:59], a[24:27], a[32:35], v[56:59]
    v_mfma_f32_16x16x32_bf16 v[60:63], a[24:27], a[36:39], v[60:63]
    s_add_u32 m0, s28, 12288
    s_add_u32 s63, s76, 12288
    buffer_load_dwordx4 v4, s[8:11], s63 offen sc1 lds
    v_mfma_f32_16x16x32_bf16 v[60:63], a[28:31], a[32:35], v[60:63]
    s_waitcnt lgkmcnt(0)
    v_mfma_f32_16x16x32_bf16 v[32:35], a[64:67], a[96:99], v[32:35]
    ds_read_b128 a[32:35], v148 offset:3968
    v_mfma_f32_16x16x32_bf16 v[36:39], a[64:67], a[100:103], v[36:39]
    ds_read2_b32 a[0:1], v144 offset0:96 offset1:97
    v_mfma_f32_16x16x32_bf16 v[40:43], a[64:67], a[104:107], v[40:43]
    ds_read2_b32 a[2:3], v144 offset0:98 offset1:99
    v_mfma_f32_16x16x32_bf16 v[44:47], a[64:67], a[108:111], v[44:47]
    ds_read_b128 a[36:39], v148 offset:3456
    v_mfma_f32_16x16x32_bf16 v[48:51], a[64:67], a[112:115], v[48:51]
    s_add_u32 m0, s28, 16384
    s_add_u32 s63, s76, 16384
    buffer_load_dwordx4 v4, s[8:11], s63 offen sc1 lds
    v_mfma_f32_16x16x32_bf16 v[52:55], a[64:67], a[116:119], v[52:55]
    ds_read2_b32 a[4:5], v144 offset0:224 offset1:225
    v_mfma_f32_16x16x32_bf16 v[56:59], a[64:67], a[120:123], v[56:59]
    ds_read2_b32 a[6:7], v144 offset0:226 offset1:227
    v_mfma_f32_16x16x32_bf16 v[60:63], a[64:67], a[124:127], v[60:63]
    ds_read_b128 a[40:43], v148 offset:2944
    v_mfma_f32_16x16x32_bf16 v[36:39], a[68:71], a[96:99], v[36:39]
    v_mfma_f32_16x16x32_bf16 v[40:43], a[68:71], a[100:103], v[40:43]
    ds_read2_b32 a[8:9], v145 offset0:96 offset1:97
    s_add_u32 m0, s28, 20480
    s_add_u32 s63, s76, 20480
    buffer_load_dwordx4 v4, s[8:11], s63 offen sc1 lds
    v_mfma_f32_16x16x32_bf16 v[44:47], a[68:71], a[104:107], v[44:47]
    ds_read2_b32 a[10:11], v145 offset0:98 offset1:99
    v_mfma_f32_16x16x32_bf16 v[48:51], a[68:71], a[108:111], v[48:51]
    ds_read_b128 a[44:47], v148 offset:2432
    v_mfma_f32_16x16x32_bf16 v[52:55], a[68:71], a[112:115], v[52:55]
    ds_read2_b32 a[12:13], v145 offset0:224 offset1:225
    v_mfma_f32_16x16x32_bf16 v[56:59], a[68:71], a[116:119], v[56:59]
    v_mfma_f32_16x16x32_bf16 v[60:63], a[68:71], a[120:123], v[60:63]
    ds_read2_b32 a[14:15], v145 offset0:226 offset1:227
    s_add_u32 m0, s28, 24576
    s_add_u32 s63, s76, 24576
    buffer_load_dwordx4 v4, s[8:11], s63 offen sc1 lds
    v_mfma_f32_16x16x32_bf16 v[40:43], a[72:75], a[96:99], v[40:43]
    ds_read_b128 a[48:51], v148 offset:1920
    v_mfma_f32_16x16x32_bf16 v[44:47], a[72:75], a[100:103], v[44:47]
    ds_read2_b32 a[16:17], v146 offset0:96 offset1:97
    v_mfma_f32_16x16x32_bf16 v[48:51], a[72:75], a[104:107], v[48:51]
    v_mfma_f32_16x16x32_bf16 v[52:55], a[72:75], a[108:111], v[52:55]
    ds_read2_b32 a[18:19], v146 offset0:98 offset1:99
    v_mfma_f32_16x16x32_bf16 v[56:59], a[72:75], a[112:115], v[56:59]
    ds_read_b128 a[52:55], v148 offset:1408
    s_add_u32 m0, s28, 28672
    s_add_u32 s63, s76, 28672
    buffer_load_dwordx4 v4, s[8:11], s63 offen sc1 lds
    v_mfma_f32_16x16x32_bf16 v[60:63], a[72:75], a[116:119], v[60:63]
    ds_read2_b32 a[20:21], v146 offset0:224 offset1:225
    v_mfma_f32_16x16x32_bf16 v[44:47], a[76:79], a[96:99], v[44:47]
    ds_read2_b32 a[22:23], v146 offset0:226 offset1:227
    v_mfma_f32_16x16x32_bf16 v[48:51], a[76:79], a[100:103], v[48:51]
    v_mfma_f32_16x16x32_bf16 v[52:55], a[76:79], a[104:107], v[52:55]
    ds_read_b128 a[56:59], v148 offset:896
    v_mfma_f32_16x16x32_bf16 v[56:59], a[76:79], a[108:111], v[56:59]
    ds_read2_b32 a[24:25], v147 offset0:96 offset1:97
    s_add_u32 m0, s28, 32768
    s_add_u32 s63, s76, 32768
    buffer_load_dwordx4 v4, s[8:11], s63 offen sc1 lds
    v_mfma_f32_16x16x32_bf16 v[60:63], a[76:79], a[112:115], v[60:63]
    ds_read2_b32 a[26:27], v147 offset0:98 offset1:99
    v_mfma_f32_16x16x32_bf16 v[48:51], a[80:83], a[96:99], v[48:51]
    v_mfma_f32_16x16x32_bf16 v[52:55], a[80:83], a[100:103], v[52:55]
    ds_read_b128 a[60:63], v148 offset:384
    v_mfma_f32_16x16x32_bf16 v[56:59], a[80:83], a[104:107], v[56:59]
    ds_read2_b32 a[28:29], v147 offset0:224 offset1:225
    v_mfma_f32_16x16x32_bf16 v[60:63], a[80:83], a[108:111], v[60:63]
    ds_read2_b32 a[30:31], v147 offset0:226 offset1:227
    s_add_u32 m0, s28, 36864
    s_add_u32 s63, s76, 36864
    buffer_load_dwordx4 v4, s[8:11], s63 offen sc1 lds
    v_mfma_f32_16x16x32_bf16 v[52:55], a[84:87], a[96:99], v[52:55]
    v_mfma_f32_16x16x32_bf16 v[56:59], a[84:87], a[100:103], v[56:59]
    v_mfma_f32_16x16x32_bf16 v[60:63], a[84:87], a[104:107], v[60:63]
    v_mfma_f32_16x16x32_bf16 v[56:59], a[88:91], a[96:99], v[56:59]
    v_mfma_f32_16x16x32_bf16 v[60:63], a[88:91], a[100:103], v[60:63]
    s_add_u32 m0, s28, 40960
    s_add_u32 s63, s76, 40960
    buffer_load_dwordx4 v4, s[8:11], s63 offen sc1 lds
    v_mfma_f32_16x16x32_bf16 v[60:63], a[92:95], a[96:99], v[60:63]
    s_waitcnt lgkmcnt(0)
    v_mfma_f32_16x16x32_bf16 v[32:35], a[0:3], a[32:35], v[32:35]
    ds_read_b128 a[96:99], v148 offset:4032
    v_mfma_f32_16x16x32_bf16 v[36:39], a[0:3], a[36:39], v[36:39]
    ds_read2_b32 a[64:65], v144 offset0:112 offset1:113
    v_mfma_f32_16x16x32_bf16 v[40:43], a[0:3], a[40:43], v[40:43]
    ds_read2_b32 a[66:67], v144 offset0:114 offset1:115
    v_mfma_f32_16x16x32_bf16 v[44:47], a[0:3], a[44:47], v[44:47]
    ds_read_b128 a[100:103], v148 offset:3520
    v_mfma_f32_16x16x32_bf16 v[48:51], a[0:3], a[48:51], v[48:51]
    s_add_u32 m0, s28, 45056
    s_add_u32 s63, s76, 45056
    buffer_load_dwordx4 v4, s[8:11], s63 offen sc1 lds
    v_mfma_f32_16x16x32_bf16 v[52:55], a[0:3], a[52:55], v[52:55]
    ds_read2_b32 a[68:69], v144 offset0:240 offset1:241
    v_mfma_f32_16x16x32_bf16 v[56:59], a[0:3], a[56:59], v[56:59]
    ds_read2_b32 a[70:71], v144 offset0:242 offset1:243
    v_mfma_f32_16x16x32_bf16 v[60:63], a[0:3], a[60:63], v[60:63]
    ds_read_b128 a[104:107], v148 offset:3008
    v_mfma_f32_16x16x32_bf16 v[36:39], a[4:7], a[32:35], v[36:39]
    v_mfma_f32_16x16x32_bf16 v[40:43], a[4:7], a[36:39], v[40:43]
    ds_read2_b32 a[72:73], v145 offset0:112 offset1:113
    s_add_u32 m0, s28, 49152
    s_add_u32 s63, s76, 49152
    buffer_load_dwordx4 v4, s[8:11], s63 offen sc1 lds
    v_mfma_f32_16x16x32_bf16 v[44:47], a[4:7], a[40:43], v[44:47]
    ds_read2_b32 a[74:75], v145 offset0:114 offset1:115
    v_mfma_f32_16x16x32_bf16 v[48:51], a[4:7], a[44:47], v[48:51]
    ds_read_b128 a[108:111], v148 offset:2496
    v_mfma_f32_16x16x32_bf16 v[52:55], a[4:7], a[48:51], v[52:55]
    ds_read2_b32 a[76:77], v145 offset0:240 offset1:241
    v_mfma_f32_16x16x32_bf16 v[56:59], a[4:7], a[52:55], v[56:59]
    v_mfma_f32_16x16x32_bf16 v[60:63], a[4:7], a[56:59], v[60:63]
    ds_read2_b32 a[78:79], v145 offset0:242 offset1:243
    s_add_u32 m0, s28, 53248
    s_add_u32 s63, s76, 53248
    buffer_load_dwordx4 v4, s[8:11], s63 offen sc1 lds
    v_mfma_f32_16x16x32_bf16 v[40:43], a[8:11], a[32:35], v[40:43]
    ds_read_b128 a[112:115], v148 offset:1984
    v_mfma_f32_16x16x32_bf16 v[44:47], a[8:11], a[36:39], v[44:47]
    ds_read2_b32 a[80:81], v146 offset0:112 offset1:113
    v_mfma_f32_16x16x32_bf16 v[48:51], a[8:11], a[40:43], v[48:51]
    v_mfma_f32_16x16x32_bf16 v[52:55], a[8:11], a[44:47], v[52:55]
    ds_read2_b32 a[82:83], v146 offset0:114 offset1:115
    v_mfma_f32_16x16x32_bf16 v[56:59], a[8:11], a[48:51], v[56:59]
    ds_read_b128 a[116:119], v148 offset:1472
    s_add_u32 m0, s28, 57344
    s_add_u32 s63, s76, 57344
    buffer_load_dwordx4 v4, s[8:11], s63 offen sc1 lds
    v_mfma_f32_16x16x32_bf16 v[60:63], a[8:11], a[52:55], v[60:63]
    ds_read2_b32 a[84:85], v146 offset0:240 offset1:241
    v_mfma_f32_16x16x32_bf16 v[44:47], a[12:15], a[32:35], v[44:47]
    ds_read2_b32 a[86:87], v146 offset0:242 offset1:243
    v_mfma_f32_16x16x32_bf16 v[48:51], a[12:15], a[36:39], v[48:51]
    v_mfma_f32_16x16x32_bf16 v[52:55], a[12:15], a[40:43], v[52:55]
    ds_read_b128 a[120:123], v148 offset:960
    v_mfma_f32_16x16x32_bf16 v[56:59], a[12:15], a[44:47], v[56:59]
    ds_read2_b32 a[88:89], v147 offset0:112 offset1:113
    s_add_u32 m0, s28, 61440
    s_add_u32 s63, s76, 61440
    buffer_load_dwordx4 v4, s[8:11], s63 offen sc1 lds
    v_mfma_f32_16x16x32_bf16 v[60:63], a[12:15], a[48:51], v[60:63]
    ds_read2_b32 a[90:91], v147 offset0:114 offset1:115
    v_mfma_f32_16x16x32_bf16 v[48:51], a[16:19], a[32:35], v[48:51]
    v_mfma_f32_16x16x32_bf16 v[52:55], a[16:19], a[36:39], v[52:55]
    ds_read_b128 a[124:127], v148 offset:448
    v_mfma_f32_16x16x32_bf16 v[56:59], a[16:19], a[40:43], v[56:59]
    ds_read2_b32 a[92:93], v147 offset0:240 offset1:241
    v_mfma_f32_16x16x32_bf16 v[60:63], a[16:19], a[44:47], v[60:63]
    ds_read2_b32 a[94:95], v147 offset0:242 offset1:243
    s_add_u32 m0, s28, 65536
    s_add_u32 s63, s76, 65536
    buffer_load_dwordx4 v4, s[8:11], s63 offen sc1 lds
    v_mfma_f32_16x16x32_bf16 v[52:55], a[20:23], a[32:35], v[52:55]
    v_mfma_f32_16x16x32_bf16 v[56:59], a[20:23], a[36:39], v[56:59]
    v_mfma_f32_16x16x32_bf16 v[60:63], a[20:23], a[40:43], v[60:63]
    v_mfma_f32_16x16x32_bf16 v[56:59], a[24:27], a[32:35], v[56:59]
    v_mfma_f32_16x16x32_bf16 v[60:63], a[24:27], a[36:39], v[60:63]
    s_add_u32 m0, s28, 69632
    s_add_u32 s63, s76, 69632
    buffer_load_dwordx4 v4, s[8:11], s63 offen sc1 lds
    v_mfma_f32_16x16x32_bf16 v[60:63], a[28:31], a[32:35], v[60:63]
    s_waitcnt lgkmcnt(0)
    v_mfma_f32_16x16x32_bf16 v[32:35], a[64:67], a[96:99], v[32:35]
    ds_read_b64 v[150:151], v149 offset:3584
    v_mfma_f32_16x16x32_bf16 v[36:39], a[64:67], a[100:103], v[36:39]
    v_mfma_f32_16x16x32_bf16 v[40:43], a[64:67], a[104:107], v[40:43]
    v_mfma_f32_16x16x32_bf16 v[44:47], a[64:67], a[108:111], v[44:47]
    ds_read_b64 v[152:153], v149 offset:3072
    v_mfma_f32_16x16x32_bf16 v[48:51], a[64:67], a[112:115], v[48:51]
    s_add_u32 m0, s28, 73728
    s_add_u32 s63, s76, 73728
    buffer_load_dwordx4 v4, s[8:11], s63 offen sc1 lds
    v_mfma_f32_16x16x32_bf16 v[52:55], a[64:67], a[116:119], v[52:55]
    v_mfma_f32_16x16x32_bf16 v[56:59], a[64:67], a[120:123], v[56:59]
    v_mfma_f32_16x16x32_bf16 v[60:63], a[64:67], a[124:127], v[60:63]
    ds_read_b64 v[154:155], v149 offset:2560
    v_mfma_f32_16x16x32_bf16 v[36:39], a[68:71], a[96:99], v[36:39]
    v_mfma_f32_16x16x32_bf16 v[40:43], a[68:71], a[100:103], v[40:43]
    s_add_u32 m0, s28, 77824
    s_add_u32 s63, s76, 77824
    buffer_load_dwordx4 v4, s[8:11], s63 offen sc1 lds
    v_mfma_f32_16x16x32_bf16 v[44:47], a[68:71], a[104:107], v[44:47]
    v_mfma_f32_16x16x32_bf16 v[48:51], a[68:71], a[108:111], v[48:51]
    ds_read_b64 v[156:157], v149 offset:2048
    v_mfma_f32_16x16x32_bf16 v[52:55], a[68:71], a[112:115], v[52:55]
    v_mfma_f32_16x16x32_bf16 v[56:59], a[68:71], a[116:119], v[56:59]
    v_mfma_f32_16x16x32_bf16 v[60:63], a[68:71], a[120:123], v[60:63]
    s_add_u32 m0, s28, 81920
    s_add_u32 s63, s76, 81920
    buffer_load_dwordx4 v4, s[8:11], s63 offen sc1 lds
    v_mfma_f32_16x16x32_bf16 v[40:43], a[72:75], a[96:99], v[40:43]
    ds_read_b64 v[158:159], v149 offset:1536
    v_mfma_f32_16x16x32_bf16 v[44:47], a[72:75], a[100:103], v[44:47]
    v_mfma_f32_16x16x32_bf16 v[48:51], a[72:75], a[104:107], v[48:51]
    v_mfma_f32_16x16x32_bf16 v[52:55], a[72:75], a[108:111], v[52:55]
    v_mfma_f32_16x16x32_bf16 v[56:59], a[72:75], a[112:115], v[56:59]
    ds_read_b64 v[160:161], v149 offset:1024
    s_add_u32 m0, s28, 86016
    s_add_u32 s63, s76, 86016
    buffer_load_dwordx4 v4, s[8:11], s63 offen sc1 lds
    v_mfma_f32_16x16x32_bf16 v[60:63], a[72:75], a[116:119], v[60:63]
    v_mfma_f32_16x16x32_bf16 v[44:47], a[76:79], a[96:99], v[44:47]
    v_mfma_f32_16x16x32_bf16 v[48:51], a[76:79], a[100:103], v[48:51]
    v_mfma_f32_16x16x32_bf16 v[52:55], a[76:79], a[104:107], v[52:55]
    ds_read_b64 v[162:163], v149 offset:512
    v_mfma_f32_16x16x32_bf16 v[56:59], a[76:79], a[108:111], v[56:59]
    s_add_u32 m0, s28, 90112
    s_add_u32 s63, s76, 90112
    buffer_load_dwordx4 v4, s[8:11], s63 offen sc1 lds
    v_mfma_f32_16x16x32_bf16 v[60:63], a[76:79], a[112:115], v[60:63]
    v_mfma_f32_16x16x32_bf16 v[48:51], a[80:83], a[96:99], v[48:51]
    v_mfma_f32_16x16x32_bf16 v[52:55], a[80:83], a[100:103], v[52:55]
    ds_read_b64 v[164:165], v149 offset:0
    v_mfma_f32_16x16x32_bf16 v[56:59], a[80:83], a[104:107], v[56:59]
    v_mfma_f32_16x16x32_bf16 v[60:63], a[80:83], a[108:111], v[60:63]
    s_add_u32 m0, s28, 94208
    s_add_u32 s63, s76, 94208
    buffer_load_dwordx4 v4, s[8:11], s63 offen sc1 lds
    v_mfma_f32_16x16x32_bf16 v[52:55], a[84:87], a[96:99], v[52:55]
    v_mfma_f32_16x16x32_bf16 v[56:59], a[84:87], a[100:103], v[56:59]
    v_mfma_f32_16x16x32_bf16 v[60:63], a[84:87], a[104:107], v[60:63]
    v_mfma_f32_16x16x32_bf16 v[56:59], a[88:91], a[96:99], v[56:59]
    v_mfma_f32_16x16x32_bf16 v[60:63], a[88:91], a[100:103], v[60:63]
    s_add_u32 m0, s28, 98304
    s_add_u32 s63, s76, 98304
    buffer_load_dwordx4 v4, s[8:11], s63 offen sc1 lds
    v_mfma_f32_16x16x32_bf16 v[60:63], a[92:95], a[96:99], v[60:63]
    s_waitcnt lgkmcnt(0)
    s_waitcnt vmcnt(25)
    s_mov_b32 s49, s48
    v_and_b32 v168, s94, v151
    v_lshlrev_b32 v169, 16, v151
    v_and_b32 v170, s94, v150
    v_lshlrev_b32 v171, 16, v150
    v_lshlrev_b32 v172, 16, v64
    v_and_b32 v173, s94, v64
    v_lshlrev_b32 v174, 16, v65
    v_and_b32 v175, s94, v65
    v_pk_fma_f32 v[168:169], v[168:169], s[48:49], v[32:33]
    v_pk_fma_f32 v[176:177], v[172:173], v[80:81], v[112:113]
    v_pk_fma_f32 v[168:169], v[176:177], v[168:169], v[172:173]
    v_pk_fma_f32 v[170:171], v[170:171], s[48:49], v[34:35]
    v_pk_fma_f32 v[178:179], v[174:175], v[82:83], v[114:115]
    v_pk_fma_f32 v[170:171], v[178:179], v[170:171], v[174:175]
    v_cvt_pk_bf16_f32 v176, v168, v170
    v_cvt_pk_bf16_f32 v177, v169, v171
    ds_write_b32 v166, v176 offset:0
    ds_write_b32 v166, v177 offset:2048
    v_and_b32 v180, s94, v153
    v_lshlrev_b32 v181, 16, v153
    v_and_b32 v182, s94, v152
    v_lshlrev_b32 v183, 16, v152
    v_lshlrev_b32 v184, 16, v66
    v_and_b32 v185, s94, v66
    v_lshlrev_b32 v186, 16, v67
    v_and_b32 v187, s94, v67
    v_pk_fma_f32 v[180:181], v[180:181], s[48:49], v[36:37]
    v_pk_fma_f32 v[188:189], v[184:185], v[84:85], v[116:117]
    v_pk_fma_f32 v[180:181], v[188:189], v[180:181], v[184:185]
    v_pk_fma_f32 v[182:183], v[182:183], s[48:49], v[38:39]
    v_pk_fma_f32 v[190:191], v[186:187], v[86:87], v[118:119]
    v_pk_fma_f32 v[182:183], v[190:191], v[182:183], v[186:187]
    v_cvt_pk_bf16_f32 v188, v180, v182
    v_cvt_pk_bf16_f32 v189, v181, v183
    ds_write_b32 v166, v188 offset:256
    ds_write_b32 v166, v189 offset:2304
    v_and_b32 v168, s94, v155
    v_lshlrev_b32 v169, 16, v155
    v_and_b32 v170, s94, v154
    v_lshlrev_b32 v171, 16, v154
    v_lshlrev_b32 v172, 16, v68
    v_and_b32 v173, s94, v68
    v_lshlrev_b32 v174, 16, v69
    v_and_b32 v175, s94, v69
    v_pk_fma_f32 v[168:169], v[168:169], s[48:49], v[40:41]
    v_pk_fma_f32 v[176:177], v[172:173], v[88:89], v[120:121]
    v_pk_fma_f32 v[168:169], v[176:177], v[168:169], v[172:173]
    v_pk_fma_f32 v[170:171], v[170:171], s[48:49], v[42:43]
    v_pk_fma_f32 v[178:179], v[174:175], v[90:91], v[122:123]
    v_pk_fma_f32 v[170:171], v[178:179], v[170:171], v[174:175]
    v_cvt_pk_bf16_f32 v176, v168, v170
    v_cvt_pk_bf16_f32 v177, v169, v171
    ds_write_b32 v166, v176 offset:512
    ds_write_b32 v166, v177 offset:2560
    v_and_b32 v180, s94, v157
    v_lshlrev_b32 v181, 16, v157
    v_and_b32 v182, s94, v156
    v_lshlrev_b32 v183, 16, v156
    v_lshlrev_b32 v184, 16, v70
    v_and_b32 v185, s94, v70
    v_lshlrev_b32 v186, 16, v71
    v_and_b32 v187, s94, v71
    v_pk_fma_f32 v[180:181], v[180:181], s[48:49], v[44:45]
    v_pk_fma_f32 v[188:189], v[184:185], v[92:93], v[124:125]
    v_pk_fma_f32 v[180:181], v[188:189], v[180:181], v[184:185]
    v_pk_fma_f32 v[182:183], v[182:183], s[48:49], v[46:47]
    v_pk_fma_f32 v[190:191], v[186:187], v[94:95], v[126:127]
    v_pk_fma_f32 v[182:183], v[190:191], v[182:183], v[186:187]
    v_cvt_pk_bf16_f32 v188, v180, v182
    v_cvt_pk_bf16_f32 v189, v181, v183
    ds_write_b32 v166, v188 offset:768
    ds_write_b32 v166, v189 offset:2816
    s_waitcnt lgkmcnt(0)
    s_barrier
    ds_read_b64_tr_b16 v[196:197], v192 offset:0
    ds_read_b64_tr_b16 v[198:199], v192 offset:2048
    ds_read_b64_tr_b16 v[200:201], v192 offset:128
    ds_read_b64_tr_b16 v[202:203], v192 offset:2176
    v_and_b32 v168, s94, v159
    v_lshlrev_b32 v169, 16, v159
    v_and_b32 v170, s94, v158
    v_lshlrev_b32 v171, 16, v158
    v_lshlrev_b32 v172, 16, v72
    v_and_b32 v173, s94, v72
    v_lshlrev_b32 v174, 16, v73
    v_and_b32 v175, s94, v73
    v_pk_fma_f32 v[168:169], v[168:169], s[48:49], v[48:49]
    v_pk_fma_f32 v[176:177], v[172:173], v[96:97], v[128:129]
    v_pk_fma_f32 v[168:169], v[176:177], v[168:169], v[172:173]
    v_pk_fma_f32 v[170:171], v[170:171], s[48:49], v[50:51]
    v_pk_fma_f32 v[178:179], v[174:175], v[98:99], v[130:131]
    v_pk_fma_f32 v[170:171], v[178:179], v[170:171], v[174:175]
    v_cvt_pk_bf16_f32 v176, v168, v170
    v_cvt_pk_bf16_f32 v177, v169, v171
    ds_write_b32 v166, v176 offset:1024
    ds_write_b32 v166, v177 offset:3072
    v_and_b32 v180, s94, v161
    v_lshlrev_b32 v181, 16, v161
    v_and_b32 v182, s94, v160
    v_lshlrev_b32 v183, 16, v160
    v_lshlrev_b32 v184, 16, v74
    v_and_b32 v185, s94, v74
    v_lshlrev_b32 v186, 16, v75
    v_and_b32 v187, s94, v75
    v_pk_fma_f32 v[180:181], v[180:181], s[48:49], v[52:53]
    v_pk_fma_f32 v[188:189], v[184:185], v[100:101], v[132:133]
    v_pk_fma_f32 v[180:181], v[188:189], v[180:181], v[184:185]
    v_pk_fma_f32 v[182:183], v[182:183], s[48:49], v[54:55]
    v_pk_fma_f32 v[190:191], v[186:187], v[102:103], v[134:135]
    v_pk_fma_f32 v[182:183], v[190:191], v[182:183], v[186:187]
    v_cvt_pk_bf16_f32 v188, v180, v182
    v_cvt_pk_bf16_f32 v189, v181, v183
    ds_write_b32 v166, v188 offset:1280
    ds_write_b32 v166, v189 offset:3328
    s_waitcnt lgkmcnt(4)
    s_add_u32 s34, s53, 0
    buffer_store_dwordx4 v[196:199], v193, s[8:11], s34 offen sc1
    s_add_u32 s34, s53, 163840
    buffer_store_dwordx4 v[200:203], v193, s[8:11], s34 offen sc1
    v_and_b32 v168, s94, v163
    v_lshlrev_b32 v169, 16, v163
    v_and_b32 v170, s94, v162
    v_lshlrev_b32 v171, 16, v162
    v_lshlrev_b32 v172, 16, v76
    v_and_b32 v173, s94, v76
    v_lshlrev_b32 v174, 16, v77
    v_and_b32 v175, s94, v77
    v_pk_fma_f32 v[168:169], v[168:169], s[48:49], v[56:57]
    v_pk_fma_f32 v[176:177], v[172:173], v[104:105], v[136:137]
    v_pk_fma_f32 v[168:169], v[176:177], v[168:169], v[172:173]
    v_pk_fma_f32 v[170:171], v[170:171], s[48:49], v[58:59]
    v_pk_fma_f32 v[178:179], v[174:175], v[106:107], v[138:139]
    v_pk_fma_f32 v[170:171], v[178:179], v[170:171], v[174:175]
    v_cvt_pk_bf16_f32 v176, v168, v170
    v_cvt_pk_bf16_f32 v177, v169, v171
    ds_write_b32 v166, v176 offset:1536
    ds_write_b32 v166, v177 offset:3584
    v_and_b32 v180, s94, v165
    v_lshlrev_b32 v181, 16, v165
    v_and_b32 v182, s94, v164
    v_lshlrev_b32 v183, 16, v164
    v_lshlrev_b32 v184, 16, v78
    v_and_b32 v185, s94, v78
    v_lshlrev_b32 v186, 16, v79
    v_and_b32 v187, s94, v79
    v_pk_fma_f32 v[180:181], v[180:181], s[48:49], v[60:61]
    v_pk_fma_f32 v[188:189], v[184:185], v[108:109], v[140:141]
    v_pk_fma_f32 v[180:181], v[188:189], v[180:181], v[184:185]
    v_pk_fma_f32 v[182:183], v[182:183], s[48:49], v[62:63]
    v_pk_fma_f32 v[190:191], v[186:187], v[110:111], v[142:143]
    v_pk_fma_f32 v[182:183], v[190:191], v[182:183], v[186:187]
    v_cvt_pk_bf16_f32 v188, v180, v182
    v_cvt_pk_bf16_f32 v189, v181, v183
    ds_write_b32 v166, v188 offset:1792
    ds_write_b32 v166, v189 offset:3840
    s_waitcnt lgkmcnt(0)
    s_barrier
    ds_read_b64_tr_b16 v[204:205], v192 offset:1024
    ds_read_b64_tr_b16 v[206:207], v192 offset:3072
    ds_read_b64_tr_b16 v[208:209], v192 offset:1152
    ds_read_b64_tr_b16 v[210:211], v192 offset:3200
    s_waitcnt lgkmcnt(0)
    s_add_u32 s34, s53, 1310720
    buffer_store_dwordx4 v[204:207], v193, s[8:11], s34 offen sc1
    s_add_u32 s34, s53, 1474560
    buffer_store_dwordx4 v[208:211], v193, s[8:11], s34 offen sc1
    s_waitcnt vmcnt(0)
    s_barrier
    s_cmp_lg_u32 s3, 0
    s_cbranch_scc1 L_sig_21
    s_lshl_b32 s32, s2, 2
    s_add_u32 s32, s32, 0x194a000
    v_lshlrev_b32 v240, 10, v1
    v_mov_b32 v241, s7
    s_mov_b64 exec, 255
    buffer_store_dword v241, v240, s[8:11], s32 offen sc1
    s_mov_b64 exec, -1
L_sig_21:
    s_add_u32 m0, s28, 102400
    s_add_u32 s63, s77, 0
    buffer_load_dwordx4 v4, s[8:11], s63 offen sc1 lds
    s_add_u32 m0, s28, 106496
    s_add_u32 s63, s77, 4096
    buffer_load_dwordx4 v4, s[8:11], s63 offen sc1 lds
    s_add_u32 m0, s28, 110592
    s_add_u32 s63, s77, 8192
    buffer_load_dwordx4 v4, s[8:11], s63 offen sc1 lds
    s_add_u32 m0, s28, 114688
    s_add_u32 s63, s77, 12288
    buffer_load_dwordx4 v4, s[8:11], s63 offen sc1 lds
    s_add_u32 m0, s28, 118784
    s_add_u32 s63, s77, 16384
    buffer_load_dwordx4 v4, s[8:11], s63 offen sc1 lds
    s_add_u32 m0, s28, 122880
    s_add_u32 s63, s77, 20480
    buffer_load_dwordx4 v4, s[8:11], s63 offen sc1 lds
    s_add_u32 m0, s28, 126976
    s_add_u32 s63, s77, 24576
    buffer_load_dwordx4 v4, s[8:11], s63 offen sc1 lds
    s_add_u32 m0, s28, 131072
    s_add_u32 s63, s77, 28672
    buffer_load_dwordx4 v4, s[8:11], s63 offen sc1 lds
    s_add_u32 m0, s28, 135168
    s_add_u32 s63, s77, 32768
    buffer_load_dwordx4 v4, s[8:11], s63 offen sc1 lds
    s_add_u32 m0, s28, 139264
    s_add_u32 s63, s77, 36864
    buffer_load_dwordx4 v4, s[8:11], s63 offen sc1 lds
    s_add_u32 m0, s28, 143360
    s_add_u32 s63, s77, 40960
    buffer_load_dwordx4 v4, s[8:11], s63 offen sc1 lds
    s_add_u32 m0, s28, 147456
    s_add_u32 s63, s77, 45056
    buffer_load_dwordx4 v4, s[8:11], s63 offen sc1 lds
    s_sub_u32 s59, s3, 0
    s_min_u32 s59, s59, 1
    s_lshl_b32 s59, s59, 10
    s_sub_u32 s63, s77, s28
    s_add_u32 s63, s63, s59
    s_add_u32 s63, s63, 49152
    s_add_u32 s59, s59, 151552
    s_sub_u32 m0, s59, 153600
    s_cmp_ge_u32 s59, 153600
    s_cselect_b32 m0, m0, s59
    s_nop 0
    buffer_load_dwordx4 v4, s[8:11], s63 offen sc1 lds
    s_branch L_b1_13
L_aux_12:
    s_waitcnt vmcnt(0)
    s_barrier
    s_cmp_lg_u32 s3, 0
    s_cbranch_scc1 L_sig_24
    s_lshl_b32 s32, s2, 2
    s_add_u32 s32, s32, 0x194e000
    v_lshlrev_b32 v240, 10, v1
    v_mov_b32 v241, s7
    s_mov_b64 exec, 255
    buffer_store_dword v241, v240, s[8:11], s32 offen sc1
    s_mov_b64 exec, -1
L_sig_24:
    s_sub_u32 s50, s30, 20
    s_lshl_b32 s50, s50, 3
    s_add_u32 s50, s50, s29
    s_cmp_ge_u32 s50, 67
    s_cbranch_scc1 L_auxdone_25
    s_mov_b32 s53, 0
    s_mov_b32 s54, 20
    s_mov_b32 s52, 1280
    s_mov_b32 s57, 0
    s_mov_b32 s56, 0x7f000000
    s_cmp_ge_u32 s50, 27
    s_cbranch_scc1 L_aw4_28
    s_mov_b32 s12, s82
    s_and_b32 s13, s83, 0xffff
    s_mov_b32 s14, 0x21c000
    s_mov_b32 s15, 0x20000
    s_mov_b32 s51, s50
    s_mov_b32 s52, 3456
    s_mov_b32 s55, 0x14d0000
    s_mov_b32 s57, 1
    s_lshl_b32 s56, s51, 8
    s_add_u32 s56, s56, 0x1945000
    s_branch L_auxgo_26
L_aw4_28:
    s_cmp_ge_u32 s50, 57
    s_cbranch_scc1 L_aw1_29
    s_mov_b32 s12, s84
    s_and_b32 s13, s85, 0xffff
    s_mov_b32 s14, 0x21c000
    s_mov_b32 s15, 0x20000
    s_sub_u32 s51, s50, 27
    s_mul_i32 s53, s51, 26
    s_lshr_b32 s53, s53, 8
    s_mul_i32 s32, s53, 10
    s_sub_u32 s51, s51, s32
    s_mul_i32 s53, s53, 20
    s_mov_b32 s54, 54
    s_mov_b32 s55, 0x1700000
    s_branch L_auxgo_26
L_aw1_29:
    s_mov_b32 s12, s78
    s_and_b32 s13, s79, 0xffff
    s_mov_b32 s14, 0xc8000
    s_mov_b32 s15, 0x20000
    s_sub_u32 s51, s50, 57
    s_mov_b32 s55, 0x7f000000
    s_lshl_b32 s56, s51, 8
    s_add_u32 s56, s56, 0x1944000
L_auxgo_26:
    s_mov_b32 s49, 7168
    s_cmp_eq_u32 s57, 0
    s_cselect_b32 s49, 5120, s49
    s_lshl_b32 s32, s51, 2
    s_add_u32 s32, s32, 0
    s_cmp_eq_u32 s57, 0
    s_cbranch_scc0 L_m_30
    s_mul_i32 s33, s32, 52
    s_lshr_b32 s33, s33, 8
    s_mul_i32 s34, s33, 5
    s_sub_u32 s34, s32, s34
    s_mul_i32 s33, s33, s54
    s_mul_i32 s33, s33, 5
    s_branch L_m_32
L_m_30:
    s_cmp_ge_u32 s32, 84
    s_cbranch_scc1 L_m_31
    s_mul_i32 s33, s32, 37
    s_lshr_b32 s33, s33, 8
    s_mul_i32 s34, s33, 7
    s_sub_u32 s34, s32, s34
    s_mul_i32 s33, s33, 140
    s_branch L_m_32
L_m_31:
    s_sub_u32 s32, s32, 84
    s_mul_i32 s33, s32, 43
    s_lshr_b32 s33, s33, 8
    s_mul_i32 s34, s33, 6
    s_sub_u32 s34, s32, s34
    s_add_u32 s33, s33, 12
    s_mul_i32 s33, s33, 140
L_m_32:
    s_add_u32 s33, s33, s34
    s_lshl_b32 s33, s33, 10
    s_add_u32 s40, s33, s55
    s_lshl_b32 s32, s51, 2
    s_add_u32 s32, s32, 1
    s_cmp_eq_u32 s57, 0
    s_cbranch_scc0 L_m_33
    s_mul_i32 s33, s32, 52
    s_lshr_b32 s33, s33, 8
    s_mul_i32 s34, s33, 5
    s_sub_u32 s34, s32, s34
    s_mul_i32 s33, s33, s54
    s_mul_i32 s33, s33, 5
    s_branch L_m_35
L_m_33:
    s_cmp_ge_u32 s32, 84
    s_cbranch_scc1 L_m_34
    s_mul_i32 s33, s32, 37
    s_lshr_b32 s33, s33, 8
    s_mul_i32 s34, s33, 7
    s_sub_u32 s34, s32, s34
    s_mul_i32 s33, s33, 140
    s_branch L_m_35
L_m_34:
    s_sub_u32 s32, s32, 84
    s_mul_i32 s33, s32, 43
    s_lshr_b32 s33, s33, 8
    s_mul_i32 s34, s33, 6
    s_sub_u32 s34, s32, s34
    s_add_u32 s33, s33, 12
    s_mul_i32 s33, s33, 140
L_m_35:
    s_add_u32 s33, s33, s34
    s_lshl_b32 s33, s33, 10
    s_add_u32 s41, s33, s55
    s_lshl_b32 s32, s51, 2
    s_add_u32 s32, s32, 2
    s_cmp_eq_u32 s57, 0
    s_cbranch_scc0 L_m_36
    s_mul_i32 s33, s32, 52
    s_lshr_b32 s33, s33, 8
    s_mul_i32 s34, s33, 5
    s_sub_u32 s34, s32, s34
    s_mul_i32 s33, s33, s54
    s_mul_i32 s33, s33, 5
    s_branch L_m_38
L_m_36:
    s_cmp_ge_u32 s32, 84
    s_cbranch_scc1 L_m_37
    s_mul_i32 s33, s32, 37
    s_lshr_b32 s33, s33, 8
    s_mul_i32 s34, s33, 7
    s_sub_u32 s34, s32, s34
    s_mul_i32 s33, s33, 140
    s_branch L_m_38
L_m_37:
    s_sub_u32 s32, s32, 84
    s_mul_i32 s33, s32, 43
    s_lshr_b32 s33, s33, 8
    s_mul_i32 s34, s33, 6
    s_sub_u32 s34, s32, s34
    s_add_u32 s33, s33, 12
    s_mul_i32 s33, s33, 140
L_m_38:
    s_add_u32 s33, s33, s34
    s_lshl_b32 s33, s33, 10
    s_add_u32 s42, s33, s55
    s_lshl_b32 s32, s51, 2
    s_add_u32 s32, s32, 3
    s_cmp_eq_u32 s57, 0
    s_cbranch_scc0 L_m_39
    s_mul_i32 s33, s32, 52
    s_lshr_b32 s33, s33, 8
    s_mul_i32 s34, s33, 5
    s_sub_u32 s34, s32, s34
    s_mul_i32 s33, s33, s54
    s_mul_i32 s33, s33, 5
    s_branch L_m_41
L_m_39:
    s_cmp_ge_u32 s32, 84
    s_cbranch_scc1 L_m_40
    s_mul_i32 s33, s32, 37
    s_lshr_b32 s33, s33, 8
    s_mul_i32 s34, s33, 7
    s_sub_u32 s34, s32, s34
    s_mul_i32 s33, s33, 140
    s_branch L_m_41
L_m_40:
    s_sub_u32 s32, s32, 84
    s_mul_i32 s33, s32, 43
    s_lshr_b32 s33, s33, 8
    s_mul_i32 s34, s33, 6
    s_sub_u32 s34, s32, s34
    s_add_u32 s33, s33, 12
    s_mul_i32 s33, s33, 140
L_m_41:
    s_add_u32 s33, s33, s34
    s_lshl_b32 s33, s33, 10
    s_add_u32 s43, s33, s55
    s_mul_i32 s58, s3, 20480
    s_lshl_b32 s59, s52, 3
    v_lshrrev_b32 v36, 3, v1
    v_mul_lo_u32 v36, v36, s52
    v_and_b32 v37, 7, v1
    v_lshl_add_u32 v36, v37, 4, v36
    v_lshrrev_b32 v37, 2, v1
    v_and_b32 v37, 3, v37
    v_lshl_add_u32 v37, v3, 3, v37
    v_lshlrev_b32 v37, 7, v37
    v_and_b32 v240, 3, v1
    v_lshl_add_u32 v37, v240, 3, v37
    v_add_u32 v37, s58, v37
    s_mul_i32 s35, s3, 5
    s_add_u32 s35, s35, s53
    s_add_u32 s36, s35, 0
    s_mul_i32 s36, s36, s52
    s_lshl_b32 s36, s36, 5
    s_lshl_b32 s37, s51, 7
    s_add_u32 s36, s36, s37
    s_mov_b32 s32, s36
    s_add_u32 m0, s58, 0
    s_nop 0
    buffer_load_dwordx4 v36, s[12:15], s32 offen lds
    s_add_u32 m0, s58, 1024
    s_add_u32 s32, s32, s59
    buffer_load_dwordx4 v36, s[12:15], s32 offen lds
    s_add_u32 m0, s58, 2048
    s_add_u32 s32, s32, s59
    buffer_load_dwordx4 v36, s[12:15], s32 offen lds
    s_add_u32 m0, s58, 3072
    s_add_u32 s32, s32, s59
    buffer_load_dwordx4 v36, s[12:15], s32 offen lds
    s_add_u32 s36, s35, 1
    s_mul_i32 s36, s36, s52
    s_lshl_b32 s36, s36, 5
    s_lshl_b32 s37, s51, 7
    s_add_u32 s36, s36, s37
    s_mov_b32 s32, s36
    s_add_u32 m0, s58, 4096
    s_nop 0
    buffer_load_dwordx4 v36, s[12:15], s32 offen lds
    s_add_u32 m0, s58, 5120
    s_add_u32 s32, s32, s59
    buffer_load_dwordx4 v36, s[12:15], s32 offen lds
    s_add_u32 m0, s58, 6144
    s_add_u32 s32, s32, s59
    buffer_load_dwordx4 v36, s[12:15], s32 offen lds
    s_add_u32 m0, s58, 7168
    s_add_u32 s32, s32, s59
    buffer_load_dwordx4 v36, s[12:15], s32 offen lds
    s_add_u32 s36, s35, 2
    s_mul_i32 s36, s36, s52
    s_lshl_b32 s36, s36, 5
    s_lshl_b32 s37, s51, 7
    s_add_u32 s36, s36, s37
    s_mov_b32 s32, s36
    s_add_u32 m0, s58, 8192
    s_nop 0
    buffer_load_dwordx4 v36, s[12:15], s32 offen lds
    s_add_u32 m0, s58, 9216
    s_add_u32 s32, s32, s59
    buffer_load_dwordx4 v36, s[12:15], s32 offen lds
    s_add_u32 m0, s58, 10240
    s_add_u32 s32, s32, s59
    buffer_load_dwordx4 v36, s[12:15], s32 offen lds
    s_add_u32 m0, s58, 11264
    s_add_u32 s32, s32, s59
    buffer_load_dwordx4 v36, s[12:15], s32 offen lds
    s_add_u32 s36, s35, 3
    s_mul_i32 s36, s36, s52
    s_lshl_b32 s36, s36, 5
    s_lshl_b32 s37, s51, 7
    s_add_u32 s36, s36, s37
    s_mov_b32 s32, s36
    s_add_u32 m0, s58, 12288
    s_nop 0
    buffer_load_dwordx4 v36, s[12:15], s32 offen lds
    s_add_u32 m0, s58, 13312
    s_add_u32 s32, s32, s59
    buffer_load_dwordx4 v36, s[12:15], s32 offen lds
    s_add_u32 m0, s58, 14336
    s_add_u32 s32, s32, s59
    buffer_load_dwordx4 v36, s[12:15], s32 offen lds
    s_add_u32 m0, s58, 15360
    s_add_u32 s32, s32, s59
    buffer_load_dwordx4 v36, s[12:15], s32 offen lds
    s_add_u32 s36, s35, 4
    s_mul_i32 s36, s36, s52
    s_lshl_b32 s36, s36, 5
    s_lshl_b32 s37, s51, 7
    s_add_u32 s36, s36, s37
    s_mov_b32 s32, s36
    s_add_u32 m0, s58, 16384
    s_nop 0
    buffer_load_dwordx4 v36, s[12:15], s32 offen lds
    s_add_u32 m0, s58, 17408
    s_add_u32 s32, s32, s59
    buffer_load_dwordx4 v36, s[12:15], s32 offen lds
    s_add_u32 m0, s58, 18432
    s_add_u32 s32, s32, s59
    buffer_load_dwordx4 v36, s[12:15], s32 offen lds
    s_add_u32 m0, s58, 19456
    s_add_u32 s32, s32, s59
    buffer_load_dwordx4 v36, s[12:15], s32 offen lds
    v_mov_b32 v60, 0x3f803f80
    v_mov_b32 v61, 0x3f803f80
    v_mov_b32 v62, 0x3f803f80
    v_mov_b32 v63, 0x3f803f80
    s_waitcnt vmcnt(16)
    ds_read_b64_tr_b16 v[64:65], v37 offset:0
    ds_read_b64_tr_b16 v[66:67], v37 offset:512
    ds_read_b64_tr_b16 v[68:69], v37 offset:32
    ds_read_b64_tr_b16 v[70:71], v37 offset:544
    ds_read_b64_tr_b16 v[72:73], v37 offset:64
    ds_read_b64_tr_b16 v[74:75], v37 offset:576
    ds_read_b64_tr_b16 v[76:77], v37 offset:96
    ds_read_b64_tr_b16 v[78:79], v37 offset:608
    s_add_u32 s36, s35, 0
    s_mul_i32 s37, s36, s49
    s_waitcnt lgkmcnt(0)
    v_mfma_f32_16x16x32_bf16 v[40:43], v[64:67], v[60:63], 0
    s_add_u32 s38, s37, s40
    s_cmp_lt_u32 s36, s54
    s_cselect_b32 s38, s38, 0x7f000000
    buffer_store_dwordx4 v[64:67], v4, s[8:11], s38 offen sc1
    v_mfma_f32_16x16x32_bf16 v[44:47], v[68:71], v[60:63], 0
    s_add_u32 s38, s37, s41
    s_cmp_lt_u32 s36, s54
    s_cselect_b32 s38, s38, 0x7f000000
    buffer_store_dwordx4 v[68:71], v4, s[8:11], s38 offen sc1
    v_mfma_f32_16x16x32_bf16 v[48:51], v[72:75], v[60:63], 0
    s_add_u32 s38, s37, s42
    s_cmp_lt_u32 s36, s54
    s_cselect_b32 s38, s38, 0x7f000000
    buffer_store_dwordx4 v[72:75], v4, s[8:11], s38 offen sc1
    v_mfma_f32_16x16x32_bf16 v[52:55], v[76:79], v[60:63], 0
    s_add_u32 s38, s37, s43
    s_cmp_lt_u32 s36, s54
    s_cselect_b32 s38, s38, 0x7f000000
    buffer_store_dwordx4 v[76:79], v4, s[8:11], s38 offen sc1
    s_waitcnt vmcnt(16)
    ds_read_b64_tr_b16 v[80:81], v37 offset:4096
    ds_read_b64_tr_b16 v[82:83], v37 offset:4608
    ds_read_b64_tr_b16 v[84:85], v37 offset:4128
    ds_read_b64_tr_b16 v[86:87], v37 offset:4640
    ds_read_b64_tr_b16 v[88:89], v37 offset:4160
    ds_read_b64_tr_b16 v[90:91], v37 offset:4672
    ds_read_b64_tr_b16 v[92:93], v37 offset:4192
    ds_read_b64_tr_b16 v[94:95], v37 offset:4704
    s_add_u32 s36, s35, 1
    s_mul_i32 s37, s36, s49
    s_waitcnt lgkmcnt(0)
    v_mfma_f32_16x16x32_bf16 v[40:43], v[80:83], v[60:63], v[40:43]
    s_add_u32 s38, s37, s40
    s_cmp_lt_u32 s36, s54
    s_cselect_b32 s38, s38, 0x7f000000
    buffer_store_dwordx4 v[80:83], v4, s[8:11], s38 offen sc1
    v_mfma_f32_16x16x32_bf16 v[44:47], v[84:87], v[60:63], v[44:47]
    s_add_u32 s38, s37, s41
    s_cmp_lt_u32 s36, s54
    s_cselect_b32 s38, s38, 0x7f000000
    buffer_store_dwordx4 v[84:87], v4, s[8:11], s38 offen sc1
    v_mfma_f32_16x16x32_bf16 v[48:51], v[88:91], v[60:63], v[48:51]
    s_add_u32 s38, s37, s42
    s_cmp_lt_u32 s36, s54
    s_cselect_b32 s38, s38, 0x7f000000
    buffer_store_dwordx4 v[88:91], v4, s[8:11], s38 offen sc1
    v_mfma_f32_16x16x32_bf16 v[52:55], v[92:95], v[60:63], v[52:55]
    s_add_u32 s38, s37, s43
    s_cmp_lt_u32 s36, s54
    s_cselect_b32 s38, s38, 0x7f000000
    buffer_store_dwordx4 v[92:95], v4, s[8:11], s38 offen sc1
    s_waitcnt vmcnt(16)
    ds_read_b64_tr_b16 v[64:65], v37 offset:8192
    ds_read_b64_tr_b16 v[66:67], v37 offset:8704
    ds_read_b64_tr_b16 v[68:69], v37 offset:8224
    ds_read_b64_tr_b16 v[70:71], v37 offset:8736
    ds_read_b64_tr_b16 v[72:73], v37 offset:8256
    ds_read_b64_tr_b16 v[74:75], v37 offset:8768
    ds_read_b64_tr_b16 v[76:77], v37 offset:8288
    ds_read_b64_tr_b16 v[78:79], v37 offset:8800
    s_add_u32 s36, s35, 2
    s_mul_i32 s37, s36, s49
    s_waitcnt lgkmcnt(0)
    v_mfma_f32_16x16x32_bf16 v[40:43], v[64:67], v[60:63], v[40:43]
    s_add_u32 s38, s37, s40
    s_cmp_lt_u32 s36, s54
    s_cselect_b32 s38, s38, 0x7f000000
    buffer_store_dwordx4 v[64:67], v4, s[8:11], s38 offen sc1
    v_mfma_f32_16x16x32_bf16 v[44:47], v[68:71], v[60:63], v[44:47]
    s_add_u32 s38, s37, s41
    s_cmp_lt_u32 s36, s54
    s_cselect_b32 s38, s38, 0x7f000000
    buffer_store_dwordx4 v[68:71], v4, s[8:11], s38 offen sc1
    v_mfma_f32_16x16x32_bf16 v[48:51], v[72:75], v[60:63], v[48:51]
    s_add_u32 s38, s37, s42
    s_cmp_lt_u32 s36, s54
    s_cselect_b32 s38, s38, 0x7f000000
    buffer_store_dwordx4 v[72:75], v4, s[8:11], s38 offen sc1
    v_mfma_f32_16x16x32_bf16 v[52:55], v[76:79], v[60:63], v[52:55]
    s_add_u32 s38, s37, s43
    s_cmp_lt_u32 s36, s54
    s_cselect_b32 s38, s38, 0x7f000000
    buffer_store_dwordx4 v[76:79], v4, s[8:11], s38 offen sc1
    s_waitcnt vmcnt(16)
    ds_read_b64_tr_b16 v[80:81], v37 offset:12288
    ds_read_b64_tr_b16 v[82:83], v37 offset:12800
    ds_read_b64_tr_b16 v[84:85], v37 offset:12320
    ds_read_b64_tr_b16 v[86:87], v37 offset:12832
    ds_read_b64_tr_b16 v[88:89], v37 offset:12352
    ds_read_b64_tr_b16 v[90:91], v37 offset:12864
    ds_read_b64_tr_b16 v[92:93], v37 offset:12384
    ds_read_b64_tr_b16 v[94:95], v37 offset:12896
    s_add_u32 s36, s35, 3
    s_mul_i32 s37, s36, s49
    s_waitcnt lgkmcnt(0)
    v_mfma_f32_16x16x32_bf16 v[40:43], v[80:83], v[60:63], v[40:43]
    s_add_u32 s38, s37, s40
    s_cmp_lt_u32 s36, s54
    s_cselect_b32 s38, s38, 0x7f000000
    buffer_store_dwordx4 v[80:83], v4, s[8:11], s38 offen sc1
    v_mfma_f32_16x16x32_bf16 v[44:47], v[84:87], v[60:63], v[44:47]
    s_add_u32 s38, s37, s41
    s_cmp_lt_u32 s36, s54
    s_cselect_b32 s38, s38, 0x7f000000
    buffer_store_dwordx4 v[84:87], v4, s[8:11], s38 offen sc1
    v_mfma_f32_16x16x32_bf16 v[48:51], v[88:91], v[60:63], v[48:51]
    s_add_u32 s38, s37, s42
    s_cmp_lt_u32 s36, s54
    s_cselect_b32 s38, s38, 0x7f000000
    buffer_store_dwordx4 v[88:91], v4, s[8:11], s38 offen sc1
    v_mfma_f32_16x16x32_bf16 v[52:55], v[92:95], v[60:63], v[52:55]
    s_add_u32 s38, s37, s43
    s_cmp_lt_u32 s36, s54
    s_cselect_b32 s38, s38, 0x7f000000
    buffer_store_dwordx4 v[92:95], v4, s[8:11], s38 offen sc1
    s_waitcnt vmcnt(16)
    ds_read_b64_tr_b16 v[64:65], v37 offset:16384
    ds_read_b64_tr_b16 v[66:67], v37 offset:16896
    ds_read_b64_tr_b16 v[68:69], v37 offset:16416
    ds_read_b64_tr_b16 v[70:71], v37 offset:16928
    ds_read_b64_tr_b16 v[72:73], v37 offset:16448
    ds_read_b64_tr_b16 v[74:75], v37 offset:16960
    ds_read_b64_tr_b16 v[76:77], v37 offset:16480
    ds_read_b64_tr_b16 v[78:79], v37 offset:16992
    s_add_u32 s36, s35, 4
    s_mul_i32 s37, s36, s49
    s_waitcnt lgkmcnt(0)
    v_mfma_f32_16x16x32_bf16 v[40:43], v[64:67], v[60:63], v[40:43]
    s_add_u32 s38, s37, s40
    s_cmp_lt_u32 s36, s54
    s_cselect_b32 s38, s38, 0x7f000000
    buffer_store_dwordx4 v[64:67], v4, s[8:11], s38 offen sc1
    v_mfma_f32_16x16x32_bf16 v[44:47], v[68:71], v[60:63], v[44:47]
    s_add_u32 s38, s37, s41
    s_cmp_lt_u32 s36, s54
    s_cselect_b32 s38, s38, 0x7f000000
    buffer_store_dwordx4 v[68:71], v4, s[8:11], s38 offen sc1
    v_mfma_f32_16x16x32_bf16 v[48:51], v[72:75], v[60:63], v[48:51]
    s_add_u32 s38, s37, s42
    s_cmp_lt_u32 s36, s54
    s_cselect_b32 s38, s38, 0x7f000000
    buffer_store_dwordx4 v[72:75], v4, s[8:11], s38 offen sc1
    v_mfma_f32_16x16x32_bf16 v[52:55], v[76:79], v[60:63], v[52:55]
    s_add_u32 s38, s37, s43
    s_cmp_lt_u32 s36, s54
    s_cselect_b32 s38, s38, 0x7f000000
    buffer_store_dwordx4 v[76:79], v4, s[8:11], s38 offen sc1
    v_lshlrev_b32 v240, 4, v3
    s_lshl_b32 s36, s3, 8
    s_add_u32 s36, s36, 161792
    v_add_u32 v240, s36, v240
    s_mov_b32 exec_lo, 0x00010001
    s_mov_b32 exec_hi, 0x00010001
    ds_write_b128 v240, v[40:43] offset:0
    ds_write_b128 v240, v[44:47] offset:64
    ds_write_b128 v240, v[48:51] offset:128
    ds_write_b128 v240, v[52:55] offset:192
    s_mov_b64 exec, -1
    s_waitcnt lgkmcnt(0)
    s_barrier
    s_cmp_lg_u32 s3, 0
    s_cbranch_scc1 L_nocs_42
    v_lshlrev_b32 v240, 2, v1
    v_add_u32 v241, 161792, v240
    ds_read_b32 v244, v241 offset:0
    ds_read_b32 v245, v241 offset:256
    ds_read_b32 v246, v241 offset:512
    ds_read_b32 v247, v241 offset:768
    s_waitcnt lgkmcnt(0)
    v_add_f32 v244, v244, v245
    v_add_f32 v246, v246, v247
    v_add_f32 v244, v244, v246
    buffer_store_dword v244, v240, s[8:11], s56 offen sc1
L_nocs_42:
L_auxdone_25:
    s_waitcnt vmcnt(0)
    s_barrier
    s_cmp_lg_u32 s3, 0
    s_cbranch_scc1 L_pskip_43
    v_mov_b32 v240, v4
    s_mov_b32 s32, 0x194e000
    s_lshl_b32 s33, s29, 10
    s_add_u32 s32, s32, s33
    s_mov_b32 s31, 0
L_ploop_44:
    buffer_load_dwordx4 v[244:247], v240, s[8:11], s32 offen sc1
    s_waitcnt vmcnt(0)
    v_xor_b32 v244, s7, v244
    v_xor_b32 v245, s7, v245
    v_xor_b32 v246, s7, v246
    v_xor_b32 v247, s7, v247
    v_or3_b32 v244, v244, v245, v246
    v_or_b32 v244, v244, v247
    v_cmp_ne_u32 vcc, 0, v244
    s_add_u32 s31, s31, 1
    s_cmp_ge_u32 s31, 40000
    s_cbranch_scc1 L_pdone_45
    s_cbranch_vccnz L_ploop_44
L_pdone_45:
L_pskip_43:
    s_waitcnt vmcnt(0)
    s_barrier
    s_cmp_lg_u32 s3, 0
    s_cbranch_scc1 L_sig_46
    s_lshl_b32 s32, s2, 2
    s_add_u32 s32, s32, 0x194a000
    v_lshlrev_b32 v240, 10, v1
    v_mov_b32 v241, s7
    s_mov_b64 exec, 255
    buffer_store_dword v241, v240, s[8:11], s32 offen sc1
    s_mov_b64 exec, -1
L_sig_46:
    s_add_u32 m0, s28, 0
    s_add_u32 s63, s76, 0
    buffer_load_dwordx4 v4, s[8:11], s63 offen sc1 lds
    s_add_u32 m0, s28, 4096
    s_add_u32 s63, s76, 4096
    buffer_load_dwordx4 v4, s[8:11], s63 offen sc1 lds
    s_add_u32 m0, s28, 8192
    s_add_u32 s63, s76, 8192
    buffer_load_dwordx4 v4, s[8:11], s63 offen sc1 lds
    s_add_u32 m0, s28, 12288
    s_add_u32 s63, s76, 12288
    buffer_load_dwordx4 v4, s[8:11], s63 offen sc1 lds
    s_add_u32 m0, s28, 16384
    s_add_u32 s63, s76, 16384
    buffer_load_dwordx4 v4, s[8:11], s63 offen sc1 lds
    s_add_u32 m0, s28, 20480
    s_add_u32 s63, s76, 20480
    buffer_load_dwordx4 v4, s[8:11], s63 offen sc1 lds
    s_add_u32 m0, s28, 24576
    s_add_u32 s63, s76, 24576
    buffer_load_dwordx4 v4, s[8:11], s63 offen sc1 lds
    s_add_u32 m0, s28, 28672
    s_add_u32 s63, s76, 28672
    buffer_load_dwordx4 v4, s[8:11], s63 offen sc1 lds
    s_add_u32 m0, s28, 32768
    s_add_u32 s63, s76, 32768
    buffer_load_dwordx4 v4, s[8:11], s63 offen sc1 lds
    s_add_u32 m0, s28, 36864
    s_add_u32 s63, s76, 36864
    buffer_load_dwordx4 v4, s[8:11], s63 offen sc1 lds
    s_add_u32 m0, s28, 40960
    s_add_u32 s63, s76, 40960
    buffer_load_dwordx4 v4, s[8:11], s63 offen sc1 lds
    s_add_u32 m0, s28, 45056
    s_add_u32 s63, s76, 45056
    buffer_load_dwordx4 v4, s[8:11], s63 offen sc1 lds
    s_add_u32 m0, s28, 49152
    s_add_u32 s63, s76, 49152
    buffer_load_dwordx4 v4, s[8:11], s63 offen sc1 lds
    s_add_u32 m0, s28, 53248
    s_add_u32 s63, s76, 53248
    buffer_load_dwordx4 v4, s[8:11], s63 offen sc1 lds
    s_add_u32 m0, s28, 57344
    s_add_u32 s63, s76, 57344
    buffer_load_dwordx4 v4, s[8:11], s63 offen sc1 lds
    s_add_u32 m0, s28, 61440
    s_add_u32 s63, s76, 61440
    buffer_load_dwordx4 v4, s[8:11], s63 offen sc1 lds
    s_add_u32 m0, s28, 65536
    s_add_u32 s63, s76, 65536
    buffer_load_dwordx4 v4, s[8:11], s63 offen sc1 lds
    s_add_u32 m0, s28, 69632
    s_add_u32 s63, s76, 69632
    buffer_load_dwordx4 v4, s[8:11], s63 offen sc1 lds
    s_add_u32 m0, s28, 73728
    s_add_u32 s63, s76, 73728
    buffer_load_dwordx4 v4, s[8:11], s63 offen sc1 lds
    s_add_u32 m0, s28, 77824
    s_add_u32 s63, s76, 77824
    buffer_load_dwordx4 v4, s[8:11], s63 offen sc1 lds
    s_add_u32 m0, s28, 81920
    s_add_u32 s63, s76, 81920
    buffer_load_dwordx4 v4, s[8:11], s63 offen sc1 lds
    s_add_u32 m0, s28, 86016
    s_add_u32 s63, s76, 86016
    buffer_load_dwordx4 v4, s[8:11], s63 offen sc1 lds
    s_add_u32 m0, s28, 90112
    s_add_u32 s63, s76, 90112
    buffer_load_dwordx4 v4, s[8:11], s63 offen sc1 lds
    s_add_u32 m0, s28, 94208
    s_add_u32 s63, s76, 94208
    buffer_load_dwordx4 v4, s[8:11], s63 offen sc1 lds
    s_add_u32 m0, s28, 98304
    s_add_u32 s63, s76, 98304
    buffer_load_dwordx4 v4, s[8:11], s63 offen sc1 lds
    s_add_u32 m0, s28, 102400
    s_add_u32 s63, s77, 0
    buffer_load_dwordx4 v4, s[8:11], s63 offen sc1 lds
    s_add_u32 m0, s28, 106496
    s_add_u32 s63, s77, 4096
    buffer_load_dwordx4 v4, s[8:11], s63 offen sc1 lds
    s_add_u32 m0, s28, 110592
    s_add_u32 s63, s77, 8192
    buffer_load_dwordx4 v4, s[8:11], s63 offen sc1 lds
    s_add_u32 m0, s28, 114688
    s_add_u32 s63, s77, 12288
    buffer_load_dwordx4 v4, s[8:11], s63 offen sc1 lds
    s_add_u32 m0, s28, 118784
    s_add_u32 s63, s77, 16384
    buffer_load_dwordx4 v4, s[8:11], s63 offen sc1 lds
    s_add_u32 m0, s28, 122880
    s_add_u32 s63, s77, 20480
    buffer_load_dwordx4 v4, s[8:11], s63 offen sc1 lds
    s_add_u32 m0, s28, 126976
    s_add_u32 s63, s77, 24576
    buffer_load_dwordx4 v4, s[8:11], s63 offen sc1 lds
    s_add_u32 m0, s28, 131072
    s_add_u32 s63, s77, 28672
    buffer_load_dwordx4 v4, s[8:11], s63 offen sc1 lds
    s_add_u32 m0, s28, 135168
    s_add_u32 s63, s77, 32768
    buffer_load_dwordx4 v4, s[8:11], s63 offen sc1 lds
    s_add_u32 m0, s28, 139264
    s_add_u32 s63, s77, 36864
    buffer_load_dwordx4 v4, s[8:11], s63 offen sc1 lds
    s_add_u32 m0, s28, 143360
    s_add_u32 s63, s77, 40960
    buffer_load_dwordx4 v4, s[8:11], s63 offen sc1 lds
    s_add_u32 m0, s28, 147456
    s_add_u32 s63, s77, 45056
    buffer_load_dwordx4 v4, s[8:11], s63 offen sc1 lds
    s_sub_u32 s59, s3, 0
    s_min_u32 s59, s59, 1
    s_lshl_b32 s59, s59, 10
    s_sub_u32 s63, s77, s28
    s_add_u32 s63, s63, s59
    s_add_u32 s63, s63, 49152
    s_add_u32 s59, s59, 151552
    s_sub_u32 m0, s59, 153600
    s_cmp_ge_u32 s59, 153600
    s_cselect_b32 m0, m0, s59
    s_nop 0
    buffer_load_dwordx4 v4, s[8:11], s63 offen sc1 lds
L_b1_13:
    v_lshlrev_b32 v176, 3, v2
    v_lshl_add_u32 v176, v3, 8, v176
    s_mul_i32 s34, s6, 20480
    s_add_u32 s34, s34, 0x500000
    v_mov_b32 v152, 0x3f803f80
    v_mov_b32 v153, 0x3f803f80
    v_mov_b32 v154, 0x3f803f80
    v_mov_b32 v155, 0x3f803f80
    s_cmp_lg_u32 s3, 0
    s_cbranch_scc1 L_pskip_47
    v_mov_b32 v240, v4
    s_mov_b32 s32, 0x194a000
    s_lshl_b32 s33, s29, 10
    s_add_u32 s32, s32, s33
    s_mov_b32 s31, 0
L_ploop_48:
    buffer_load_dwordx4 v[244:247], v240, s[8:11], s32 offen sc1
    s_waitcnt vmcnt(0)
    v_xor_b32 v244, s7, v244
    v_xor_b32 v245, s7, v245
    v_xor_b32 v246, s7, v246
    v_xor_b32 v247, s7, v247
    v_or3_b32 v244, v244, v245, v246
    v_or_b32 v244, v244, v247
    v_cmp_ne_u32 vcc, 0, v244
    s_add_u32 s31, s31, 1
    s_cmp_ge_u32 s31, 40000
    s_cbranch_scc1 L_pdone_49
    s_cbranch_vccnz L_ploop_48
L_pdone_49:
L_pskip_47:
    s_waitcnt vmcnt(0)
    s_barrier
    s_add_u32 s35, s34, 0
    buffer_load_dwordx2 a[0:1], v176, s[8:11], s35 offen sc1
    buffer_load_dwordx2 a[2:3], v176, s[8:11], s35 offen offset:128 sc1
    s_add_u32 s35, s34, 1024
    buffer_load_dwordx2 a[4:5], v176, s[8:11], s35 offen sc1
    buffer_load_dwordx2 a[6:7], v176, s[8:11], s35 offen offset:128 sc1
    s_add_u32 s35, s34, 2048
    buffer_load_dwordx2 a[8:9], v176, s[8:11], s35 offen sc1
    buffer_load_dwordx2 a[10:11], v176, s[8:11], s35 offen offset:128 sc1
    s_add_u32 s35, s34, 3072
    buffer_load_dwordx2 a[12:13], v176, s[8:11], s35 offen sc1
    buffer_load_dwordx2 a[14:15], v176, s[8:11], s35 offen offset:128 sc1
    ds_read_b128 v[72:75], v4 offset:0
    ds_read_b128 v[76:79], v4 offset:1024
    ds_read_b128 v[80:83], v4 offset:2048
    ds_read_b128 v[84:87], v4 offset:3072
    ds_read_b128 v[88:91], v4 offset:4096
    ds_read_b128 v[92:95], v4 offset:5120
    ds_read_b128 v[96:99], v4 offset:6144
    ds_read_b128 v[100:103], v4 offset:7168
    ds_read_b128 v[104:107], v4 offset:8192
    ds_read_b128 v[108:111], v4 offset:9216
    s_lshr_b32 s33, s5, 2
    s_add_u32 s33, s33, 1
    s_sub_u32 s41, 0, s33
    s_bitcmp1_b32 s5, 1
    s_cselect_b32 s33, s41, s33
    s_lshl_b32 s41, s6, 4
    s_add_u32 s33, s33, s41
    v_add_u32 v200, s33, v2
    v_lshrrev_b32 v198, 4, v200
    v_mul_u32_u24 v198, 20480, v198
    v_and_b32 v242, 15, v200
    v_lshl_add_u32 v198, v242, 4, v198
    s_mul_i32 s98, s5, 5
    s_and_b32 s99, s98, 1
    s_lshr_b32 s98, s98, 1
    v_and_b32 v194, 1, v3
    v_add_u32 v194, s99, v194
    v_lshlrev_b32 v194, 9, v194
    v_lshrrev_b32 v242, 1, v3
    v_lshl_add_u32 v194, v242, 8, v194
    v_add_u32 v198, v198, v194
    v_mov_b32 v242, 0x7f000000
    v_cmp_gt_u32 vcc, 2048, v200
    s_nop 1
    v_cndmask_b32 v198, v242, v198, vcc
    v_and_b32 v242, 1, v3
    v_mov_b32 v243, 0x7f000000
    v_cmp_eq_u32 vcc, 0, v242
    s_nop 1
    v_cndmask_b32 v195, v243, v198, vcc
    s_lshl_b32 s41, s98, 10
    s_add_u32 s41, s41, 0x0
    s_waitcnt vmcnt(6)
    s_waitcnt lgkmcnt(5)
    v_mfma_f32_16x16x32_bf16 v[32:35], v[72:75], a[0:3], 0
    ds_read_b128 v[112:115], v4 offset:10240
    v_mfma_f32_16x16x32_bf16 v[36:39], v[76:79], a[0:3], 0
    ds_read_b128 v[116:119], v4 offset:11264
    s_add_u32 s35, s34, 4096
    buffer_load_dwordx2 a[16:17], v176, s[8:11], s35 offen sc1
    buffer_load_dwordx2 a[18:19], v176, s[8:11], s35 offen offset:128 sc1
    v_mfma_f32_16x16x32_bf16 v[40:43], v[80:83], a[0:3], 0
    ds_read_b128 v[120:123], v4 offset:12288
    v_mfma_f32_16x16x32_bf16 v[44:47], v[84:87], a[0:3], 0
    ds_read_b128 v[124:127], v4 offset:13312
    s_add_u32 s35, s34, 5120
    buffer_load_dwordx2 a[20:21], v176, s[8:11], s35 offen sc1
    buffer_load_dwordx2 a[22:23], v176, s[8:11], s35 offen offset:128 sc1
    v_mfma_f32_16x16x32_bf16 v[48:51], v[88:91], a[0:3], 0
    ds_read_b128 v[128:131], v4 offset:14336
    v_mfma_f32_16x16x32_bf16 v[136:139], v[152:155], a[0:3], 0
    v_mfma_f32_16x16x32_bf16 v[140:143], a[0:3], a[0:3], 0
    s_waitcnt vmcnt(8)
    s_waitcnt lgkmcnt(5)
    v_mfma_f32_16x16x32_bf16 v[32:35], v[92:95], a[4:7], v[32:35]
    ds_read_b128 v[72:75], v4 offset:15360
    v_mfma_f32_16x16x32_bf16 v[36:39], v[96:99], a[4:7], v[36:39]
    ds_read_b128 v[76:79], v4 offset:16384
    s_add_u32 s35, s34, 6144
    buffer_load_dwordx2 a[24:25], v176, s[8:11], s35 offen sc1
    buffer_load_dwordx2 a[26:27], v176, s[8:11], s35 offen offset:128 sc1
    v_mfma_f32_16x16x32_bf16 v[40:43], v[100:103], a[4:7], v[40:43]
    ds_read_b128 v[80:83], v4 offset:17408
    v_mfma_f32_16x16x32_bf16 v[44:47], v[104:107], a[4:7], v[44:47]
    ds_read_b128 v[84:87], v4 offset:18432
    s_add_u32 s35, s34, 7168
    buffer_load_dwordx2 a[28:29], v176, s[8:11], s35 offen sc1
    buffer_load_dwordx2 a[30:31], v176, s[8:11], s35 offen offset:128 sc1
    v_mfma_f32_16x16x32_bf16 v[48:51], v[108:111], a[4:7], v[48:51]
    ds_read_b128 v[88:91], v4 offset:19456
    v_mfma_f32_16x16x32_bf16 v[136:139], v[152:155], a[4:7], v[136:139]
    v_mfma_f32_16x16x32_bf16 v[140:143], a[4:7], a[4:7], v[140:143]
    s_waitcnt vmcnt(10)
    s_waitcnt lgkmcnt(5)
    v_mfma_f32_16x16x32_bf16 v[32:35], v[112:115], a[8:11], v[32:35]
    ds_read_b128 v[92:95], v4 offset:20480
    v_mfma_f32_16x16x32_bf16 v[36:39], v[116:119], a[8:11], v[36:39]
    ds_read_b128 v[96:99], v4 offset:21504
    s_add_u32 s35, s34, 8192
    buffer_load_dwordx2 a[32:33], v176, s[8:11], s35 offen sc1
    buffer_load_dwordx2 a[34:35], v176, s[8:11], s35 offen offset:128 sc1
    v_mfma_f32_16x16x32_bf16 v[40:43], v[120:123], a[8:11], v[40:43]
    ds_read_b128 v[100:103], v4 offset:22528
    v_mfma_f32_16x16x32_bf16 v[44:47], v[124:127], a[8:11], v[44:47]
    ds_read_b128 v[104:107], v4 offset:23552
    s_add_u32 s35, s34, 9216
    buffer_load_dwordx2 a[36:37], v176, s[8:11], s35 offen sc1
    buffer_load_dwordx2 a[38:39], v176, s[8:11], s35 offen offset:128 sc1
    v_mfma_f32_16x16x32_bf16 v[48:51], v[128:131], a[8:11], v[48:51]
    ds_read_b128 v[108:111], v4 offset:24576
    v_mfma_f32_16x16x32_bf16 v[136:139], v[152:155], a[8:11], v[136:139]
    v_mfma_f32_16x16x32_bf16 v[140:143], a[8:11], a[8:11], v[140:143]
    s_waitcnt vmcnt(12)
    s_waitcnt lgkmcnt(5)
    v_mfma_f32_16x16x32_bf16 v[32:35], v[72:75], a[12:15], v[32:35]
    ds_read_b128 v[112:115], v4 offset:25600
    v_mfma_f32_16x16x32_bf16 v[36:39], v[76:79], a[12:15], v[36:39]
    ds_read_b128 v[116:119], v4 offset:26624
    s_add_u32 s35, s34, 10240
    buffer_load_dwordx2 a[40:41], v176, s[8:11], s35 offen sc1
    buffer_load_dwordx2 a[42:43], v176, s[8:11], s35 offen offset:128 sc1
    v_mfma_f32_16x16x32_bf16 v[40:43], v[80:83], a[12:15], v[40:43]
    ds_read_b128 v[120:123], v4 offset:27648
    v_mfma_f32_16x16x32_bf16 v[44:47], v[84:87], a[12:15], v[44:47]
    ds_read_b128 v[124:127], v4 offset:28672
    s_add_u32 s35, s34, 11264
    buffer_load_dwordx2 a[44:45], v176, s[8:11], s35 offen sc1
    buffer_load_dwordx2 a[46:47], v176, s[8:11], s35 offen offset:128 sc1
    v_mfma_f32_16x16x32_bf16 v[48:51], v[88:91], a[12:15], v[48:51]
    ds_read_b128 v[128:131], v4 offset:29696
    v_mfma_f32_16x16x32_bf16 v[136:139], v[152:155], a[12:15], v[136:139]
    v_mfma_f32_16x16x32_bf16 v[140:143], a[12:15], a[12:15], v[140:143]
    s_waitcnt vmcnt(14)
    s_waitcnt lgkmcnt(5)
    v_mfma_f32_16x16x32_bf16 v[32:35], v[92:95], a[16:19], v[32:35]
    ds_read_b128 v[72:75], v4 offset:30720
    v_mfma_f32_16x16x32_bf16 v[36:39], v[96:99], a[16:19], v[36:39]
    ds_read_b128 v[76:79], v4 offset:31744
    s_add_u32 s35, s34, 12288
    buffer_load_dwordx2 a[48:49], v176, s[8:11], s35 offen sc1
    buffer_load_dwordx2 a[50:51], v176, s[8:11], s35 offen offset:128 sc1
    v_mfma_f32_16x16x32_bf16 v[40:43], v[100:103], a[16:19], v[40:43]
    ds_read_b128 v[80:83], v4 offset:32768
    v_mfma_f32_16x16x32_bf16 v[44:47], v[104:107], a[16:19], v[44:47]
    ds_read_b128 v[84:87], v4 offset:33792
    v_mfma_f32_16x16x32_bf16 v[48:51], v[108:111], a[16:19], v[48:51]
    ds_read_b128 v[88:91], v4 offset:34816
    v_mfma_f32_16x16x32_bf16 v[136:139], v[152:155], a[16:19], v[136:139]
    v_mfma_f32_16x16x32_bf16 v[140:143], a[16:19], a[16:19], v[140:143]
    s_waitcnt vmcnt(14)
    s_waitcnt lgkmcnt(5)
    v_mfma_f32_16x16x32_bf16 v[32:35], v[112:115], a[20:23], v[32:35]
    ds_read_b128 v[92:95], v4 offset:35840
    v_mfma_f32_16x16x32_bf16 v[36:39], v[116:119], a[20:23], v[36:39]
    ds_read_b128 v[96:99], v4 offset:36864
    s_add_u32 s35, s34, 13312
    buffer_load_dwordx2 a[52:53], v176, s[8:11], s35 offen sc1
    buffer_load_dwordx2 a[54:55], v176, s[8:11], s35 offen offset:128 sc1
    v_mfma_f32_16x16x32_bf16 v[40:43], v[120:123], a[20:23], v[40:43]
    ds_read_b128 v[100:103], v4 offset:37888
    v_mfma_f32_16x16x32_bf16 v[44:47], v[124:127], a[20:23], v[44:47]
    ds_read_b128 v[104:107], v4 offset:38912
    v_mfma_f32_16x16x32_bf16 v[48:51], v[128:131], a[20:23], v[48:51]
    ds_read_b128 v[108:111], v4 offset:39936
    v_mfma_f32_16x16x32_bf16 v[136:139], v[152:155], a[20:23], v[136:139]
    v_mfma_f32_16x16x32_bf16 v[140:143], a[20:23], a[20:23], v[140:143]
    s_waitcnt vmcnt(14)
    s_waitcnt lgkmcnt(5)
    v_mfma_f32_16x16x32_bf16 v[32:35], v[72:75], a[24:27], v[32:35]
    ds_read_b128 v[112:115], v4 offset:40960
    v_mfma_f32_16x16x32_bf16 v[36:39], v[76:79], a[24:27], v[36:39]
    ds_read_b128 v[116:119], v4 offset:41984
    s_add_u32 s35, s34, 14336
    buffer_load_dwordx2 a[56:57], v176, s[8:11], s35 offen sc1
    buffer_load_dwordx2 a[58:59], v176, s[8:11], s35 offen offset:128 sc1
    v_mfma_f32_16x16x32_bf16 v[40:43], v[80:83], a[24:27], v[40:43]
    ds_read_b128 v[120:123], v4 offset:43008
    v_mfma_f32_16x16x32_bf16 v[44:47], v[84:87], a[24:27], v[44:47]
    ds_read_b128 v[124:127], v4 offset:44032
    v_mfma_f32_16x16x32_bf16 v[48:51], v[88:91], a[24:27], v[48:51]
    ds_read_b128 v[128:131], v4 offset:45056
    v_mfma_f32_16x16x32_bf16 v[136:139], v[152:155], a[24:27], v[136:139]
    v_mfma_f32_16x16x32_bf16 v[140:143], a[24:27], a[24:27], v[140:143]
    s_waitcnt vmcnt(14)
    s_waitcnt lgkmcnt(5)
    v_mfma_f32_16x16x32_bf16 v[32:35], v[92:95], a[28:31], v[32:35]
    ds_read_b128 v[72:75], v4 offset:46080
    v_mfma_f32_16x16x32_bf16 v[36:39], v[96:99], a[28:31], v[36:39]
    ds_read_b128 v[76:79], v4 offset:47104
    s_add_u32 s35, s34, 15360
    buffer_load_dwordx2 a[60:61], v176, s[8:11], s35 offen sc1
    buffer_load_dwordx2 a[62:63], v176, s[8:11], s35 offen offset:128 sc1
    v_mfma_f32_16x16x32_bf16 v[40:43], v[100:103], a[28:31], v[40:43]
    ds_read_b128 v[80:83], v4 offset:48128
    v_mfma_f32_16x16x32_bf16 v[44:47], v[104:107], a[28:31], v[44:47]
    ds_read_b128 v[84:87], v4 offset:49152
    v_mfma_f32_16x16x32_bf16 v[48:51], v[108:111], a[28:31], v[48:51]
    ds_read_b128 v[88:91], v4 offset:50176
    v_mfma_f32_16x16x32_bf16 v[136:139], v[152:155], a[28:31], v[136:139]
    v_mfma_f32_16x16x32_bf16 v[140:143], a[28:31], a[28:31], v[140:143]
    s_waitcnt vmcnt(14)
    s_waitcnt lgkmcnt(5)
    v_mfma_f32_16x16x32_bf16 v[32:35], v[112:115], a[32:35], v[32:35]
    ds_read_b128 v[92:95], v4 offset:51200
    v_mfma_f32_16x16x32_bf16 v[36:39], v[116:119], a[32:35], v[36:39]
    ds_read_b128 v[96:99], v4 offset:52224
    s_add_u32 s35, s34, 16384
    buffer_load_dwordx2 a[64:65], v176, s[8:11], s35 offen sc1
    buffer_load_dwordx2 a[66:67], v176, s[8:11], s35 offen offset:128 sc1
    v_mfma_f32_16x16x32_bf16 v[40:43], v[120:123], a[32:35], v[40:43]
    ds_read_b128 v[100:103], v4 offset:53248
    v_mfma_f32_16x16x32_bf16 v[44:47], v[124:127], a[32:35], v[44:47]
    ds_read_b128 v[104:107], v4 offset:54272
    v_mfma_f32_16x16x32_bf16 v[48:51], v[128:131], a[32:35], v[48:51]
    ds_read_b128 v[108:111], v4 offset:55296
    v_mfma_f32_16x16x32_bf16 v[136:139], v[152:155], a[32:35], v[136:139]
    v_mfma_f32_16x16x32_bf16 v[140:143], a[32:35], a[32:35], v[140:143]
    s_waitcnt vmcnt(14)
    s_waitcnt lgkmcnt(5)
    v_mfma_f32_16x16x32_bf16 v[32:35], v[72:75], a[36:39], v[32:35]
    ds_read_b128 v[112:115], v4 offset:56320
    v_mfma_f32_16x16x32_bf16 v[36:39], v[76:79], a[36:39], v[36:39]
    ds_read_b128 v[116:119], v4 offset:57344
    s_add_u32 s35, s34, 17408
    buffer_load_dwordx2 a[68:69], v176, s[8:11], s35 offen sc1
    buffer_load_dwordx2 a[70:71], v176, s[8:11], s35 offen offset:128 sc1
    v_mfma_f32_16x16x32_bf16 v[40:43], v[80:83], a[36:39], v[40:43]
    ds_read_b128 v[120:123], v4 offset:58368
    v_mfma_f32_16x16x32_bf16 v[44:47], v[84:87], a[36:39], v[44:47]
    ds_read_b128 v[124:127], v4 offset:59392
    v_mfma_f32_16x16x32_bf16 v[48:51], v[88:91], a[36:39], v[48:51]
    ds_read_b128 v[128:131], v4 offset:60416
    v_mfma_f32_16x16x32_bf16 v[136:139], v[152:155], a[36:39], v[136:139]
    v_mfma_f32_16x16x32_bf16 v[140:143], a[36:39], a[36:39], v[140:143]
    s_waitcnt vmcnt(14)
    s_waitcnt lgkmcnt(5)
    v_mfma_f32_16x16x32_bf16 v[32:35], v[92:95], a[40:43], v[32:35]
    ds_read_b128 v[72:75], v4 offset:61440
    v_mfma_f32_16x16x32_bf16 v[36:39], v[96:99], a[40:43], v[36:39]
    ds_read_b128 v[76:79], v4 offset:62464
    s_add_u32 s35, s34, 18432
    buffer_load_dwordx2 a[72:73], v176, s[8:11], s35 offen sc1
    buffer_load_dwordx2 a[74:75], v176, s[8:11], s35 offen offset:128 sc1
    v_mfma_f32_16x16x32_bf16 v[40:43], v[100:103], a[40:43], v[40:43]
    ds_read_b128 v[80:83], v4 offset:63488
    v_mfma_f32_16x16x32_bf16 v[44:47], v[104:107], a[40:43], v[44:47]
    ds_read_b128 v[84:87], v4 offset:64512
    v_mfma_f32_16x16x32_bf16 v[48:51], v[108:111], a[40:43], v[48:51]
    ds_read_b128 v[88:91], v5 offset:0
    v_mfma_f32_16x16x32_bf16 v[136:139], v[152:155], a[40:43], v[136:139]
    v_mfma_f32_16x16x32_bf16 v[140:143], a[40:43], a[40:43], v[140:143]
    s_waitcnt vmcnt(14)
    s_waitcnt lgkmcnt(5)
    v_mfma_f32_16x16x32_bf16 v[32:35], v[112:115], a[44:47], v[32:35]
    ds_read_b128 v[92:95], v5 offset:1024
    v_mfma_f32_16x16x32_bf16 v[36:39], v[116:119], a[44:47], v[36:39]
    ds_read_b128 v[96:99], v5 offset:2048
    s_add_u32 s35, s34, 19456
    buffer_load_dwordx2 a[76:77], v176, s[8:11], s35 offen sc1
    buffer_load_dwordx2 a[78:79], v176, s[8:11], s35 offen offset:128 sc1
    v_mfma_f32_16x16x32_bf16 v[40:43], v[120:123], a[44:47], v[40:43]
    ds_read_b128 v[100:103], v5 offset:3072
    v_mfma_f32_16x16x32_bf16 v[44:47], v[124:127], a[44:47], v[44:47]
    ds_read_b128 v[104:107], v5 offset:4096
    v_mfma_f32_16x16x32_bf16 v[48:51], v[128:131], a[44:47], v[48:51]
    ds_read_b128 v[108:111], v5 offset:5120
    v_mfma_f32_16x16x32_bf16 v[136:139], v[152:155], a[44:47], v[136:139]
    v_mfma_f32_16x16x32_bf16 v[140:143], a[44:47], a[44:47], v[140:143]
    s_waitcnt vmcnt(14)
    s_waitcnt lgkmcnt(5)
    v_mfma_f32_16x16x32_bf16 v[32:35], v[72:75], a[48:51], v[32:35]
    ds_read_b128 v[112:115], v5 offset:6144
    v_mfma_f32_16x16x32_bf16 v[36:39], v[76:79], a[48:51], v[36:39]
    ds_read_b128 v[116:119], v5 offset:7168
    v_mfma_f32_16x16x32_bf16 v[40:43], v[80:83], a[48:51], v[40:43]
    ds_read_b128 v[120:123], v5 offset:8192
    v_mfma_f32_16x16x32_bf16 v[44:47], v[84:87], a[48:51], v[44:47]
    ds_read_b128 v[124:127], v5 offset:9216
    v_mfma_f32_16x16x32_bf16 v[48:51], v[88:91], a[48:51], v[48:51]
    ds_read_b128 v[128:131], v5 offset:10240
    v_mfma_f32_16x16x32_bf16 v[136:139], v[152:155], a[48:51], v[136:139]
    v_mfma_f32_16x16x32_bf16 v[140:143], a[48:51], a[48:51], v[140:143]
    s_waitcnt vmcnt(12)
    s_waitcnt lgkmcnt(5)
    v_mfma_f32_16x16x32_bf16 v[32:35], v[92:95], a[52:55], v[32:35]
    ds_read_b128 v[72:75], v5 offset:11264
    v_mfma_f32_16x16x32_bf16 v[36:39], v[96:99], a[52:55], v[36:39]
    ds_read_b128 v[76:79], v5 offset:12288
    v_mfma_f32_16x16x32_bf16 v[40:43], v[100:103], a[52:55], v[40:43]
    ds_read_b128 v[80:83], v5 offset:13312
    v_mfma_f32_16x16x32_bf16 v[44:47], v[104:107], a[52:55], v[44:47]
    ds_read_b128 v[84:87], v5 offset:14336
    v_mfma_f32_16x16x32_bf16 v[48:51], v[108:111], a[52:55], v[48:51]
    ds_read_b128 v[88:91], v5 offset:15360
    v_mfma_f32_16x16x32_bf16 v[136:139], v[152:155], a[52:55], v[136:139]
    v_mfma_f32_16x16x32_bf16 v[140:143], a[52:55], a[52:55], v[140:143]
    s_waitcnt vmcnt(10)
    s_waitcnt lgkmcnt(5)
    v_mfma_f32_16x16x32_bf16 v[32:35], v[112:115], a[56:59], v[32:35]
    ds_read_b128 v[92:95], v5 offset:16384
    v_mfma_f32_16x16x32_bf16 v[36:39], v[116:119], a[56:59], v[36:39]
    ds_read_b128 v[96:99], v5 offset:17408
    v_mfma_f32_16x16x32_bf16 v[40:43], v[120:123], a[56:59], v[40:43]
    ds_read_b128 v[100:103], v5 offset:18432
    v_mfma_f32_16x16x32_bf16 v[44:47], v[124:127], a[56:59], v[44:47]
    ds_read_b128 v[104:107], v5 offset:19456
    v_mfma_f32_16x16x32_bf16 v[48:51], v[128:131], a[56:59], v[48:51]
    ds_read_b128 v[108:111], v5 offset:20480
    v_mfma_f32_16x16x32_bf16 v[136:139], v[152:155], a[56:59], v[136:139]
    v_mfma_f32_16x16x32_bf16 v[140:143], a[56:59], a[56:59], v[140:143]
    v_lshlrev_b32 v241, 4, v3
    s_mul_i32 s35, s5, 320
    s_add_u32 s35, s35, 0x1944000
    buffer_load_dwordx4 v[156:159], v241, s[8:11], s35 offen offset:0 sc1
    buffer_load_dwordx4 v[160:163], v241, s[8:11], s35 offen offset:64 sc1
    buffer_load_dwordx4 v[164:167], v241, s[8:11], s35 offen offset:128 sc1
    buffer_load_dwordx4 v[168:171], v241, s[8:11], s35 offen offset:192 sc1
    buffer_load_dwordx4 v[172:175], v241, s[8:11], s35 offen offset:256 sc1
    s_waitcnt vmcnt(13)
    s_waitcnt lgkmcnt(5)
    v_mfma_f32_16x16x32_bf16 v[32:35], v[72:75], a[60:63], v[32:35]
    ds_read_b128 v[112:115], v5 offset:21504
    v_mfma_f32_16x16x32_bf16 v[36:39], v[76:79], a[60:63], v[36:39]
    ds_read_b128 v[116:119], v5 offset:22528
    v_mfma_f32_16x16x32_bf16 v[40:43], v[80:83], a[60:63], v[40:43]
    ds_read_b128 v[120:123], v5 offset:23552
    v_mfma_f32_16x16x32_bf16 v[44:47], v[84:87], a[60:63], v[44:47]
    ds_read_b128 v[124:127], v5 offset:24576
    v_mfma_f32_16x16x32_bf16 v[48:51], v[88:91], a[60:63], v[48:51]
    ds_read_b128 v[128:131], v5 offset:25600
    v_mfma_f32_16x16x32_bf16 v[136:139], v[152:155], a[60:63], v[136:139]
    v_mfma_f32_16x16x32_bf16 v[140:143], a[60:63], a[60:63], v[140:143]
    s_waitcnt vmcnt(11)
    s_waitcnt lgkmcnt(5)
    v_mfma_f32_16x16x32_bf16 v[32:35], v[92:95], a[64:67], v[32:35]
    ds_read_b128 v[72:75], v5 offset:26624
    v_mfma_f32_16x16x32_bf16 v[36:39], v[96:99], a[64:67], v[36:39]
    ds_read_b128 v[76:79], v5 offset:27648
    v_mfma_f32_16x16x32_bf16 v[40:43], v[100:103], a[64:67], v[40:43]
    ds_read_b128 v[80:83], v5 offset:28672
    v_mfma_f32_16x16x32_bf16 v[44:47], v[104:107], a[64:67], v[44:47]
    ds_read_b128 v[84:87], v5 offset:29696
    v_mfma_f32_16x16x32_bf16 v[48:51], v[108:111], a[64:67], v[48:51]
    ds_read_b128 v[88:91], v5 offset:30720
    v_mfma_f32_16x16x32_bf16 v[136:139], v[152:155], a[64:67], v[136:139]
    v_mfma_f32_16x16x32_bf16 v[140:143], a[64:67], a[64:67], v[140:143]
    s_waitcnt vmcnt(9)
    s_waitcnt lgkmcnt(5)
    v_mfma_f32_16x16x32_bf16 v[32:35], v[112:115], a[68:71], v[32:35]
    ds_read_b128 v[92:95], v5 offset:31744
    v_mfma_f32_16x16x32_bf16 v[36:39], v[116:119], a[68:71], v[36:39]
    ds_read_b128 v[96:99], v5 offset:32768
    v_mfma_f32_16x16x32_bf16 v[40:43], v[120:123], a[68:71], v[40:43]
    ds_read_b128 v[100:103], v5 offset:33792
    v_mfma_f32_16x16x32_bf16 v[44:47], v[124:127], a[68:71], v[44:47]
    ds_read_b128 v[104:107], v5 offset:34816
    v_mfma_f32_16x16x32_bf16 v[48:51], v[128:131], a[68:71], v[48:51]
    ds_read_b128 v[108:111], v5 offset:35840
    v_mfma_f32_16x16x32_bf16 v[136:139], v[152:155], a[68:71], v[136:139]
    v_mfma_f32_16x16x32_bf16 v[140:143], a[68:71], a[68:71], v[140:143]
    s_waitcnt vmcnt(7)
    s_waitcnt lgkmcnt(5)
    v_mfma_f32_16x16x32_bf16 v[32:35], v[72:75], a[72:75], v[32:35]
    v_mfma_f32_16x16x32_bf16 v[36:39], v[76:79], a[72:75], v[36:39]
    v_mfma_f32_16x16x32_bf16 v[40:43], v[80:83], a[72:75], v[40:43]
    v_mfma_f32_16x16x32_bf16 v[44:47], v[84:87], a[72:75], v[44:47]
    v_mfma_f32_16x16x32_bf16 v[48:51], v[88:91], a[72:75], v[48:51]
    v_mfma_f32_16x16x32_bf16 v[136:139], v[152:155], a[72:75], v[136:139]
    v_mfma_f32_16x16x32_bf16 v[140:143], a[72:75], a[72:75], v[140:143]
    s_waitcnt vmcnt(5)
    s_waitcnt lgkmcnt(0)
    v_mfma_f32_16x16x32_bf16 v[32:35], v[92:95], a[76:79], v[32:35]
    v_mfma_f32_16x16x32_bf16 v[36:39], v[96:99], a[76:79], v[36:39]
    v_mfma_f32_16x16x32_bf16 v[40:43], v[100:103], a[76:79], v[40:43]
    v_mfma_f32_16x16x32_bf16 v[44:47], v[104:107], a[76:79], v[44:47]
    v_mfma_f32_16x16x32_bf16 v[48:51], v[108:111], a[76:79], v[48:51]
    v_mfma_f32_16x16x32_bf16 v[136:139], v[152:155], a[76:79], v[136:139]
    v_mfma_f32_16x16x32_bf16 v[140:143], a[76:79], a[76:79], v[140:143]
    s_nop 6
    v_mul_f32 v8, 0x3acccccd, v136
    v_and_b32 v240, 3, v2
    v_mov_b32 v241, v140
    v_cmp_eq_u32 vcc, 1, v240
    s_nop 1
    v_cndmask_b32 v241, v241, v141, vcc
    v_cmp_eq_u32 vcc, 2, v240
    s_nop 1
    v_cndmask_b32 v241, v241, v142, vcc
    v_cmp_eq_u32 vcc, 3, v240
    s_nop 1
    v_cndmask_b32 v241, v241, v143, vcc
    v_lshrrev_b32 v242, 2, v2
    v_cmp_eq_u32 vcc, v242, v3
    s_nop 1
    v_cndmask_b32 v241, 0, v241, vcc
    v_mov_b32 v242, v241
    s_nop 1
    v_permlane32_swap_b32 v241, v242
    v_add_f32 v241, v241, v242
    v_mov_b32 v242, v241
    s_nop 1
    v_permlane16_swap_b32 v241, v242
    v_add_f32 v241, v241, v242
    v_mul_f32 v241, 0x3acccccd, v241
    v_fma_f32 v241, -v8, v8, v241
    v_max_f32 v241, 0, v241
    v_add_f32 v242, 0x3727c5ac, v241
    v_rsq_f32 v9, v242
    s_nop 0
    v_mul_f32 v241, v241, v9
    v_mul_f32 v241, v241, v9
    v_add_f32 v241, 0x3727c5ac, v241
    v_rsq_f32 v241, v241
    s_nop 0
    v_mul_f32 v178, v241, v9
    v_rcp_f32 v179, v178
    v_sub_f32 v180, 0, v8
    v_mul_f32 v181, 0xc0135761, v178
    v_mul_f32 v242, v178, v178
    v_mul_f32 v92, 0xbdd2d3e8, v178
    v_mul_f32 v92, v92, v242
    v_mov_b32 v93, v179
    s_waitcnt vmcnt(0)
    v_pk_fma_f32 v[32:33], v[156:157], v[180:181], v[32:33] op_sel_hi:[1,0,1]
    v_pk_fma_f32 v[34:35], v[158:159], v[180:181], v[34:35] op_sel_hi:[1,0,1]
    v_pk_fma_f32 v[36:37], v[160:161], v[180:181], v[36:37] op_sel_hi:[1,0,1]
    v_pk_fma_f32 v[38:39], v[162:163], v[180:181], v[38:39] op_sel_hi:[1,0,1]
    v_pk_fma_f32 v[40:41], v[164:165], v[180:181], v[40:41] op_sel_hi:[1,0,1]
    v_pk_mul_f32 v[72:73], v[32:33], v[32:33]
    v_pk_mul_f32 v[76:77], v[34:35], v[34:35]
    v_pk_mul_f32 v[80:81], v[36:37], v[36:37]
    v_pk_mul_f32 v[84:85], v[38:39], v[38:39]
    v_pk_mul_f32 v[88:89], v[40:41], v[40:41]
    v_pk_fma_f32 v[72:73], v[72:73], v[92:93], v[180:181] op_sel:[0,0,1] op_sel_hi:[1,0,1]
    v_pk_fma_f32 v[76:77], v[76:77], v[92:93], v[180:181] op_sel:[0,0,1] op_sel_hi:[1,0,1]
    v_pk_fma_f32 v[80:81], v[80:81], v[92:93], v[180:181] op_sel:[0,0,1] op_sel_hi:[1,0,1]
    v_pk_fma_f32 v[84:85], v[84:85], v[92:93], v[180:181] op_sel:[0,0,1] op_sel_hi:[1,0,1]
    v_pk_fma_f32 v[88:89], v[88:89], v[92:93], v[180:181] op_sel:[0,0,1] op_sel_hi:[1,0,1]
    v_pk_mul_f32 v[72:73], v[72:73], v[32:33]
    v_pk_mul_f32 v[76:77], v[76:77], v[34:35]
    v_pk_mul_f32 v[80:81], v[80:81], v[36:37]
    v_pk_mul_f32 v[84:85], v[84:85], v[38:39]
    v_pk_mul_f32 v[88:89], v[88:89], v[40:41]
    v_exp_f32 v74, v72
    v_exp_f32 v75, v73
    v_exp_f32 v78, v76
    v_exp_f32 v79, v77
    v_exp_f32 v82, v80
    v_exp_f32 v83, v81
    v_exp_f32 v86, v84
    v_exp_f32 v87, v85
    v_exp_f32 v90, v88
    v_exp_f32 v91, v89
    v_pk_fma_f32 v[74:75], v[74:75], v[92:93], v[92:93] op_sel:[0,1,1] op_sel_hi:[1,1,1]
    v_pk_fma_f32 v[78:79], v[78:79], v[92:93], v[92:93] op_sel:[0,1,1] op_sel_hi:[1,1,1]
    v_pk_fma_f32 v[82:83], v[82:83], v[92:93], v[92:93] op_sel:[0,1,1] op_sel_hi:[1,1,1]
    v_pk_fma_f32 v[86:87], v[86:87], v[92:93], v[92:93] op_sel:[0,1,1] op_sel_hi:[1,1,1]
    v_pk_fma_f32 v[90:91], v[90:91], v[92:93], v[92:93] op_sel:[0,1,1] op_sel_hi:[1,1,1]
    v_rcp_f32 v72, v74
    v_rcp_f32 v73, v75
    v_rcp_f32 v76, v78
    v_rcp_f32 v77, v79
    v_rcp_f32 v80, v82
    v_rcp_f32 v81, v83
    v_rcp_f32 v84, v86
    v_rcp_f32 v85, v87
    v_rcp_f32 v88, v90
    v_rcp_f32 v89, v91
    v_pk_mul_f32 v[32:33], v[32:33], v[72:73]
    v_pk_mul_f32 v[34:35], v[34:35], v[76:77]
    v_pk_mul_f32 v[36:37], v[36:37], v[80:81]
    v_pk_mul_f32 v[38:39], v[38:39], v[84:85]
    v_pk_mul_f32 v[40:41], v[40:41], v[88:89]
    v_pk_fma_f32 v[42:43], v[166:167], v[180:181], v[42:43] op_sel_hi:[1,0,1]
    v_pk_fma_f32 v[44:45], v[168:169], v[180:181], v[44:45] op_sel_hi:[1,0,1]
    v_pk_fma_f32 v[46:47], v[170:171], v[180:181], v[46:47] op_sel_hi:[1,0,1]
    v_pk_fma_f32 v[48:49], v[172:173], v[180:181], v[48:49] op_sel_hi:[1,0,1]
    v_pk_fma_f32 v[50:51], v[174:175], v[180:181], v[50:51] op_sel_hi:[1,0,1]
    v_pk_mul_f32 v[72:73], v[42:43], v[42:43]
    v_pk_mul_f32 v[76:77], v[44:45], v[44:45]
    v_pk_mul_f32 v[80:81], v[46:47], v[46:47]
    v_pk_mul_f32 v[84:85], v[48:49], v[48:49]
    v_pk_mul_f32 v[88:89], v[50:51], v[50:51]
    v_pk_fma_f32 v[72:73], v[72:73], v[92:93], v[180:181] op_sel:[0,0,1] op_sel_hi:[1,0,1]
    v_pk_fma_f32 v[76:77], v[76:77], v[92:93], v[180:181] op_sel:[0,0,1] op_sel_hi:[1,0,1]
    v_pk_fma_f32 v[80:81], v[80:81], v[92:93], v[180:181] op_sel:[0,0,1] op_sel_hi:[1,0,1]
    v_pk_fma_f32 v[84:85], v[84:85], v[92:93], v[180:181] op_sel:[0,0,1] op_sel_hi:[1,0,1]
    v_pk_fma_f32 v[88:89], v[88:89], v[92:93], v[180:181] op_sel:[0,0,1] op_sel_hi:[1,0,1]
    v_pk_mul_f32 v[72:73], v[72:73], v[42:43]
    v_pk_mul_f32 v[76:77], v[76:77], v[44:45]
    v_pk_mul_f32 v[80:81], v[80:81], v[46:47]
    v_pk_mul_f32 v[84:85], v[84:85], v[48:49]
    v_pk_mul_f32 v[88:89], v[88:89], v[50:51]
    v_exp_f32 v74, v72
    v_exp_f32 v75, v73
    v_exp_f32 v78, v76
    v_exp_f32 v79, v77
    v_exp_f32 v82, v80
    v_exp_f32 v83, v81
    v_exp_f32 v86, v84
    v_exp_f32 v87, v85
    v_exp_f32 v90, v88
    v_exp_f32 v91, v89
    v_pk_fma_f32 v[74:75], v[74:75], v[92:93], v[92:93] op_sel:[0,1,1] op_sel_hi:[1,1,1]
    v_pk_fma_f32 v[78:79], v[78:79], v[92:93], v[92:93] op_sel:[0,1,1] op_sel_hi:[1,1,1]
    v_pk_fma_f32 v[82:83], v[82:83], v[92:93], v[92:93] op_sel:[0,1,1] op_sel_hi:[1,1,1]
    v_pk_fma_f32 v[86:87], v[86:87], v[92:93], v[92:93] op_sel:[0,1,1] op_sel_hi:[1,1,1]
    v_pk_fma_f32 v[90:91], v[90:91], v[92:93], v[92:93] op_sel:[0,1,1] op_sel_hi:[1,1,1]
    v_rcp_f32 v72, v74
    v_rcp_f32 v73, v75
    v_rcp_f32 v76, v78
    v_rcp_f32 v77, v79
    v_rcp_f32 v80, v82
    v_rcp_f32 v81, v83
    v_rcp_f32 v84, v86
    v_rcp_f32 v85, v87
    v_rcp_f32 v88, v90
    v_rcp_f32 v89, v91
    v_pk_mul_f32 v[42:43], v[42:43], v[72:73]
    v_pk_mul_f32 v[44:45], v[44:45], v[76:77]
    v_pk_mul_f32 v[46:47], v[46:47], v[80:81]
    v_pk_mul_f32 v[48:49], v[48:49], v[84:85]
    v_pk_mul_f32 v[50:51], v[50:51], v[88:89]
    v_cvt_pk_bf16_f32 v182, v32, v33
    v_cvt_pk_bf16_f32 v183, v34, v35
    v_cvt_pk_bf16_f32 v184, v36, v37
    v_cvt_pk_bf16_f32 v185, v38, v39
    v_cvt_pk_bf16_f32 v186, v40, v41
    v_cvt_pk_bf16_f32 v187, v42, v43
    v_cvt_pk_bf16_f32 v188, v44, v45
    v_cvt_pk_bf16_f32 v189, v46, v47
    v_cvt_pk_bf16_f32 v190, v48, v49
    v_cvt_pk_bf16_f32 v191, v50, v51
    v_permlane16_swap_b32 v182, v184
    v_permlane16_swap_b32 v183, v185
    v_permlane16_swap_b32 v186, v188
    v_permlane16_swap_b32 v187, v189
    v_permlane16_swap_b32 v190, v192
    v_permlane16_swap_b32 v191, v193
    buffer_store_dwordx4 v[182:185], v198, s[8:11], s41 offen offset:0 sc1
    buffer_store_dwordx4 v[186:189], v198, s[8:11], s41 offen offset:1024 sc1
    buffer_store_dwordx4 v[190:193], v195, s[8:11], s41 offen offset:2048 sc1
    s_cmp_eq_u32 s4, 0
    s_cselect_b32 s35, 1, 0
    s_cmp_eq_u32 s4, 31
    s_cselect_b32 s35, 1, s35
    s_cmp_eq_u32 s35, 0
    s_cbranch_scc1 L_nz_50
    s_lshl_b32 s35, s6, 4
    v_add_u32 v196, s35, v2
    v_lshlrev_b32 v197, 1, v196
    v_sub_u32 v197, v197, v200
    v_lshrrev_b32 v241, 4, v196
    v_mul_u32_u24 v241, 20480, v241
    v_and_b32 v196, 15, v196
    v_lshl_add_u32 v241, v196, 4, v241
    v_add_u32 v241, v241, v194
    v_mov_b32 v196, 0x7f000000
    v_cmp_gt_u32 vcc, 2048, v197
    s_nop 1
    v_cndmask_b32 v241, v241, v196, vcc
    v_and_b32 v242, 1, v3
    v_mov_b32 v243, 0x7f000000
    v_cmp_eq_u32 vcc, 0, v242
    s_nop 1
    v_cndmask_b32 v195, v243, v241, vcc
    v_mov_b32 v72, 0
    v_mov_b32 v73, 0
    v_mov_b32 v74, 0
    v_mov_b32 v75, 0
    buffer_store_dwordx4 v[72:75], v241, s[8:11], s41 offen offset:0 sc1
    buffer_store_dwordx4 v[72:75], v241, s[8:11], s41 offen offset:1024 sc1
    buffer_store_dwordx4 v[72:75], v195, s[8:11], s41 offen offset:2048 sc1
L_nz_50:
    s_waitcnt vmcnt(0)
    s_barrier
    s_cmp_lg_u32 s3, 0
    s_cbranch_scc1 L_sig_51
    s_lshl_b32 s32, s95, 2
    s_add_u32 s32, s32, 0x194c000
    v_lshlrev_b32 v240, 10, v1
    v_mov_b32 v241, s7
    s_mov_b64 exec, 1
    buffer_store_dword v241, v240, s[8:11], s32 offen sc1
    s_mov_b64 exec, -1
L_sig_51:
    s_add_u32 m0, s28, 0
    s_add_u32 s63, s77, 51200
    buffer_load_dwordx4 v4, s[8:11], s63 offen sc1 lds
    s_add_u32 m0, s28, 4096
    s_add_u32 s63, s77, 55296
    buffer_load_dwordx4 v4, s[8:11], s63 offen sc1 lds
    s_add_u32 m0, s28, 8192
    s_add_u32 s63, s77, 59392
    buffer_load_dwordx4 v4, s[8:11], s63 offen sc1 lds
    s_add_u32 m0, s28, 12288
    s_add_u32 s63, s77, 63488
    buffer_load_dwordx4 v4, s[8:11], s63 offen sc1 lds
    s_add_u32 m0, s28, 16384
    s_add_u32 s63, s77, 67584
    buffer_load_dwordx4 v4, s[8:11], s63 offen sc1 lds
    s_add_u32 m0, s28, 20480
    s_add_u32 s63, s77, 71680
    buffer_load_dwordx4 v4, s[8:11], s63 offen sc1 lds
    s_add_u32 m0, s28, 24576
    s_add_u32 s63, s77, 75776
    buffer_load_dwordx4 v4, s[8:11], s63 offen sc1 lds
    s_add_u32 m0, s28, 28672
    s_add_u32 s63, s77, 79872
    buffer_load_dwordx4 v4, s[8:11], s63 offen sc1 lds
    s_add_u32 m0, s28, 32768
    s_add_u32 s63, s77, 83968
    buffer_load_dwordx4 v4, s[8:11], s63 offen sc1 lds
    s_add_u32 m0, s28, 36864
    s_add_u32 s63, s77, 88064
    buffer_load_dwordx4 v4, s[8:11], s63 offen sc1 lds
    s_add_u32 m0, s28, 40960
    s_add_u32 s63, s77, 92160
    buffer_load_dwordx4 v4, s[8:11], s63 offen sc1 lds
    s_add_u32 m0, s28, 45056
    s_add_u32 s63, s77, 96256
    buffer_load_dwordx4 v4, s[8:11], s63 offen sc1 lds
    s_sub_u32 s59, s3, 0
    s_min_u32 s59, s59, 1
    s_lshl_b32 s59, s59, 10
    s_sub_u32 s63, s77, s28
    s_add_u32 s63, s63, s59
    s_add_u32 s63, s63, 100352
    s_add_u32 s59, s59, 49152
    s_sub_u32 m0, s59, 153600
    s_cmp_ge_u32 s59, 153600
    s_cselect_b32 m0, m0, s59
    s_nop 0
    buffer_load_dwordx4 v4, s[8:11], s63 offen sc1 lds
    s_sub_u32 s40, s4, 1
    s_max_i32 s40, s40, 0
    s_add_u32 s41, s4, 2
    s_min_u32 s41, s41, 32
    s_sub_u32 s41, s41, s40
    s_lshl_b32 s40, s40, 3
    s_lshl_b32 s41, s41, 3
    s_mul_i32 s42, s6, 20480
    s_add_u32 s34, s42, 0x0
    s_cmp_lg_u32 s3, 0
    s_cbranch_scc1 L_pskip_52
    s_sub_u32 s33, s41, 1
    v_min_u32 v240, s33, v1
    v_add_u32 v240, s40, v240
    v_lshlrev_b32 v240, 2, v240
    s_mov_b32 s32, 0x194c000
    s_mov_b32 s31, 0
L_ploop_53:
    buffer_load_dword v244, v240, s[8:11], s32 offen sc1
    s_waitcnt vmcnt(0)
    v_cmp_ne_u32 vcc, s7, v244
    s_add_u32 s31, s31, 1
    s_cmp_ge_u32 s31, 40000
    s_cbranch_scc1 L_pdone_54
    s_cbranch_vccnz L_ploop_53
L_pdone_54:
L_pskip_52:
    s_waitcnt vmcnt(0)
    s_barrier
    s_add_u32 s35, s34, 0
    buffer_load_dwordx4 a[0:3], v4, s[8:11], s35 offen sc1
    s_add_u32 s35, s34, 1024
    buffer_load_dwordx4 a[4:7], v4, s[8:11], s35 offen sc1
    s_add_u32 s35, s34, 2048
    buffer_load_dwordx4 a[8:11], v4, s[8:11], s35 offen sc1
    s_add_u32 s35, s34, 3072
    buffer_load_dwordx4 a[12:15], v4, s[8:11], s35 offen sc1
    s_add_u32 s35, s34, 4096
    buffer_load_dwordx4 a[16:19], v4, s[8:11], s35 offen sc1
    s_add_u32 s35, s34, 5120
    buffer_load_dwordx4 a[20:23], v4, s[8:11], s35 offen sc1
    s_add_u32 s35, s34, 6144
    buffer_load_dwordx4 a[24:27], v4, s[8:11], s35 offen sc1
    s_add_u32 s35, s34, 7168
    buffer_load_dwordx4 a[28:31], v4, s[8:11], s35 offen sc1
    ds_read_b128 v[72:75], v5 offset:36864
    ds_read_b128 v[76:79], v5 offset:37888
    ds_read_b128 v[80:83], v5 offset:38912
    ds_read_b128 v[84:87], v5 offset:39936
    ds_read_b128 v[88:91], v5 offset:40960
    ds_read_b128 v[92:95], v5 offset:41984
    ds_read_b128 v[96:99], v5 offset:43008
    ds_read_b128 v[100:103], v5 offset:44032
    ds_read_b128 v[104:107], v5 offset:45056
    ds_read_b128 v[108:111], v5 offset:46080
    s_lshl_b32 s43, s98, 10
    s_add_u32 s43, s43, s42
    s_add_u32 s43, s43, 0x280000
    v_and_b32 v172, 1, v3
    v_add_u32 v172, s99, v172
    v_lshlrev_b32 v172, 9, v172
    v_lshrrev_b32 v242, 1, v3
    v_lshl_add_u32 v172, v242, 8, v172
    v_lshl_add_u32 v172, v2, 4, v172
    v_and_b32 v242, 1, v3
    v_mov_b32 v243, 0x7f000000
    v_cmp_eq_u32 vcc, 0, v242
    s_nop 1
    v_cndmask_b32 v173, v243, v172, vcc
    v_lshlrev_b32 v174, 3, v2
    s_lshl_b32 s44, s6, 7
    s_lshl_b32 s35, s5, 14
    s_add_u32 s44, s44, s35
    s_add_u32 s44, s44, 0x1924000
    s_waitcnt vmcnt(7)
    s_waitcnt lgkmcnt(5)
    v_mfma_f32_16x16x32_bf16 v[32:35], v[72:75], a[0:3], 0
    ds_read_b128 v[112:115], v5 offset:47104
    v_mfma_f32_16x16x32_bf16 v[36:39], v[76:79], a[0:3], 0
    ds_read_b128 v[116:119], v5 offset:48128
    s_add_u32 s35, s34, 8192
    buffer_load_dwordx4 a[32:35], v4, s[8:11], s35 offen sc1
    v_mfma_f32_16x16x32_bf16 v[40:43], v[80:83], a[0:3], 0
    ds_read_b128 v[120:123], v5 offset:49152
    v_mfma_f32_16x16x32_bf16 v[44:47], v[84:87], a[0:3], 0
    ds_read_b128 v[124:127], v5 offset:50176
    s_add_u32 s35, s34, 9216
    buffer_load_dwordx4 a[36:39], v4, s[8:11], s35 offen sc1
    v_mfma_f32_16x16x32_bf16 v[48:51], v[88:91], a[0:3], 0
    ds_read_b128 v[128:131], v5 offset:51200
    s_waitcnt vmcnt(8)
    s_waitcnt lgkmcnt(5)
    v_mfma_f32_16x16x32_bf16 v[32:35], v[92:95], a[4:7], v[32:35]
    ds_read_b128 v[72:75], v5 offset:52224
    v_mfma_f32_16x16x32_bf16 v[36:39], v[96:99], a[4:7], v[36:39]
    ds_read_b128 v[76:79], v5 offset:53248
    s_add_u32 s35, s34, 10240
    buffer_load_dwordx4 a[40:43], v4, s[8:11], s35 offen sc1
    v_mfma_f32_16x16x32_bf16 v[40:43], v[100:103], a[4:7], v[40:43]
    ds_read_b128 v[80:83], v5 offset:54272
    v_mfma_f32_16x16x32_bf16 v[44:47], v[104:107], a[4:7], v[44:47]
    ds_read_b128 v[84:87], v5 offset:55296
    s_add_u32 s35, s34, 11264
    buffer_load_dwordx4 a[44:47], v4, s[8:11], s35 offen sc1
    v_mfma_f32_16x16x32_bf16 v[48:51], v[108:111], a[4:7], v[48:51]
    ds_read_b128 v[88:91], v5 offset:56320
    s_waitcnt vmcnt(9)
    s_waitcnt lgkmcnt(5)
    v_mfma_f32_16x16x32_bf16 v[32:35], v[112:115], a[8:11], v[32:35]
    ds_read_b128 v[92:95], v5 offset:57344
    v_mfma_f32_16x16x32_bf16 v[36:39], v[116:119], a[8:11], v[36:39]
    ds_read_b128 v[96:99], v5 offset:58368
    s_add_u32 s35, s34, 12288
    buffer_load_dwordx4 a[48:51], v4, s[8:11], s35 offen sc1
    v_mfma_f32_16x16x32_bf16 v[40:43], v[120:123], a[8:11], v[40:43]
    ds_read_b128 v[100:103], v5 offset:59392
    v_mfma_f32_16x16x32_bf16 v[44:47], v[124:127], a[8:11], v[44:47]
    ds_read_b128 v[104:107], v5 offset:60416
    s_add_u32 s35, s34, 13312
    buffer_load_dwordx4 a[52:55], v4, s[8:11], s35 offen sc1
    v_mfma_f32_16x16x32_bf16 v[48:51], v[128:131], a[8:11], v[48:51]
    ds_read_b128 v[108:111], v5 offset:61440
    s_waitcnt vmcnt(10)
    s_waitcnt lgkmcnt(5)
    v_mfma_f32_16x16x32_bf16 v[32:35], v[72:75], a[12:15], v[32:35]
    ds_read_b128 v[112:115], v5 offset:62464
    v_mfma_f32_16x16x32_bf16 v[36:39], v[76:79], a[12:15], v[36:39]
    ds_read_b128 v[116:119], v5 offset:63488
    s_add_u32 s35, s34, 14336
    buffer_load_dwordx4 a[56:59], v4, s[8:11], s35 offen sc1
    v_mfma_f32_16x16x32_bf16 v[40:43], v[80:83], a[12:15], v[40:43]
    ds_read_b128 v[120:123], v5 offset:64512
    v_mfma_f32_16x16x32_bf16 v[44:47], v[84:87], a[12:15], v[44:47]
    ds_read_b128 v[124:127], v6 offset:0
    s_add_u32 s35, s34, 15360
    buffer_load_dwordx4 a[60:63], v4, s[8:11], s35 offen sc1
    v_mfma_f32_16x16x32_bf16 v[48:51], v[88:91], a[12:15], v[48:51]
    ds_read_b128 v[128:131], v6 offset:1024
    s_waitcnt vmcnt(11)
    s_waitcnt lgkmcnt(5)
    v_mfma_f32_16x16x32_bf16 v[32:35], v[92:95], a[16:19], v[32:35]
    ds_read_b128 v[72:75], v6 offset:2048
    v_mfma_f32_16x16x32_bf16 v[36:39], v[96:99], a[16:19], v[36:39]
    ds_read_b128 v[76:79], v6 offset:3072
    s_add_u32 s35, s34, 16384
    buffer_load_dwordx4 a[64:67], v4, s[8:11], s35 offen sc1
    v_mfma_f32_16x16x32_bf16 v[40:43], v[100:103], a[16:19], v[40:43]
    ds_read_b128 v[80:83], v6 offset:4096
    v_mfma_f32_16x16x32_bf16 v[44:47], v[104:107], a[16:19], v[44:47]
    ds_read_b128 v[84:87], v6 offset:5120
    v_mfma_f32_16x16x32_bf16 v[48:51], v[108:111], a[16:19], v[48:51]
    ds_read_b128 v[88:91], v6 offset:6144
    s_waitcnt vmcnt(11)
    s_waitcnt lgkmcnt(5)
    v_mfma_f32_16x16x32_bf16 v[32:35], v[112:115], a[20:23], v[32:35]
    ds_read_b128 v[92:95], v6 offset:7168
    v_mfma_f32_16x16x32_bf16 v[36:39], v[116:119], a[20:23], v[36:39]
    ds_read_b128 v[96:99], v6 offset:8192
    s_add_u32 s35, s34, 17408
    buffer_load_dwordx4 a[68:71], v4, s[8:11], s35 offen sc1
    v_mfma_f32_16x16x32_bf16 v[40:43], v[120:123], a[20:23], v[40:43]
    ds_read_b128 v[100:103], v6 offset:9216
    v_mfma_f32_16x16x32_bf16 v[44:47], v[124:127], a[20:23], v[44:47]
    ds_read_b128 v[104:107], v6 offset:10240
    v_mfma_f32_16x16x32_bf16 v[48:51], v[128:131], a[20:23], v[48:51]
    ds_read_b128 v[108:111], v6 offset:11264
    s_waitcnt vmcnt(11)
    s_waitcnt lgkmcnt(5)
    v_mfma_f32_16x16x32_bf16 v[32:35], v[72:75], a[24:27], v[32:35]
    ds_read_b128 v[112:115], v6 offset:12288
    v_mfma_f32_16x16x32_bf16 v[36:39], v[76:79], a[24:27], v[36:39]
    ds_read_b128 v[116:119], v6 offset:13312
    s_add_u32 s35, s34, 18432
    buffer_load_dwordx4 a[72:75], v4, s[8:11], s35 offen sc1
    v_mfma_f32_16x16x32_bf16 v[40:43], v[80:83], a[24:27], v[40:43]
    ds_read_b128 v[120:123], v6 offset:14336
    v_mfma_f32_16x16x32_bf16 v[44:47], v[84:87], a[24:27], v[44:47]
    ds_read_b128 v[124:127], v6 offset:15360
    v_mfma_f32_16x16x32_bf16 v[48:51], v[88:91], a[24:27], v[48:51]
    ds_read_b128 v[128:131], v6 offset:16384
    s_waitcnt vmcnt(11)
    s_waitcnt lgkmcnt(5)
    v_mfma_f32_16x16x32_bf16 v[32:35], v[92:95], a[28:31], v[32:35]
    ds_read_b128 v[72:75], v6 offset:17408
    v_mfma_f32_16x16x32_bf16 v[36:39], v[96:99], a[28:31], v[36:39]
    ds_read_b128 v[76:79], v6 offset:18432
    s_add_u32 s35, s34, 19456
    buffer_load_dwordx4 a[76:79], v4, s[8:11], s35 offen sc1
    v_mfma_f32_16x16x32_bf16 v[40:43], v[100:103], a[28:31], v[40:43]
    ds_read_b128 v[80:83], v6 offset:19456
    v_mfma_f32_16x16x32_bf16 v[44:47], v[104:107], a[28:31], v[44:47]
    ds_read_b128 v[84:87], v6 offset:20480
    v_mfma_f32_16x16x32_bf16 v[48:51], v[108:111], a[28:31], v[48:51]
    ds_read_b128 v[88:91], v6 offset:21504
    s_waitcnt vmcnt(11)
    s_waitcnt lgkmcnt(5)
    v_mfma_f32_16x16x32_bf16 v[32:35], v[112:115], a[32:35], v[32:35]
    ds_read_b128 v[92:95], v4 offset:0
    v_mfma_f32_16x16x32_bf16 v[36:39], v[116:119], a[32:35], v[36:39]
    ds_read_b128 v[96:99], v4 offset:1024
    v_mfma_f32_16x16x32_bf16 v[40:43], v[120:123], a[32:35], v[40:43]
    ds_read_b128 v[100:103], v4 offset:2048
    v_mfma_f32_16x16x32_bf16 v[44:47], v[124:127], a[32:35], v[44:47]
    ds_read_b128 v[104:107], v4 offset:3072
    v_mfma_f32_16x16x32_bf16 v[48:51], v[128:131], a[32:35], v[48:51]
    ds_read_b128 v[108:111], v4 offset:4096
    s_add_u32 m0, s28, 51200
    s_add_u32 s63, s88, 0
    buffer_load_dwordx4 v4, s[8:11], s63 offen sc1 lds
    s_waitcnt vmcnt(11)
    s_waitcnt lgkmcnt(5)
    v_mfma_f32_16x16x32_bf16 v[32:35], v[72:75], a[36:39], v[32:35]
    ds_read_b128 v[112:115], v4 offset:5120
    v_mfma_f32_16x16x32_bf16 v[36:39], v[76:79], a[36:39], v[36:39]
    ds_read_b128 v[116:119], v4 offset:6144
    v_mfma_f32_16x16x32_bf16 v[40:43], v[80:83], a[36:39], v[40:43]
    ds_read_b128 v[120:123], v4 offset:7168
    v_mfma_f32_16x16x32_bf16 v[44:47], v[84:87], a[36:39], v[44:47]
    ds_read_b128 v[124:127], v4 offset:8192
    v_mfma_f32_16x16x32_bf16 v[48:51], v[88:91], a[36:39], v[48:51]
    ds_read_b128 v[128:131], v4 offset:9216
    s_add_u32 m0, s28, 55296
    s_add_u32 s63, s88, 4096
    buffer_load_dwordx4 v4, s[8:11], s63 offen sc1 lds
    s_waitcnt vmcnt(11)
    s_waitcnt lgkmcnt(5)
    v_mfma_f32_16x16x32_bf16 v[32:35], v[92:95], a[40:43], v[32:35]
    ds_read_b128 v[72:75], v4 offset:10240
    v_mfma_f32_16x16x32_bf16 v[36:39], v[96:99], a[40:43], v[36:39]
    ds_read_b128 v[76:79], v4 offset:11264
    v_mfma_f32_16x16x32_bf16 v[40:43], v[100:103], a[40:43], v[40:43]
    ds_read_b128 v[80:83], v4 offset:12288
    v_mfma_f32_16x16x32_bf16 v[44:47], v[104:107], a[40:43], v[44:47]
    ds_read_b128 v[84:87], v4 offset:13312
    v_mfma_f32_16x16x32_bf16 v[48:51], v[108:111], a[40:43], v[48:51]
    ds_read_b128 v[88:91], v4 offset:14336
    s_add_u32 m0, s28, 59392
    s_add_u32 s63, s88, 8192
    buffer_load_dwordx4 v4, s[8:11], s63 offen sc1 lds
    s_waitcnt vmcnt(11)
    s_waitcnt lgkmcnt(5)
    v_mfma_f32_16x16x32_bf16 v[32:35], v[112:115], a[44:47], v[32:35]
    ds_read_b128 v[92:95], v4 offset:15360
    v_mfma_f32_16x16x32_bf16 v[36:39], v[116:119], a[44:47], v[36:39]
    ds_read_b128 v[96:99], v4 offset:16384
    v_mfma_f32_16x16x32_bf16 v[40:43], v[120:123], a[44:47], v[40:43]
    ds_read_b128 v[100:103], v4 offset:17408
    v_mfma_f32_16x16x32_bf16 v[44:47], v[124:127], a[44:47], v[44:47]
    ds_read_b128 v[104:107], v4 offset:18432
    v_mfma_f32_16x16x32_bf16 v[48:51], v[128:131], a[44:47], v[48:51]
    ds_read_b128 v[108:111], v4 offset:19456
    s_add_u32 m0, s28, 63488
    s_add_u32 s63, s88, 12288
    buffer_load_dwordx4 v4, s[8:11], s63 offen sc1 lds
    v_lshlrev_b32 v240, 3, v1
    s_mul_i32 s35, s5, 2560
    s_add_u32 s35, s35, s42
    s_add_u32 s35, s35, 0x500000
    buffer_load_dwordx2 v[136:137], v240, s[8:11], s35 offen offset:0 sc1
    buffer_load_dwordx2 v[138:139], v240, s[8:11], s35 offen offset:512 sc1
    buffer_load_dwordx2 v[140:141], v240, s[8:11], s35 offen offset:1024 sc1
    buffer_load_dwordx2 v[142:143], v240, s[8:11], s35 offen offset:1536 sc1
    buffer_load_dwordx2 v[144:145], v240, s[8:11], s35 offen offset:2048 sc1
    s_waitcnt vmcnt(16)
    s_waitcnt lgkmcnt(5)
    v_mfma_f32_16x16x32_bf16 v[32:35], v[72:75], a[48:51], v[32:35]
    ds_read_b128 v[112:115], v4 offset:20480
    v_mfma_f32_16x16x32_bf16 v[36:39], v[76:79], a[48:51], v[36:39]
    ds_read_b128 v[116:119], v4 offset:21504
    v_mfma_f32_16x16x32_bf16 v[40:43], v[80:83], a[48:51], v[40:43]
    ds_read_b128 v[120:123], v4 offset:22528
    v_mfma_f32_16x16x32_bf16 v[44:47], v[84:87], a[48:51], v[44:47]
    ds_read_b128 v[124:127], v4 offset:23552
    v_mfma_f32_16x16x32_bf16 v[48:51], v[88:91], a[48:51], v[48:51]
    ds_read_b128 v[128:131], v4 offset:24576
    s_add_u32 m0, s28, 67584
    s_add_u32 s63, s88, 16384
    buffer_load_dwordx4 v4, s[8:11], s63 offen sc1 lds
    s_waitcnt vmcnt(16)
    s_waitcnt lgkmcnt(5)
    v_mfma_f32_16x16x32_bf16 v[32:35], v[92:95], a[52:55], v[32:35]
    ds_read_b128 v[72:75], v4 offset:25600
    v_mfma_f32_16x16x32_bf16 v[36:39], v[96:99], a[52:55], v[36:39]
    ds_read_b128 v[76:79], v4 offset:26624
    v_mfma_f32_16x16x32_bf16 v[40:43], v[100:103], a[52:55], v[40:43]
    ds_read_b128 v[80:83], v4 offset:27648
    v_mfma_f32_16x16x32_bf16 v[44:47], v[104:107], a[52:55], v[44:47]
    ds_read_b128 v[84:87], v4 offset:28672
    v_mfma_f32_16x16x32_bf16 v[48:51], v[108:111], a[52:55], v[48:51]
    ds_read_b128 v[88:91], v4 offset:29696
    s_add_u32 m0, s28, 71680
    s_add_u32 s63, s88, 20480
    buffer_load_dwordx4 v4, s[8:11], s63 offen sc1 lds
    s_waitcnt vmcnt(16)
    s_waitcnt lgkmcnt(5)
    v_mfma_f32_16x16x32_bf16 v[32:35], v[112:115], a[56:59], v[32:35]
    ds_read_b128 v[92:95], v4 offset:30720
    v_mfma_f32_16x16x32_bf16 v[36:39], v[116:119], a[56:59], v[36:39]
    ds_read_b128 v[96:99], v4 offset:31744
    v_mfma_f32_16x16x32_bf16 v[40:43], v[120:123], a[56:59], v[40:43]
    ds_read_b128 v[100:103], v4 offset:32768
    v_mfma_f32_16x16x32_bf16 v[44:47], v[124:127], a[56:59], v[44:47]
    ds_read_b128 v[104:107], v4 offset:33792
    v_mfma_f32_16x16x32_bf16 v[48:51], v[128:131], a[56:59], v[48:51]
    ds_read_b128 v[108:111], v4 offset:34816
    s_add_u32 m0, s28, 75776
    s_add_u32 s63, s88, 24576
    buffer_load_dwordx4 v4, s[8:11], s63 offen sc1 lds
    s_waitcnt vmcnt(16)
    s_waitcnt lgkmcnt(5)
    v_mfma_f32_16x16x32_bf16 v[32:35], v[72:75], a[60:63], v[32:35]
    ds_read_b128 v[112:115], v4 offset:35840
    v_mfma_f32_16x16x32_bf16 v[36:39], v[76:79], a[60:63], v[36:39]
    ds_read_b128 v[116:119], v4 offset:36864
    v_mfma_f32_16x16x32_bf16 v[40:43], v[80:83], a[60:63], v[40:43]
    ds_read_b128 v[120:123], v4 offset:37888
    v_mfma_f32_16x16x32_bf16 v[44:47], v[84:87], a[60:63], v[44:47]
    ds_read_b128 v[124:127], v4 offset:38912
    v_mfma_f32_16x16x32_bf16 v[48:51], v[88:91], a[60:63], v[48:51]
    ds_read_b128 v[128:131], v4 offset:39936
    s_add_u32 m0, s28, 79872
    s_add_u32 s63, s88, 28672
    buffer_load_dwordx4 v4, s[8:11], s63 offen sc1 lds
    s_waitcnt vmcnt(16)
    s_waitcnt lgkmcnt(5)
    v_mfma_f32_16x16x32_bf16 v[32:35], v[92:95], a[64:67], v[32:35]
    ds_read_b128 v[72:75], v4 offset:40960
    v_mfma_f32_16x16x32_bf16 v[36:39], v[96:99], a[64:67], v[36:39]
    ds_read_b128 v[76:79], v4 offset:41984
    v_mfma_f32_16x16x32_bf16 v[40:43], v[100:103], a[64:67], v[40:43]
    ds_read_b128 v[80:83], v4 offset:43008
    v_mfma_f32_16x16x32_bf16 v[44:47], v[104:107], a[64:67], v[44:47]
    ds_read_b128 v[84:87], v4 offset:44032
    v_mfma_f32_16x16x32_bf16 v[48:51], v[108:111], a[64:67], v[48:51]
    ds_read_b128 v[88:91], v4 offset:45056
    s_add_u32 m0, s28, 83968
    s_add_u32 s63, s88, 32768
    buffer_load_dwordx4 v4, s[8:11], s63 offen sc1 lds
    s_waitcnt vmcnt(16)
    s_waitcnt lgkmcnt(5)
    v_mfma_f32_16x16x32_bf16 v[32:35], v[112:115], a[68:71], v[32:35]
    ds_read_b128 v[92:95], v4 offset:46080
    v_mfma_f32_16x16x32_bf16 v[36:39], v[116:119], a[68:71], v[36:39]
    ds_read_b128 v[96:99], v4 offset:47104
    v_mfma_f32_16x16x32_bf16 v[40:43], v[120:123], a[68:71], v[40:43]
    ds_read_b128 v[100:103], v4 offset:48128
    v_mfma_f32_16x16x32_bf16 v[44:47], v[124:127], a[68:71], v[44:47]
    ds_read_b128 v[104:107], v4 offset:49152
    v_mfma_f32_16x16x32_bf16 v[48:51], v[128:131], a[68:71], v[48:51]
    ds_read_b128 v[108:111], v4 offset:50176
    s_add_u32 m0, s28, 88064
    s_add_u32 s63, s88, 36864
    buffer_load_dwordx4 v4, s[8:11], s63 offen sc1 lds
    s_add_u32 m0, s28, 92160
    s_add_u32 s63, s88, 40960
    buffer_load_dwordx4 v4, s[8:11], s63 offen sc1 lds
    s_waitcnt vmcnt(17)
    s_waitcnt lgkmcnt(5)
    v_mfma_f32_16x16x32_bf16 v[32:35], v[72:75], a[72:75], v[32:35]
    v_mfma_f32_16x16x32_bf16 v[36:39], v[76:79], a[72:75], v[36:39]
    v_mfma_f32_16x16x32_bf16 v[40:43], v[80:83], a[72:75], v[40:43]
    v_mfma_f32_16x16x32_bf16 v[44:47], v[84:87], a[72:75], v[44:47]
    v_mfma_f32_16x16x32_bf16 v[48:51], v[88:91], a[72:75], v[48:51]
    s_add_u32 m0, s28, 96256
    s_add_u32 s63, s88, 45056
    buffer_load_dwordx4 v4, s[8:11], s63 offen sc1 lds
    s_sub_u32 s59, s3, 0
    s_min_u32 s59, s59, 1
    s_lshl_b32 s59, s59, 10
    s_sub_u32 s63, s88, s28
    s_add_u32 s63, s63, s59
    s_add_u32 s63, s63, 49152
    s_add_u32 s59, s59, 100352
    s_sub_u32 m0, s59, 153600
    s_cmp_ge_u32 s59, 153600
    s_cselect_b32 m0, m0, s59
    s_nop 0
    buffer_load_dwordx4 v4, s[8:11], s63 offen sc1 lds
    s_waitcnt vmcnt(18)
    s_waitcnt lgkmcnt(0)
    v_mfma_f32_16x16x32_bf16 v[32:35], v[92:95], a[76:79], v[32:35]
    v_mfma_f32_16x16x32_bf16 v[36:39], v[96:99], a[76:79], v[36:39]
    v_mfma_f32_16x16x32_bf16 v[40:43], v[100:103], a[76:79], v[40:43]
    v_mfma_f32_16x16x32_bf16 v[44:47], v[104:107], a[76:79], v[44:47]
    v_mfma_f32_16x16x32_bf16 v[48:51], v[108:111], a[76:79], v[48:51]
    s_waitcnt vmcnt(9)
    v_mov_b32 v150, 0
    v_mov_b32 v151, 0
    v_mov_b32 v152, 0
    v_mov_b32 v153, 0
    v_mul_f32 v154, v8, v9
    v_mov_b32 v156, v9
    v_lshlrev_b32 v146, 16, v136
    v_and_b32 v147, s94, v136
    v_lshlrev_b32 v148, 16, v137
    v_and_b32 v149, s94, v137
    v_pk_fma_f32 v[32:33], v[146:147], v[156:157], v[32:33] op_sel_hi:[1,0,1]
    v_pk_add_f32 v[32:33], v[32:33], v[154:155] op_sel_hi:[1,0] neg_lo:[0,1] neg_hi:[0,1]
    v_pk_fma_f32 v[34:35], v[148:149], v[156:157], v[34:35] op_sel_hi:[1,0,1]
    v_pk_add_f32 v[34:35], v[34:35], v[154:155] op_sel_hi:[1,0] neg_lo:[0,1] neg_hi:[0,1]
    v_cvt_pk_bf16_f32 v160, v32, v33
    v_cvt_pk_bf16_f32 v161, v34, v35
    v_lshlrev_b32 v32, 16, v160
    v_and_b32 v33, s94, v160
    v_pk_add_f32 v[10:11], v[32:33], v[146:147]
    v_pk_add_f32 v[150:151], v[150:151], v[32:33]
    v_pk_fma_f32 v[152:153], v[32:33], v[32:33], v[152:153]
    v_lshlrev_b32 v34, 16, v161
    v_and_b32 v35, s94, v161
    v_pk_add_f32 v[12:13], v[34:35], v[148:149]
    v_pk_add_f32 v[150:151], v[150:151], v[34:35]
    v_pk_fma_f32 v[152:153], v[34:35], v[34:35], v[152:153]
    v_lshlrev_b32 v146, 16, v138
    v_and_b32 v147, s94, v138
    v_lshlrev_b32 v148, 16, v139
    v_and_b32 v149, s94, v139
    v_pk_fma_f32 v[36:37], v[146:147], v[156:157], v[36:37] op_sel_hi:[1,0,1]
    v_pk_add_f32 v[36:37], v[36:37], v[154:155] op_sel_hi:[1,0] neg_lo:[0,1] neg_hi:[0,1]
    v_pk_fma_f32 v[38:39], v[148:149], v[156:157], v[38:39] op_sel_hi:[1,0,1]
    v_pk_add_f32 v[38:39], v[38:39], v[154:155] op_sel_hi:[1,0] neg_lo:[0,1] neg_hi:[0,1]
    v_cvt_pk_bf16_f32 v162, v36, v37
    v_cvt_pk_bf16_f32 v163, v38, v39
    v_lshlrev_b32 v36, 16, v162
    v_and_b32 v37, s94, v162
    v_pk_add_f32 v[14:15], v[36:37], v[146:147]
    v_pk_add_f32 v[150:151], v[150:151], v[36:37]
    v_pk_fma_f32 v[152:153], v[36:37], v[36:37], v[152:153]
    v_lshlrev_b32 v38, 16, v163
    v_and_b32 v39, s94, v163
    v_pk_add_f32 v[16:17], v[38:39], v[148:149]
    v_pk_add_f32 v[150:151], v[150:151], v[38:39]
    v_pk_fma_f32 v[152:153], v[38:39], v[38:39], v[152:153]
    v_lshlrev_b32 v146, 16, v140
    v_and_b32 v147, s94, v140
    v_lshlrev_b32 v148, 16, v141
    v_and_b32 v149, s94, v141
    v_pk_fma_f32 v[40:41], v[146:147], v[156:157], v[40:41] op_sel_hi:[1,0,1]
    v_pk_add_f32 v[40:41], v[40:41], v[154:155] op_sel_hi:[1,0] neg_lo:[0,1] neg_hi:[0,1]
    v_pk_fma_f32 v[42:43], v[148:149], v[156:157], v[42:43] op_sel_hi:[1,0,1]
    v_pk_add_f32 v[42:43], v[42:43], v[154:155] op_sel_hi:[1,0] neg_lo:[0,1] neg_hi:[0,1]
    v_cvt_pk_bf16_f32 v164, v40, v41
    v_cvt_pk_bf16_f32 v165, v42, v43
    v_lshlrev_b32 v40, 16, v164
    v_and_b32 v41, s94, v164
    v_pk_add_f32 v[18:19], v[40:41], v[146:147]
    v_pk_add_f32 v[150:151], v[150:151], v[40:41]
    v_pk_fma_f32 v[152:153], v[40:41], v[40:41], v[152:153]
    v_lshlrev_b32 v42, 16, v165
    v_and_b32 v43, s94, v165
    v_pk_add_f32 v[20:21], v[42:43], v[148:149]
    v_pk_add_f32 v[150:151], v[150:151], v[42:43]
    v_pk_fma_f32 v[152:153], v[42:43], v[42:43], v[152:153]
    v_lshlrev_b32 v146, 16, v142
    v_and_b32 v147, s94, v142
    v_lshlrev_b32 v148, 16, v143
    v_and_b32 v149, s94, v143
    v_pk_fma_f32 v[44:45], v[146:147], v[156:157], v[44:45] op_sel_hi:[1,0,1]
    v_pk_add_f32 v[44:45], v[44:45], v[154:155] op_sel_hi:[1,0] neg_lo:[0,1] neg_hi:[0,1]
    v_pk_fma_f32 v[46:47], v[148:149], v[156:157], v[46:47] op_sel_hi:[1,0,1]
    v_pk_add_f32 v[46:47], v[46:47], v[154:155] op_sel_hi:[1,0] neg_lo:[0,1] neg_hi:[0,1]
    v_cvt_pk_bf16_f32 v166, v44, v45
    v_cvt_pk_bf16_f32 v167, v46, v47
    v_lshlrev_b32 v44, 16, v166
    v_and_b32 v45, s94, v166
    v_pk_add_f32 v[22:23], v[44:45], v[146:147]
    v_pk_add_f32 v[150:151], v[150:151], v[44:45]
    v_pk_fma_f32 v[152:153], v[44:45], v[44:45], v[152:153]
    v_lshlrev_b32 v46, 16, v167
    v_and_b32 v47, s94, v167
    v_pk_add_f32 v[24:25], v[46:47], v[148:149]
    v_pk_add_f32 v[150:151], v[150:151], v[46:47]
    v_pk_fma_f32 v[152:153], v[46:47], v[46:47], v[152:153]
    v_lshlrev_b32 v146, 16, v144
    v_and_b32 v147, s94, v144
    v_lshlrev_b32 v148, 16, v145
    v_and_b32 v149, s94, v145
    v_pk_fma_f32 v[48:49], v[146:147], v[156:157], v[48:49] op_sel_hi:[1,0,1]
    v_pk_add_f32 v[48:49], v[48:49], v[154:155] op_sel_hi:[1,0] neg_lo:[0,1] neg_hi:[0,1]
    v_pk_fma_f32 v[50:51], v[148:149], v[156:157], v[50:51] op_sel_hi:[1,0,1]
    v_pk_add_f32 v[50:51], v[50:51], v[154:155] op_sel_hi:[1,0] neg_lo:[0,1] neg_hi:[0,1]
    v_cvt_pk_bf16_f32 v168, v48, v49
    v_cvt_pk_bf16_f32 v169, v50, v51
    v_lshlrev_b32 v48, 16, v168
    v_and_b32 v49, s94, v168
    v_pk_add_f32 v[26:27], v[48:49], v[146:147]
    v_pk_add_f32 v[150:151], v[150:151], v[48:49]
    v_pk_fma_f32 v[152:153], v[48:49], v[48:49], v[152:153]
    v_lshlrev_b32 v50, 16, v169
    v_and_b32 v51, s94, v169
    v_pk_add_f32 v[28:29], v[50:51], v[148:149]
    v_pk_add_f32 v[150:151], v[150:151], v[50:51]
    v_pk_fma_f32 v[152:153], v[50:51], v[50:51], v[152:153]
    v_permlane16_swap_b32 v160, v162
    v_permlane16_swap_b32 v161, v163
    v_permlane16_swap_b32 v164, v166
    v_permlane16_swap_b32 v165, v167
    v_permlane16_swap_b32 v168, v170
    v_permlane16_swap_b32 v169, v171
    buffer_store_dwordx4 v[160:163], v172, s[8:11], s43 offen offset:0 sc1
    buffer_store_dwordx4 v[164:167], v172, s[8:11], s43 offen offset:1024 sc1
    buffer_store_dwordx4 v[168:171], v173, s[8:11], s43 offen offset:2048 sc1
    v_add_f32 v150, v150, v151
    v_add_f32 v151, v152, v153
    v_mov_b32 v158, v150
    v_mov_b32 v159, v151
    s_nop 0
    v_permlane32_swap_b32 v150, v158
    v_permlane32_swap_b32 v151, v159
    v_add_f32 v150, v150, v158
    v_add_f32 v151, v151, v159
    v_mov_b32 v158, v150
    v_mov_b32 v159, v151
    s_nop 0
    v_permlane16_swap_b32 v150, v158
    v_permlane16_swap_b32 v151, v159
    v_add_f32 v150, v150, v158
    v_add_f32 v151, v151, v159
    s_mov_b64 exec, 0xffff
    buffer_store_dwordx2 v[150:151], v174, s[8:11], s44 offen sc1
    s_mov_b64 exec, -1
    s_waitcnt vmcnt(0)
    s_barrier
    s_cmp_lg_u32 s3, 0
    s_cbranch_scc1 L_sig_55
    s_lshl_b32 s32, s95, 2
    s_add_u32 s32, s32, 0x194c400
    v_lshlrev_b32 v240, 10, v1
    v_mov_b32 v241, s7
    s_mov_b64 exec, 1
    buffer_store_dword v241, v240, s[8:11], s32 offen sc1
    s_mov_b64 exec, -1
L_sig_55:
    s_add_u32 m0, s28, 102400
    s_add_u32 s63, s88, 51200
    buffer_load_dwordx4 v4, s[8:11], s63 offen sc1 lds
    s_add_u32 m0, s28, 106496
    s_add_u32 s63, s88, 55296
    buffer_load_dwordx4 v4, s[8:11], s63 offen sc1 lds
    s_add_u32 m0, s28, 110592
    s_add_u32 s63, s88, 59392
    buffer_load_dwordx4 v4, s[8:11], s63 offen sc1 lds
    s_add_u32 m0, s28, 114688
    s_add_u32 s63, s88, 63488
    buffer_load_dwordx4 v4, s[8:11], s63 offen sc1 lds
    s_add_u32 m0, s28, 118784
    s_add_u32 s63, s88, 67584
    buffer_load_dwordx4 v4, s[8:11], s63 offen sc1 lds
    s_add_u32 m0, s28, 122880
    s_add_u32 s63, s88, 71680
    buffer_load_dwordx4 v4, s[8:11], s63 offen sc1 lds
    s_add_u32 m0, s28, 126976
    s_add_u32 s63, s88, 75776
    buffer_load_dwordx4 v4, s[8:11], s63 offen sc1 lds
    s_add_u32 m0, s28, 131072
    s_add_u32 s63, s88, 79872
    buffer_load_dwordx4 v4, s[8:11], s63 offen sc1 lds
    s_add_u32 m0, s28, 135168
    s_add_u32 s63, s88, 83968
    buffer_load_dwordx4 v4, s[8:11], s63 offen sc1 lds
    s_add_u32 m0, s28, 139264
    s_add_u32 s63, s88, 88064
    buffer_load_dwordx4 v4, s[8:11], s63 offen sc1 lds
    s_add_u32 m0, s28, 143360
    s_add_u32 s63, s88, 92160
    buffer_load_dwordx4 v4, s[8:11], s63 offen sc1 lds
    s_add_u32 m0, s28, 147456
    s_add_u32 s63, s88, 96256
    buffer_load_dwordx4 v4, s[8:11], s63 offen sc1 lds
    s_sub_u32 s59, s3, 0
    s_min_u32 s59, s59, 3
    s_lshl_b32 s59, s59, 10
    s_sub_u32 s63, s88, s28
    s_add_u32 s63, s63, s59
    s_add_u32 s63, s63, 100352
    s_add_u32 s59, s59, 151552
    s_sub_u32 m0, s59, 153600
    s_cmp_ge_u32 s59, 153600
    s_cselect_b32 m0, m0, s59
    s_nop 0
    buffer_load_dwordx4 v4, s[8:11], s63 offen sc1 lds
    s_add_u32 m0, s28, 2048
    s_add_u32 s63, s88, 104448
    buffer_load_dwordx4 v4, s[8:11], s63 offen sc1 lds
    s_lshr_b32 s40, s4, 1
    s_lshl_b32 s40, s40, 4
    s_mov_b32 s41, 16
    s_lshr_b32 s42, s4, 1
    s_lshl_b32 s42, s42, 2
    s_add_u32 s42, s42, s3
    s_lshl_b32 s42, s42, 1
    s_and_b32 s43, s30, 15
    s_mul_i32 s47, s42, 20480
    s_add_u32 s47, s47, 0x280000
    s_cmp_lg_u32 s3, 0
    s_cbranch_scc1 L_pskip_56
    s_sub_u32 s33, s41, 1
    v_min_u32 v240, s33, v1
    v_add_u32 v240, s40, v240
    v_lshlrev_b32 v240, 2, v240
    s_mov_b32 s32, 0x194c400
    s_mov_b32 s31, 0
L_ploop_57:
    buffer_load_dword v244, v240, s[8:11], s32 offen sc1
    s_waitcnt vmcnt(0)
    v_cmp_ne_u32 vcc, s7, v244
    s_add_u32 s31, s31, 1
    s_cmp_ge_u32 s31, 40000
    s_cbranch_scc1 L_pdone_58
    s_cbranch_vccnz L_ploop_57
L_pdone_58:
L_pskip_56:
    s_waitcnt vmcnt(0)
    s_barrier
    s_add_u32 s35, s47, 0
    buffer_load_dwordx4 a[0:3], v4, s[8:11], s35 offen sc1
    s_add_u32 s35, s35, 20480
    buffer_load_dwordx4 a[80:83], v4, s[8:11], s35 offen sc1
    s_add_u32 s35, s47, 1024
    buffer_load_dwordx4 a[4:7], v4, s[8:11], s35 offen sc1
    s_add_u32 s35, s35, 20480
    buffer_load_dwordx4 a[84:87], v4, s[8:11], s35 offen sc1
    s_add_u32 s35, s47, 2048
    buffer_load_dwordx4 a[8:11], v4, s[8:11], s35 offen sc1
    s_add_u32 s35, s35, 20480
    buffer_load_dwordx4 a[88:91], v4, s[8:11], s35 offen sc1
    s_add_u32 s35, s47, 3072
    buffer_load_dwordx4 a[12:15], v4, s[8:11], s35 offen sc1
    s_add_u32 s35, s35, 20480
    buffer_load_dwordx4 a[92:95], v4, s[8:11], s35 offen sc1
    s_add_u32 s35, s47, 4096
    buffer_load_dwordx4 a[16:19], v4, s[8:11], s35 offen sc1
    s_add_u32 s35, s35, 20480
    buffer_load_dwordx4 a[96:99], v4, s[8:11], s35 offen sc1
    s_mul_i32 s44, s43, 7
    s_mul_i32 s34, s43, 6
    s_add_u32 s34, s34, 12
    s_cmp_lt_u32 s43, 12
    s_cselect_b32 s44, s44, s34
    s_cselect_b32 s45, 1, 0
    v_lshlrev_b32 v236, 3, v2
    v_lshl_add_u32 v236, v3, 15, v236
    v_lshlrev_b32 v237, 4, v3
    s_lshl_b32 s51, s42, 7
    s_add_u32 s51, s51, 0x1924000
    s_add_u32 s58, s51, 16384
    s_lshl_b32 s52, s44, 6
    s_add_u32 s52, s52, 0x1945000
    s_lshr_b32 s98, s44, 1
    s_and_b32 s46, s44, 1
    v_xor_b32 v180, 16, v1
    v_lshlrev_b32 v180, 2, v180
    v_xor_b32 v181, 32, v1
    v_lshlrev_b32 v181, 2, v181
    v_and_b32 v194, 1, v3
    v_add_u32 v194, s46, v194
    v_cmp_eq_u32 s[48:49], 2, v194
    v_and_b32 v194, 1, v194
    v_lshlrev_b32 v194, 9, v194
    v_lshrrev_b32 v242, 1, v3
    v_lshl_add_u32 v194, v242, 8, v194
    v_lshl_add_u32 v194, v2, 4, v194
    v_and_b32 v242, 1, v3
    v_mov_b32 v243, 0x7f000000
    v_cmp_eq_u32 vcc, 0, v242
    s_nop 1
    v_cndmask_b32 v195, v243, v194, vcc
    ds_read_b128 v[88:91], v4 offset:51200
    ds_read_b128 v[92:95], v4 offset:52224
    ds_read_b128 v[96:99], v4 offset:53248
    ds_read_b128 v[100:103], v4 offset:54272
    ds_read_b128 v[104:107], v4 offset:55296
    ds_read_b128 v[108:111], v4 offset:56320
    ds_read_b128 v[112:115], v4 offset:57344
    s_waitcnt vmcnt(8)
    s_waitcnt lgkmcnt(0)
    v_mfma_f32_16x16x32_bf16 v[32:35], v[88:91], a[0:3], 0
    ds_read_b128 v[116:119], v4 offset:58368
    v_mfma_f32_16x16x32_bf16 v[60:63], v[88:91], a[80:83], 0
    ds_read_b128 v[120:123], v4 offset:59392
    v_mfma_f32_16x16x32_bf16 v[36:39], v[92:95], a[0:3], 0
    ds_read_b128 v[124:127], v4 offset:60416
    v_mfma_f32_16x16x32_bf16 v[64:67], v[92:95], a[80:83], 0
    ds_read_b128 v[128:131], v4 offset:61440
    s_add_u32 s35, s47, 5120
    buffer_load_dwordx4 a[20:23], v4, s[8:11], s35 offen sc1
    s_add_u32 s35, s35, 20480
    buffer_load_dwordx4 a[100:103], v4, s[8:11], s35 offen sc1
    v_mfma_f32_16x16x32_bf16 v[40:43], v[96:99], a[0:3], 0
    ds_read_b128 v[132:135], v4 offset:62464
    v_mfma_f32_16x16x32_bf16 v[68:71], v[96:99], a[80:83], 0
    ds_read_b128 v[136:139], v4 offset:63488
    v_mfma_f32_16x16x32_bf16 v[44:47], v[100:103], a[0:3], 0
    ds_read_b128 v[140:143], v4 offset:64512
    v_mfma_f32_16x16x32_bf16 v[72:75], v[100:103], a[80:83], 0
    v_mfma_f32_16x16x32_bf16 v[48:51], v[104:107], a[0:3], 0
    v_mfma_f32_16x16x32_bf16 v[76:79], v[104:107], a[80:83], 0
    v_mfma_f32_16x16x32_bf16 v[52:55], v[108:111], a[0:3], 0
    v_mfma_f32_16x16x32_bf16 v[80:83], v[108:111], a[80:83], 0
    v_mfma_f32_16x16x32_bf16 v[56:59], v[112:115], a[0:3], 0
    v_mfma_f32_16x16x32_bf16 v[84:87], v[112:115], a[80:83], 0
    s_add_u32 m0, s28, 6144
    s_add_u32 s63, s88, 108544
    buffer_load_dwordx4 v4, s[8:11], s63 offen sc1 lds
    s_waitcnt vmcnt(9)
    s_waitcnt lgkmcnt(0)
    v_mfma_f32_16x16x32_bf16 v[32:35], v[116:119], a[4:7], v[32:35]
    ds_read_b128 v[88:91], v5 offset:0
    s_add_u32 s57, s42, 0
    v_mfma_f32_16x16x32_bf16 v[60:63], v[116:119], a[84:87], v[60:63]
    ds_read_b128 v[92:95], v5 offset:1024
    s_add_u32 s53, s98, 0
    v_mfma_f32_16x16x32_bf16 v[36:39], v[120:123], a[4:7], v[36:39]
    ds_read_b128 v[96:99], v5 offset:2048
    s_mul_i32 s54, s57, 20480
    v_mfma_f32_16x16x32_bf16 v[64:67], v[120:123], a[84:87], v[64:67]
    ds_read_b128 v[100:103], v5 offset:3072
    s_add_u32 s35, s47, 6144
    buffer_load_dwordx4 a[24:27], v4, s[8:11], s35 offen sc1
    s_add_u32 s35, s35, 20480
    buffer_load_dwordx4 a[104:107], v4, s[8:11], s35 offen sc1
    v_mfma_f32_16x16x32_bf16 v[40:43], v[124:127], a[4:7], v[40:43]
    ds_read_b128 v[104:107], v5 offset:4096
    v_mfma_f32_16x16x32_bf16 v[68:71], v[124:127], a[84:87], v[68:71]
    ds_read_b128 v[108:111], v5 offset:5120
    s_add_u32 s56, s54, 0x4fb000
    v_mfma_f32_16x16x32_bf16 v[44:47], v[128:131], a[4:7], v[44:47]
    ds_read_b128 v[112:115], v5 offset:6144
    v_mfma_f32_16x16x32_bf16 v[72:75], v[128:131], a[84:87], v[72:75]
    s_add_u32 s54, s54, 0x0
    v_mfma_f32_16x16x32_bf16 v[48:51], v[132:135], a[4:7], v[48:51]
    s_cmp_ge_u32 s53, 20
    s_cselect_b32 s54, s56, s54
    v_mfma_f32_16x16x32_bf16 v[76:79], v[132:135], a[84:87], v[76:79]
    s_mul_i32 s56, s57, 14336
    v_mfma_f32_16x16x32_bf16 v[52:55], v[136:139], a[4:7], v[52:55]
    v_mfma_f32_16x16x32_bf16 v[80:83], v[136:139], a[84:87], v[80:83]
    s_add_u32 s56, s56, 0xc76000
    v_mfma_f32_16x16x32_bf16 v[56:59], v[140:143], a[4:7], v[56:59]
    s_cmp_ge_u32 s53, 40
    s_cselect_b32 s54, s56, s54
    v_mfma_f32_16x16x32_bf16 v[84:87], v[140:143], a[84:87], v[84:87]
    s_add_u32 m0, s28, 10240
    s_add_u32 s63, s88, 112640
    buffer_load_dwordx4 v4, s[8:11], s63 offen sc1 lds
    s_waitcnt vmcnt(10)
    s_waitcnt lgkmcnt(0)
    v_mfma_f32_16x16x32_bf16 v[32:35], v[88:91], a[8:11], v[32:35]
    ds_read_b128 v[116:119], v5 offset:7168
    s_lshl_b32 s53, s53, 10
    v_mfma_f32_16x16x32_bf16 v[60:63], v[88:91], a[88:91], v[60:63]
    ds_read_b128 v[120:123], v5 offset:8192
    s_add_u32 s24, s54, s53
    v_mfma_f32_16x16x32_bf16 v[36:39], v[92:95], a[8:11], v[36:39]
    ds_read_b128 v[124:127], v5 offset:9216
    s_add_u32 s57, s42, 0
    v_mfma_f32_16x16x32_bf16 v[64:67], v[92:95], a[88:91], v[64:67]
    ds_read_b128 v[128:131], v5 offset:10240
    s_add_u32 s35, s47, 7168
    buffer_load_dwordx4 a[28:31], v4, s[8:11], s35 offen sc1
    s_add_u32 s35, s35, 20480
    buffer_load_dwordx4 a[108:111], v4, s[8:11], s35 offen sc1
    v_mfma_f32_16x16x32_bf16 v[40:43], v[96:99], a[8:11], v[40:43]
    ds_read_b128 v[132:135], v5 offset:11264
    v_mfma_f32_16x16x32_bf16 v[68:71], v[96:99], a[88:91], v[68:71]
    ds_read_b128 v[136:139], v5 offset:12288
    s_add_u32 s53, s98, 1
    v_mfma_f32_16x16x32_bf16 v[44:47], v[100:103], a[8:11], v[44:47]
    ds_read_b128 v[140:143], v5 offset:13312
    v_mfma_f32_16x16x32_bf16 v[72:75], v[100:103], a[88:91], v[72:75]
    s_mul_i32 s54, s57, 20480
    v_mfma_f32_16x16x32_bf16 v[48:51], v[104:107], a[8:11], v[48:51]
    s_add_u32 s56, s54, 0x4fb000
    v_mfma_f32_16x16x32_bf16 v[76:79], v[104:107], a[88:91], v[76:79]
    s_add_u32 s54, s54, 0x0
    v_mfma_f32_16x16x32_bf16 v[52:55], v[108:111], a[8:11], v[52:55]
    v_mfma_f32_16x16x32_bf16 v[80:83], v[108:111], a[88:91], v[80:83]
    s_cmp_ge_u32 s53, 20
    s_cselect_b32 s54, s56, s54
    v_mfma_f32_16x16x32_bf16 v[56:59], v[112:115], a[8:11], v[56:59]
    s_mul_i32 s56, s57, 14336
    v_mfma_f32_16x16x32_bf16 v[84:87], v[112:115], a[88:91], v[84:87]
    s_add_u32 m0, s28, 14336
    s_add_u32 s63, s88, 116736
    buffer_load_dwordx4 v4, s[8:11], s63 offen sc1 lds
    s_waitcnt vmcnt(11)
    s_waitcnt lgkmcnt(0)
    v_mfma_f32_16x16x32_bf16 v[32:35], v[116:119], a[12:15], v[32:35]
    ds_read_b128 v[88:91], v5 offset:14336
    s_add_u32 s56, s56, 0xc76000
    v_mfma_f32_16x16x32_bf16 v[60:63], v[116:119], a[92:95], v[60:63]
    ds_read_b128 v[92:95], v5 offset:15360
    s_cmp_ge_u32 s53, 40
    s_cselect_b32 s54, s56, s54
    v_mfma_f32_16x16x32_bf16 v[36:39], v[120:123], a[12:15], v[36:39]
    ds_read_b128 v[96:99], v5 offset:16384
    s_lshl_b32 s53, s53, 10
    v_mfma_f32_16x16x32_bf16 v[64:67], v[120:123], a[92:95], v[64:67]
    ds_read_b128 v[100:103], v5 offset:17408
    s_add_u32 s35, s47, 8192
    buffer_load_dwordx4 a[32:35], v4, s[8:11], s35 offen sc1
    s_add_u32 s35, s35, 20480
    buffer_load_dwordx4 a[112:115], v4, s[8:11], s35 offen sc1
    v_mfma_f32_16x16x32_bf16 v[40:43], v[124:127], a[12:15], v[40:43]
    ds_read_b128 v[104:107], v5 offset:18432
    v_mfma_f32_16x16x32_bf16 v[68:71], v[124:127], a[92:95], v[68:71]
    ds_read_b128 v[108:111], v5 offset:19456
    s_add_u32 s25, s54, s53
    v_mfma_f32_16x16x32_bf16 v[44:47], v[128:131], a[12:15], v[44:47]
    ds_read_b128 v[112:115], v5 offset:20480
    v_mfma_f32_16x16x32_bf16 v[72:75], v[128:131], a[92:95], v[72:75]
    s_add_u32 s57, s42, 0
    v_mfma_f32_16x16x32_bf16 v[48:51], v[132:135], a[12:15], v[48:51]
    s_add_u32 s53, s98, 2
    v_mfma_f32_16x16x32_bf16 v[76:79], v[132:135], a[92:95], v[76:79]
    s_mul_i32 s54, s57, 20480
    v_mfma_f32_16x16x32_bf16 v[52:55], v[136:139], a[12:15], v[52:55]
    v_mfma_f32_16x16x32_bf16 v[80:83], v[136:139], a[92:95], v[80:83]
    s_add_u32 s56, s54, 0x4fb000
    v_mfma_f32_16x16x32_bf16 v[56:59], v[140:143], a[12:15], v[56:59]
    s_add_u32 s54, s54, 0x0
    v_mfma_f32_16x16x32_bf16 v[84:87], v[140:143], a[92:95], v[84:87]
    s_add_u32 m0, s28, 18432
    s_add_u32 s63, s88, 120832
    buffer_load_dwordx4 v4, s[8:11], s63 offen sc1 lds
    s_waitcnt vmcnt(12)
    s_waitcnt lgkmcnt(0)
    v_mfma_f32_16x16x32_bf16 v[32:35], v[88:91], a[16:19], v[32:35]
    ds_read_b128 v[116:119], v5 offset:21504
    s_cmp_ge_u32 s53, 20
    s_cselect_b32 s54, s56, s54
    v_mfma_f32_16x16x32_bf16 v[60:63], v[88:91], a[96:99], v[60:63]
    ds_read_b128 v[120:123], v5 offset:22528
    s_mul_i32 s56, s57, 14336
    v_mfma_f32_16x16x32_bf16 v[36:39], v[92:95], a[16:19], v[36:39]
    ds_read_b128 v[124:127], v5 offset:23552
    s_add_u32 s56, s56, 0xc76000
    v_mfma_f32_16x16x32_bf16 v[64:67], v[92:95], a[96:99], v[64:67]
    ds_read_b128 v[128:131], v5 offset:24576
    s_add_u32 s35, s47, 9216
    buffer_load_dwordx4 a[36:39], v4, s[8:11], s35 offen sc1
    s_add_u32 s35, s35, 20480
    buffer_load_dwordx4 a[116:119], v4, s[8:11], s35 offen sc1
    v_mfma_f32_16x16x32_bf16 v[40:43], v[96:99], a[16:19], v[40:43]
    ds_read_b128 v[132:135], v5 offset:25600
    v_mfma_f32_16x16x32_bf16 v[68:71], v[96:99], a[96:99], v[68:71]
    ds_read_b128 v[136:139], v5 offset:26624
    s_cmp_ge_u32 s53, 40
    s_cselect_b32 s54, s56, s54
    v_mfma_f32_16x16x32_bf16 v[44:47], v[100:103], a[16:19], v[44:47]
    ds_read_b128 v[140:143], v5 offset:27648
    v_mfma_f32_16x16x32_bf16 v[72:75], v[100:103], a[96:99], v[72:75]
    s_lshl_b32 s53, s53, 10
    v_mfma_f32_16x16x32_bf16 v[48:51], v[104:107], a[16:19], v[48:51]
    s_add_u32 s26, s54, s53
    v_mfma_f32_16x16x32_bf16 v[76:79], v[104:107], a[96:99], v[76:79]
    s_add_u32 s57, s42, 0
    v_mfma_f32_16x16x32_bf16 v[52:55], v[108:111], a[16:19], v[52:55]
    v_mfma_f32_16x16x32_bf16 v[80:83], v[108:111], a[96:99], v[80:83]
    s_add_u32 s53, s98, 3
    v_mfma_f32_16x16x32_bf16 v[56:59], v[112:115], a[16:19], v[56:59]
    s_mul_i32 s54, s57, 20480
    v_mfma_f32_16x16x32_bf16 v[84:87], v[112:115], a[96:99], v[84:87]
    s_add_u32 m0, s28, 22528
    s_add_u32 s63, s88, 124928
    buffer_load_dwordx4 v4, s[8:11], s63 offen sc1 lds
    s_waitcnt vmcnt(13)
    s_waitcnt lgkmcnt(0)
    v_mfma_f32_16x16x32_bf16 v[32:35], v[116:119], a[20:23], v[32:35]
    ds_read_b128 v[88:91], v5 offset:28672
    s_add_u32 s56, s54, 0x4fb000
    v_mfma_f32_16x16x32_bf16 v[60:63], v[116:119], a[100:103], v[60:63]
    ds_read_b128 v[92:95], v5 offset:29696
    s_add_u32 s54, s54, 0x0
    v_mfma_f32_16x16x32_bf16 v[36:39], v[120:123], a[20:23], v[36:39]
    ds_read_b128 v[96:99], v5 offset:30720
    s_cmp_ge_u32 s53, 20
    s_cselect_b32 s54, s56, s54
    v_mfma_f32_16x16x32_bf16 v[64:67], v[120:123], a[100:103], v[64:67]
    ds_read_b128 v[100:103], v5 offset:31744
    s_add_u32 s35, s47, 10240
    buffer_load_dwordx4 a[40:43], v4, s[8:11], s35 offen sc1
    s_add_u32 s35, s35, 20480
    buffer_load_dwordx4 a[120:123], v4, s[8:11], s35 offen sc1
    v_mfma_f32_16x16x32_bf16 v[40:43], v[124:127], a[20:23], v[40:43]
    ds_read_b128 v[104:107], v5 offset:32768
    v_mfma_f32_16x16x32_bf16 v[68:71], v[124:127], a[100:103], v[68:71]
    ds_read_b128 v[108:111], v5 offset:33792
    s_mul_i32 s56, s57, 14336
    v_mfma_f32_16x16x32_bf16 v[44:47], v[128:131], a[20:23], v[44:47]
    ds_read_b128 v[112:115], v5 offset:34816
    v_mfma_f32_16x16x32_bf16 v[72:75], v[128:131], a[100:103], v[72:75]
    s_add_u32 s56, s56, 0xc76000
    v_mfma_f32_16x16x32_bf16 v[48:51], v[132:135], a[20:23], v[48:51]
    s_cmp_ge_u32 s53, 40
    s_cselect_b32 s54, s56, s54
    v_mfma_f32_16x16x32_bf16 v[76:79], v[132:135], a[100:103], v[76:79]
    s_lshl_b32 s53, s53, 10
    v_mfma_f32_16x16x32_bf16 v[52:55], v[136:139], a[20:23], v[52:55]
    v_mfma_f32_16x16x32_bf16 v[80:83], v[136:139], a[100:103], v[80:83]
    s_add_u32 s27, s54, s53
    v_mfma_f32_16x16x32_bf16 v[56:59], v[140:143], a[20:23], v[56:59]
    s_add_u32 s57, s42, 1
    v_mfma_f32_16x16x32_bf16 v[84:87], v[140:143], a[100:103], v[84:87]
    s_add_u32 m0, s28, 26624
    s_add_u32 s63, s88, 129024
    buffer_load_dwordx4 v4, s[8:11], s63 offen sc1 lds
    s_waitcnt vmcnt(13)
    s_waitcnt lgkmcnt(0)
    v_mfma_f32_16x16x32_bf16 v[32:35], v[88:91], a[24:27], v[32:35]
    ds_read_b128 v[116:119], v5 offset:35840
    s_add_u32 s53, s98, 0
    v_mfma_f32_16x16x32_bf16 v[60:63], v[88:91], a[104:107], v[60:63]
    ds_read_b128 v[120:123], v5 offset:36864
    s_mul_i32 s54, s57, 20480
    v_mfma_f32_16x16x32_bf16 v[36:39], v[92:95], a[24:27], v[36:39]
    ds_read_b128 v[124:127], v5 offset:37888
    s_add_u32 s56, s54, 0x4fb000
    v_mfma_f32_16x16x32_bf16 v[64:67], v[92:95], a[104:107], v[64:67]
    ds_read_b128 v[128:131], v5 offset:38912
    s_add_u32 s35, s47, 11264
    buffer_load_dwordx4 a[44:47], v4, s[8:11], s35 offen sc1
    s_add_u32 s35, s35, 20480
    buffer_load_dwordx4 a[124:127], v4, s[8:11], s35 offen sc1
    v_mfma_f32_16x16x32_bf16 v[40:43], v[96:99], a[24:27], v[40:43]
    ds_read_b128 v[132:135], v5 offset:39936
    v_mfma_f32_16x16x32_bf16 v[68:71], v[96:99], a[104:107], v[68:71]
    ds_read_b128 v[136:139], v5 offset:40960
    s_add_u32 s54, s54, 0x0
    v_mfma_f32_16x16x32_bf16 v[44:47], v[100:103], a[24:27], v[44:47]
    ds_read_b128 v[140:143], v5 offset:41984
    v_mfma_f32_16x16x32_bf16 v[72:75], v[100:103], a[104:107], v[72:75]
    s_cmp_ge_u32 s53, 20
    s_cselect_b32 s54, s56, s54
    v_mfma_f32_16x16x32_bf16 v[48:51], v[104:107], a[24:27], v[48:51]
    s_mul_i32 s56, s57, 14336
    v_mfma_f32_16x16x32_bf16 v[76:79], v[104:107], a[104:107], v[76:79]
    s_add_u32 s56, s56, 0xc76000
    v_mfma_f32_16x16x32_bf16 v[52:55], v[108:111], a[24:27], v[52:55]
    v_mfma_f32_16x16x32_bf16 v[80:83], v[108:111], a[104:107], v[80:83]
    s_cmp_ge_u32 s53, 40
    s_cselect_b32 s54, s56, s54
    v_mfma_f32_16x16x32_bf16 v[56:59], v[112:115], a[24:27], v[56:59]
    s_lshl_b32 s53, s53, 10
    v_mfma_f32_16x16x32_bf16 v[84:87], v[112:115], a[104:107], v[84:87]
    s_add_u32 m0, s28, 30720
    s_add_u32 s63, s88, 133120
    buffer_load_dwordx4 v4, s[8:11], s63 offen sc1 lds
    s_waitcnt vmcnt(13)
    s_waitcnt lgkmcnt(0)
    v_mfma_f32_16x16x32_bf16 v[32:35], v[116:119], a[28:31], v[32:35]
    ds_read_b128 v[88:91], v5 offset:43008
    s_add_u32 s12, s54, s53
    v_mfma_f32_16x16x32_bf16 v[60:63], v[116:119], a[108:111], v[60:63]
    ds_read_b128 v[92:95], v5 offset:44032
    s_add_u32 s57, s42, 1
    v_mfma_f32_16x16x32_bf16 v[36:39], v[120:123], a[28:31], v[36:39]
    ds_read_b128 v[96:99], v5 offset:45056
    s_add_u32 s53, s98, 1
    v_mfma_f32_16x16x32_bf16 v[64:67], v[120:123], a[108:111], v[64:67]
    ds_read_b128 v[100:103], v5 offset:46080
    s_add_u32 s35, s47, 12288
    buffer_load_dwordx4 a[48:51], v4, s[8:11], s35 offen sc1
    s_add_u32 s35, s35, 20480
    buffer_load_dwordx4 a[128:131], v4, s[8:11], s35 offen sc1
    v_mfma_f32_16x16x32_bf16 v[40:43], v[124:127], a[28:31], v[40:43]
    ds_read_b128 v[104:107], v5 offset:47104
    v_mfma_f32_16x16x32_bf16 v[68:71], v[124:127], a[108:111], v[68:71]
    ds_read_b128 v[108:111], v5 offset:48128
    s_mul_i32 s54, s57, 20480
    v_mfma_f32_16x16x32_bf16 v[44:47], v[128:131], a[28:31], v[44:47]
    ds_read_b128 v[112:115], v5 offset:49152
    v_mfma_f32_16x16x32_bf16 v[72:75], v[128:131], a[108:111], v[72:75]
    s_add_u32 s56, s54, 0x4fb000
    v_mfma_f32_16x16x32_bf16 v[48:51], v[132:135], a[28:31], v[48:51]
    s_add_u32 s54, s54, 0x0
    v_mfma_f32_16x16x32_bf16 v[76:79], v[132:135], a[108:111], v[76:79]
    s_cmp_ge_u32 s53, 20
    s_cselect_b32 s54, s56, s54
    v_mfma_f32_16x16x32_bf16 v[52:55], v[136:139], a[28:31], v[52:55]
    v_mfma_f32_16x16x32_bf16 v[80:83], v[136:139], a[108:111], v[80:83]
    s_mul_i32 s56, s57, 14336
    v_mfma_f32_16x16x32_bf16 v[56:59], v[140:143], a[28:31], v[56:59]
    s_add_u32 s56, s56, 0xc76000
    v_mfma_f32_16x16x32_bf16 v[84:87], v[140:143], a[108:111], v[84:87]
    s_add_u32 m0, s28, 34816
    s_add_u32 s63, s88, 137216
    buffer_load_dwordx4 v4, s[8:11], s63 offen sc1 lds
    s_waitcnt vmcnt(13)
    s_waitcnt lgkmcnt(0)
    v_mfma_f32_16x16x32_bf16 v[32:35], v[88:91], a[32:35], v[32:35]
    ds_read_b128 v[116:119], v5 offset:50176
    s_cmp_ge_u32 s53, 40
    s_cselect_b32 s54, s56, s54
    v_mfma_f32_16x16x32_bf16 v[60:63], v[88:91], a[112:115], v[60:63]
    ds_read_b128 v[120:123], v5 offset:51200
    s_lshl_b32 s53, s53, 10
    v_mfma_f32_16x16x32_bf16 v[36:39], v[92:95], a[32:35], v[36:39]
    ds_read_b128 v[124:127], v5 offset:52224
    s_add_u32 s13, s54, s53
    v_mfma_f32_16x16x32_bf16 v[64:67], v[92:95], a[112:115], v[64:67]
    ds_read_b128 v[128:131], v5 offset:53248
    s_add_u32 s35, s47, 13312
    buffer_load_dwordx4 a[52:55], v4, s[8:11], s35 offen sc1
    s_add_u32 s35, s35, 20480
    buffer_load_dwordx4 a[132:135], v4, s[8:11], s35 offen sc1
    v_mfma_f32_16x16x32_bf16 v[40:43], v[96:99], a[32:35], v[40:43]
    ds_read_b128 v[132:135], v5 offset:54272
    v_mfma_f32_16x16x32_bf16 v[68:71], v[96:99], a[112:115], v[68:71]
    ds_read_b128 v[136:139], v5 offset:55296
    s_add_u32 s57, s42, 1
    v_mfma_f32_16x16x32_bf16 v[44:47], v[100:103], a[32:35], v[44:47]
    ds_read_b128 v[140:143], v5 offset:56320
    v_mfma_f32_16x16x32_bf16 v[72:75], v[100:103], a[112:115], v[72:75]
    s_add_u32 s53, s98, 2
    v_mfma_f32_16x16x32_bf16 v[48:51], v[104:107], a[32:35], v[48:51]
    s_mul_i32 s54, s57, 20480
    v_mfma_f32_16x16x32_bf16 v[76:79], v[104:107], a[112:115], v[76:79]
    s_add_u32 s56, s54, 0x4fb000
    v_mfma_f32_16x16x32_bf16 v[52:55], v[108:111], a[32:35], v[52:55]
    v_mfma_f32_16x16x32_bf16 v[80:83], v[108:111], a[112:115], v[80:83]
    s_add_u32 s54, s54, 0x0
    v_mfma_f32_16x16x32_bf16 v[56:59], v[112:115], a[32:35], v[56:59]
    s_cmp_ge_u32 s53, 20
    s_cselect_b32 s54, s56, s54
    v_mfma_f32_16x16x32_bf16 v[84:87], v[112:115], a[112:115], v[84:87]
    s_sub_u32 s59, s3, 0
    s_min_u32 s59, s59, 1
    s_lshl_b32 s59, s59, 10
    s_sub_u32 s63, s88, s28
    s_add_u32 s63, s63, s59
    s_add_u32 s63, s63, 141312
    s_add_u32 s59, s59, 38912
    s_sub_u32 m0, s59, 153600
    s_cmp_ge_u32 s59, 153600
    s_cselect_b32 m0, m0, s59
    s_nop 0
    buffer_load_dwordx4 v4, s[8:11], s63 offen sc1 lds
    s_waitcnt vmcnt(13)
    s_waitcnt lgkmcnt(0)
    v_mfma_f32_16x16x32_bf16 v[32:35], v[116:119], a[36:39], v[32:35]
    ds_read_b128 v[88:91], v5 offset:57344
    s_mul_i32 s56, s57, 14336
    v_mfma_f32_16x16x32_bf16 v[60:63], v[116:119], a[116:119], v[60:63]
    ds_read_b128 v[92:95], v5 offset:58368
    s_add_u32 s56, s56, 0xc76000
    v_mfma_f32_16x16x32_bf16 v[36:39], v[120:123], a[36:39], v[36:39]
    ds_read_b128 v[96:99], v5 offset:59392
    s_cmp_ge_u32 s53, 40
    s_cselect_b32 s54, s56, s54
    v_mfma_f32_16x16x32_bf16 v[64:67], v[120:123], a[116:119], v[64:67]
    ds_read_b128 v[100:103], v5 offset:60416
    s_add_u32 s35, s47, 14336
    buffer_load_dwordx4 a[56:59], v4, s[8:11], s35 offen sc1
    s_add_u32 s35, s35, 20480
    buffer_load_dwordx4 a[136:139], v4, s[8:11], s35 offen sc1
    v_mfma_f32_16x16x32_bf16 v[40:43], v[124:127], a[36:39], v[40:43]
    ds_read_b128 v[104:107], v5 offset:61440
    v_mfma_f32_16x16x32_bf16 v[68:71], v[124:127], a[116:119], v[68:71]
    ds_read_b128 v[108:111], v5 offset:62464
    s_lshl_b32 s53, s53, 10
    v_mfma_f32_16x16x32_bf16 v[44:47], v[128:131], a[36:39], v[44:47]
    ds_read_b128 v[112:115], v5 offset:63488
    v_mfma_f32_16x16x32_bf16 v[72:75], v[128:131], a[116:119], v[72:75]
    s_add_u32 s14, s54, s53
    v_mfma_f32_16x16x32_bf16 v[48:51], v[132:135], a[36:39], v[48:51]
    s_add_u32 s57, s42, 1
    v_mfma_f32_16x16x32_bf16 v[76:79], v[132:135], a[116:119], v[76:79]
    s_add_u32 s53, s98, 3
    v_mfma_f32_16x16x32_bf16 v[52:55], v[136:139], a[36:39], v[52:55]
    v_mfma_f32_16x16x32_bf16 v[80:83], v[136:139], a[116:119], v[80:83]
    s_mul_i32 s54, s57, 20480
    v_mfma_f32_16x16x32_bf16 v[56:59], v[140:143], a[36:39], v[56:59]
    s_add_u32 s56, s54, 0x4fb000
    v_mfma_f32_16x16x32_bf16 v[84:87], v[140:143], a[116:119], v[84:87]
    buffer_load_dwordx2 v[172:173], v236, s[8:11], s51 offen offset:0 sc1
    buffer_load_dwordx2 v[174:175], v236, s[8:11], s58 offen offset:0 sc1
    s_waitcnt vmcnt(14)
    s_waitcnt lgkmcnt(0)
    v_mfma_f32_16x16x32_bf16 v[32:35], v[88:91], a[40:43], v[32:35]
    ds_read_b128 v[116:119], v5 offset:64512
    s_add_u32 s54, s54, 0x0
    v_mfma_f32_16x16x32_bf16 v[60:63], v[88:91], a[120:123], v[60:63]
    ds_read_b128 v[120:123], v6 offset:0
    s_cmp_ge_u32 s53, 20
    s_cselect_b32 s54, s56, s54
    v_mfma_f32_16x16x32_bf16 v[36:39], v[92:95], a[40:43], v[36:39]
    ds_read_b128 v[124:127], v6 offset:1024
    s_mul_i32 s56, s57, 14336
    v_mfma_f32_16x16x32_bf16 v[64:67], v[92:95], a[120:123], v[64:67]
    ds_read_b128 v[128:131], v6 offset:2048
    s_add_u32 s35, s47, 15360
    buffer_load_dwordx4 a[60:63], v4, s[8:11], s35 offen sc1
    s_add_u32 s35, s35, 20480
    buffer_load_dwordx4 a[140:143], v4, s[8:11], s35 offen sc1
    v_mfma_f32_16x16x32_bf16 v[40:43], v[96:99], a[40:43], v[40:43]
    ds_read_b128 v[132:135], v6 offset:3072
    v_mfma_f32_16x16x32_bf16 v[68:71], v[96:99], a[120:123], v[68:71]
    ds_read_b128 v[136:139], v6 offset:4096
    s_add_u32 s56, s56, 0xc76000
    v_mfma_f32_16x16x32_bf16 v[44:47], v[100:103], a[40:43], v[44:47]
    ds_read_b128 v[140:143], v6 offset:5120
    v_mfma_f32_16x16x32_bf16 v[72:75], v[100:103], a[120:123], v[72:75]
    s_cmp_ge_u32 s53, 40
    s_cselect_b32 s54, s56, s54
    v_mfma_f32_16x16x32_bf16 v[48:51], v[104:107], a[40:43], v[48:51]
    s_lshl_b32 s53, s53, 10
    v_mfma_f32_16x16x32_bf16 v[76:79], v[104:107], a[120:123], v[76:79]
    s_add_u32 s15, s54, s53
    v_mfma_f32_16x16x32_bf16 v[52:55], v[108:111], a[40:43], v[52:55]
    v_mfma_f32_16x16x32_bf16 v[80:83], v[108:111], a[120:123], v[80:83]
    v_mfma_f32_16x16x32_bf16 v[56:59], v[112:115], a[40:43], v[56:59]
    v_mfma_f32_16x16x32_bf16 v[84:87], v[112:115], a[120:123], v[84:87]
    buffer_load_dwordx2 v[176:177], v236, s[8:11], s51 offen offset:128 sc1
    buffer_load_dwordx2 v[178:179], v236, s[8:11], s58 offen offset:128 sc1
    s_waitcnt vmcnt(15)
    s_waitcnt lgkmcnt(0)
    v_mfma_f32_16x16x32_bf16 v[32:35], v[116:119], a[44:47], v[32:35]
    ds_read_b128 v[88:91], v6 offset:6144
    v_mfma_f32_16x16x32_bf16 v[60:63], v[116:119], a[124:127], v[60:63]
    ds_read_b128 v[92:95], v6 offset:7168
    v_mfma_f32_16x16x32_bf16 v[36:39], v[120:123], a[44:47], v[36:39]
    ds_read_b128 v[96:99], v6 offset:8192
    v_mfma_f32_16x16x32_bf16 v[64:67], v[120:123], a[124:127], v[64:67]
    ds_read_b128 v[100:103], v6 offset:9216
    s_add_u32 s35, s47, 16384
    buffer_load_dwordx4 a[64:67], v4, s[8:11], s35 offen sc1
    s_add_u32 s35, s35, 20480
    buffer_load_dwordx4 a[144:147], v4, s[8:11], s35 offen sc1
    v_mfma_f32_16x16x32_bf16 v[40:43], v[124:127], a[44:47], v[40:43]
    ds_read_b128 v[104:107], v6 offset:10240
    v_mfma_f32_16x16x32_bf16 v[68:71], v[124:127], a[124:127], v[68:71]
    ds_read_b128 v[108:111], v6 offset:11264
    v_mfma_f32_16x16x32_bf16 v[44:47], v[128:131], a[44:47], v[44:47]
    ds_read_b128 v[112:115], v6 offset:12288
    v_mfma_f32_16x16x32_bf16 v[72:75], v[128:131], a[124:127], v[72:75]
    v_mfma_f32_16x16x32_bf16 v[48:51], v[132:135], a[44:47], v[48:51]
    v_mfma_f32_16x16x32_bf16 v[76:79], v[132:135], a[124:127], v[76:79]
    v_mfma_f32_16x16x32_bf16 v[52:55], v[136:139], a[44:47], v[52:55]
    v_mfma_f32_16x16x32_bf16 v[80:83], v[136:139], a[124:127], v[80:83]
    v_mfma_f32_16x16x32_bf16 v[56:59], v[140:143], a[44:47], v[56:59]
    v_mfma_f32_16x16x32_bf16 v[84:87], v[140:143], a[124:127], v[84:87]
    buffer_load_dwordx4 v[144:147], v237, s[8:11], s52 offen offset:0 sc1
    s_waitcnt vmcnt(15)
    s_waitcnt lgkmcnt(0)
    v_mfma_f32_16x16x32_bf16 v[32:35], v[88:91], a[48:51], v[32:35]
    ds_read_b128 v[116:119], v6 offset:13312
    v_mfma_f32_16x16x32_bf16 v[60:63], v[88:91], a[128:131], v[60:63]
    ds_read_b128 v[120:123], v6 offset:14336
    v_mfma_f32_16x16x32_bf16 v[36:39], v[92:95], a[48:51], v[36:39]
    ds_read_b128 v[124:127], v6 offset:15360
    v_mfma_f32_16x16x32_bf16 v[64:67], v[92:95], a[128:131], v[64:67]
    ds_read_b128 v[128:131], v6 offset:16384
    s_add_u32 s35, s47, 17408
    buffer_load_dwordx4 a[68:71], v4, s[8:11], s35 offen sc1
    s_add_u32 s35, s35, 20480
    buffer_load_dwordx4 a[148:151], v4, s[8:11], s35 offen sc1
    v_mfma_f32_16x16x32_bf16 v[40:43], v[96:99], a[48:51], v[40:43]
    ds_read_b128 v[132:135], v6 offset:17408
    v_mfma_f32_16x16x32_bf16 v[68:71], v[96:99], a[128:131], v[68:71]
    ds_read_b128 v[136:139], v6 offset:18432
    v_mfma_f32_16x16x32_bf16 v[44:47], v[100:103], a[48:51], v[44:47]
    ds_read_b128 v[140:143], v6 offset:19456
    v_mfma_f32_16x16x32_bf16 v[72:75], v[100:103], a[128:131], v[72:75]
    v_mfma_f32_16x16x32_bf16 v[48:51], v[104:107], a[48:51], v[48:51]
    v_mfma_f32_16x16x32_bf16 v[76:79], v[104:107], a[128:131], v[76:79]
    v_mfma_f32_16x16x32_bf16 v[52:55], v[108:111], a[48:51], v[52:55]
    v_mfma_f32_16x16x32_bf16 v[80:83], v[108:111], a[128:131], v[80:83]
    v_mfma_f32_16x16x32_bf16 v[56:59], v[112:115], a[48:51], v[56:59]
    v_mfma_f32_16x16x32_bf16 v[84:87], v[112:115], a[128:131], v[84:87]
    buffer_load_dwordx4 v[148:151], v237, s[8:11], s52 offen offset:64 sc1
    s_waitcnt vmcnt(14)
    s_barrier
    s_waitcnt vmcnt(15)
    s_waitcnt vmcnt(6)
    s_waitcnt lgkmcnt(0)
    v_mfma_f32_16x16x32_bf16 v[32:35], v[116:119], a[52:55], v[32:35]
    ds_read_b128 v[88:91], v6 offset:20480
    v_add_f32 v172, v172, v174
    v_mfma_f32_16x16x32_bf16 v[60:63], v[116:119], a[132:135], v[60:63]
    ds_read_b128 v[92:95], v6 offset:21504
    v_add_f32 v173, v173, v175
    v_mfma_f32_16x16x32_bf16 v[36:39], v[120:123], a[52:55], v[36:39]
    ds_read_b128 v[96:99], v4 offset:0
    ds_bpermute_b32 v182, v180, v172
    v_mfma_f32_16x16x32_bf16 v[64:67], v[120:123], a[132:135], v[64:67]
    ds_read_b128 v[100:103], v4 offset:1024
    s_add_u32 s35, s47, 18432
    buffer_load_dwordx4 a[72:75], v4, s[8:11], s35 offen sc1
    s_add_u32 s35, s35, 20480
    buffer_load_dwordx4 a[152:155], v4, s[8:11], s35 offen sc1
    v_mfma_f32_16x16x32_bf16 v[40:43], v[124:127], a[52:55], v[40:43]
    ds_read_b128 v[104:107], v4 offset:2048
    ds_bpermute_b32 v183, v180, v173
    v_mfma_f32_16x16x32_bf16 v[68:71], v[124:127], a[132:135], v[68:71]
    ds_read_b128 v[108:111], v4 offset:3072
    v_add_f32 v176, v176, v178
    v_mfma_f32_16x16x32_bf16 v[44:47], v[128:131], a[52:55], v[44:47]
    ds_read_b128 v[112:115], v4 offset:4096
    v_add_f32 v177, v177, v179
    v_mfma_f32_16x16x32_bf16 v[72:75], v[128:131], a[132:135], v[72:75]
    ds_bpermute_b32 v184, v180, v176
    v_mfma_f32_16x16x32_bf16 v[48:51], v[132:135], a[52:55], v[48:51]
    ds_bpermute_b32 v185, v180, v177
    v_mfma_f32_16x16x32_bf16 v[76:79], v[132:135], a[132:135], v[76:79]
    v_mfma_f32_16x16x32_bf16 v[52:55], v[136:139], a[52:55], v[52:55]
    v_mfma_f32_16x16x32_bf16 v[80:83], v[136:139], a[132:135], v[80:83]
    v_mfma_f32_16x16x32_bf16 v[56:59], v[140:143], a[52:55], v[56:59]
    v_mfma_f32_16x16x32_bf16 v[84:87], v[140:143], a[132:135], v[84:87]
    buffer_load_dwordx4 v[152:155], v237, s[8:11], s52 offen offset:128 sc1
    s_waitcnt vmcnt(15)
    s_waitcnt lgkmcnt(0)
    v_mfma_f32_16x16x32_bf16 v[32:35], v[88:91], a[56:59], v[32:35]
    ds_read_b128 v[116:119], v4 offset:5120
    v_add_f32 v172, v172, v182
    v_mfma_f32_16x16x32_bf16 v[60:63], v[88:91], a[136:139], v[60:63]
    ds_read_b128 v[120:123], v4 offset:6144
    v_add_f32 v173, v173, v183
    v_mfma_f32_16x16x32_bf16 v[36:39], v[92:95], a[56:59], v[36:39]
    ds_read_b128 v[124:127], v4 offset:7168
    ds_bpermute_b32 v182, v181, v172
    v_mfma_f32_16x16x32_bf16 v[64:67], v[92:95], a[136:139], v[64:67]
    ds_read_b128 v[128:131], v4 offset:8192
    s_add_u32 s35, s47, 19456
    buffer_load_dwordx4 a[76:79], v4, s[8:11], s35 offen sc1
    s_add_u32 s35, s35, 20480
    buffer_load_dwordx4 a[156:159], v4, s[8:11], s35 offen sc1
    v_mfma_f32_16x16x32_bf16 v[40:43], v[96:99], a[56:59], v[40:43]
    ds_read_b128 v[132:135], v4 offset:9216
    ds_bpermute_b32 v183, v181, v173
    v_mfma_f32_16x16x32_bf16 v[68:71], v[96:99], a[136:139], v[68:71]
    ds_read_b128 v[136:139], v4 offset:10240
    v_add_f32 v176, v176, v184
    v_mfma_f32_16x16x32_bf16 v[44:47], v[100:103], a[56:59], v[44:47]
    ds_read_b128 v[140:143], v4 offset:11264
    v_add_f32 v177, v177, v185
    v_mfma_f32_16x16x32_bf16 v[72:75], v[100:103], a[136:139], v[72:75]
    ds_bpermute_b32 v184, v181, v176
    v_mfma_f32_16x16x32_bf16 v[48:51], v[104:107], a[56:59], v[48:51]
    ds_bpermute_b32 v185, v181, v177
    v_mfma_f32_16x16x32_bf16 v[76:79], v[104:107], a[136:139], v[76:79]
    v_mfma_f32_16x16x32_bf16 v[52:55], v[108:111], a[56:59], v[52:55]
    v_mfma_f32_16x16x32_bf16 v[80:83], v[108:111], a[136:139], v[80:83]
    v_mfma_f32_16x16x32_bf16 v[56:59], v[112:115], a[56:59], v[56:59]
    v_mfma_f32_16x16x32_bf16 v[84:87], v[112:115], a[136:139], v[84:87]
    buffer_load_dwordx4 v[156:159], v237, s[8:11], s52 offen offset:192 sc1
    s_waitcnt vmcnt(14)
    s_waitcnt lgkmcnt(0)
    v_mfma_f32_16x16x32_bf16 v[32:35], v[116:119], a[60:63], v[32:35]
    ds_read_b128 v[88:91], v4 offset:12288
    v_add_f32 v172, v172, v182
    v_mfma_f32_16x16x32_bf16 v[60:63], v[116:119], a[140:143], v[60:63]
    ds_read_b128 v[92:95], v4 offset:13312
    v_add_f32 v173, v173, v183
    v_mfma_f32_16x16x32_bf16 v[36:39], v[120:123], a[60:63], v[36:39]
    ds_read_b128 v[96:99], v4 offset:14336
    v_mul_f32 v172, 0x3acccccd, v172
    v_mfma_f32_16x16x32_bf16 v[64:67], v[120:123], a[140:143], v[64:67]
    ds_read_b128 v[100:103], v4 offset:15360
    v_mfma_f32_16x16x32_bf16 v[40:43], v[124:127], a[60:63], v[40:43]
    ds_read_b128 v[104:107], v4 offset:16384
    v_mul_f32 v173, 0x3acccccd, v173
    v_mfma_f32_16x16x32_bf16 v[68:71], v[124:127], a[140:143], v[68:71]
    ds_read_b128 v[108:111], v4 offset:17408
    v_add_f32 v176, v176, v184
    v_mfma_f32_16x16x32_bf16 v[44:47], v[128:131], a[60:63], v[44:47]
    ds_read_b128 v[112:115], v4 offset:18432
    v_add_f32 v177, v177, v185
    v_mfma_f32_16x16x32_bf16 v[72:75], v[128:131], a[140:143], v[72:75]
    v_mul_f32 v176, 0x3acccccd, v176
    v_mfma_f32_16x16x32_bf16 v[48:51], v[132:135], a[60:63], v[48:51]
    v_mul_f32 v177, 0x3acccccd, v177
    v_mfma_f32_16x16x32_bf16 v[76:79], v[132:135], a[140:143], v[76:79]
    v_mfma_f32_16x16x32_bf16 v[52:55], v[136:139], a[60:63], v[52:55]
    v_mfma_f32_16x16x32_bf16 v[80:83], v[136:139], a[140:143], v[80:83]
    v_mfma_f32_16x16x32_bf16 v[56:59], v[140:143], a[60:63], v[56:59]
    v_mfma_f32_16x16x32_bf16 v[84:87], v[140:143], a[140:143], v[84:87]
    buffer_load_dwordx4 v[160:163], v237, s[8:11], s52 offen offset:256 sc1
    s_waitcnt vmcnt(11)
    s_waitcnt lgkmcnt(0)
    v_mfma_f32_16x16x32_bf16 v[32:35], v[88:91], a[64:67], v[32:35]
    ds_read_b128 v[116:119], v4 offset:19456
    v_fma_f32 v173, -v172, v172, v173
    v_mfma_f32_16x16x32_bf16 v[60:63], v[88:91], a[144:147], v[60:63]
    ds_read_b128 v[120:123], v4 offset:20480
    v_max_f32 v173, 0, v173
    v_mfma_f32_16x16x32_bf16 v[36:39], v[92:95], a[64:67], v[36:39]
    ds_read_b128 v[124:127], v4 offset:21504
    v_add_f32 v173, 0x3727c5ac, v173
    v_mfma_f32_16x16x32_bf16 v[64:67], v[92:95], a[144:147], v[64:67]
    ds_read_b128 v[128:131], v4 offset:22528
    v_mfma_f32_16x16x32_bf16 v[40:43], v[96:99], a[64:67], v[40:43]
    ds_read_b128 v[132:135], v4 offset:23552
    v_rsq_f32 v174, v173
    v_mfma_f32_16x16x32_bf16 v[68:71], v[96:99], a[144:147], v[68:71]
    ds_read_b128 v[136:139], v4 offset:24576
    v_fma_f32 v177, -v176, v176, v177
    v_mfma_f32_16x16x32_bf16 v[44:47], v[100:103], a[64:67], v[44:47]
    ds_read_b128 v[140:143], v4 offset:25600
    v_max_f32 v177, 0, v177
    v_mfma_f32_16x16x32_bf16 v[72:75], v[100:103], a[144:147], v[72:75]
    v_add_f32 v177, 0x3727c5ac, v177
    v_mfma_f32_16x16x32_bf16 v[48:51], v[104:107], a[64:67], v[48:51]
    v_rsq_f32 v178, v177
    v_mfma_f32_16x16x32_bf16 v[76:79], v[104:107], a[144:147], v[76:79]
    v_mfma_f32_16x16x32_bf16 v[52:55], v[108:111], a[64:67], v[52:55]
    v_mfma_f32_16x16x32_bf16 v[80:83], v[108:111], a[144:147], v[80:83]
    v_mfma_f32_16x16x32_bf16 v[56:59], v[112:115], a[64:67], v[56:59]
    v_mfma_f32_16x16x32_bf16 v[84:87], v[112:115], a[144:147], v[84:87]
    buffer_load_dwordx4 v[164:167], v237, s[8:11], s52 offen offset:320 sc1
    s_waitcnt vmcnt(9)
    s_waitcnt lgkmcnt(0)
    v_mfma_f32_16x16x32_bf16 v[32:35], v[116:119], a[68:71], v[32:35]
    ds_read_b128 v[88:91], v4 offset:26624
    v_mul_f32 v175, v173, v174
    v_mfma_f32_16x16x32_bf16 v[60:63], v[116:119], a[148:151], v[60:63]
    ds_read_b128 v[92:95], v4 offset:27648
    v_sub_f32 v186, 0, v172
    v_mfma_f32_16x16x32_bf16 v[36:39], v[120:123], a[68:71], v[36:39]
    ds_read_b128 v[96:99], v4 offset:28672
    v_mul_f32 v187, 0xc0135761, v174
    v_mfma_f32_16x16x32_bf16 v[64:67], v[120:123], a[148:151], v[64:67]
    ds_read_b128 v[100:103], v4 offset:29696
    v_mfma_f32_16x16x32_bf16 v[40:43], v[124:127], a[68:71], v[40:43]
    ds_read_b128 v[104:107], v4 offset:30720
    v_mul_f32 v182, v174, v174
    v_mfma_f32_16x16x32_bf16 v[68:71], v[124:127], a[148:151], v[68:71]
    ds_read_b128 v[108:111], v4 offset:31744
    v_mul_f32 v188, 0xbdd2d3e8, v174
    v_mfma_f32_16x16x32_bf16 v[44:47], v[128:131], a[68:71], v[44:47]
    ds_read_b128 v[112:115], v4 offset:32768
    v_mul_f32 v179, v177, v178
    v_mfma_f32_16x16x32_bf16 v[72:75], v[128:131], a[148:151], v[72:75]
    v_sub_f32 v190, 0, v176
    v_mfma_f32_16x16x32_bf16 v[48:51], v[132:135], a[68:71], v[48:51]
    v_mul_f32 v191, 0xc0135761, v178
    v_mfma_f32_16x16x32_bf16 v[76:79], v[132:135], a[148:151], v[76:79]
    v_mul_f32 v183, v178, v178
    v_mfma_f32_16x16x32_bf16 v[52:55], v[136:139], a[68:71], v[52:55]
    v_mfma_f32_16x16x32_bf16 v[80:83], v[136:139], a[148:151], v[80:83]
    v_mul_f32 v192, 0xbdd2d3e8, v178
    v_mfma_f32_16x16x32_bf16 v[56:59], v[140:143], a[68:71], v[56:59]
    v_mfma_f32_16x16x32_bf16 v[84:87], v[140:143], a[148:151], v[84:87]
    buffer_load_dwordx4 v[168:171], v237, s[8:11], s52 offen offset:384 sc1
    s_waitcnt vmcnt(7)
    s_waitcnt lgkmcnt(0)
    v_mfma_f32_16x16x32_bf16 v[32:35], v[88:91], a[72:75], v[32:35]
    ds_read_b128 v[116:119], v4 offset:33792
    v_mul_f32 v188, v188, v182
    v_mfma_f32_16x16x32_bf16 v[60:63], v[88:91], a[152:155], v[60:63]
    ds_read_b128 v[120:123], v4 offset:34816
    v_mov_b32 v189, v175
    v_mfma_f32_16x16x32_bf16 v[36:39], v[92:95], a[72:75], v[36:39]
    ds_read_b128 v[124:127], v4 offset:35840
    v_mul_f32 v192, v192, v183
    v_mfma_f32_16x16x32_bf16 v[64:67], v[92:95], a[152:155], v[64:67]
    ds_read_b128 v[128:131], v4 offset:36864
    v_mfma_f32_16x16x32_bf16 v[40:43], v[96:99], a[72:75], v[40:43]
    ds_read_b128 v[132:135], v4 offset:37888
    v_mov_b32 v193, v179
    v_mfma_f32_16x16x32_bf16 v[68:71], v[96:99], a[152:155], v[68:71]
    ds_read_b128 v[136:139], v4 offset:38912
    v_mfma_f32_16x16x32_bf16 v[44:47], v[100:103], a[72:75], v[44:47]
    ds_read_b128 v[140:143], v4 offset:39936
    v_mfma_f32_16x16x32_bf16 v[72:75], v[100:103], a[152:155], v[72:75]
    v_mfma_f32_16x16x32_bf16 v[48:51], v[104:107], a[72:75], v[48:51]
    v_mfma_f32_16x16x32_bf16 v[76:79], v[104:107], a[152:155], v[76:79]
    v_mfma_f32_16x16x32_bf16 v[52:55], v[108:111], a[72:75], v[52:55]
    v_mfma_f32_16x16x32_bf16 v[80:83], v[108:111], a[152:155], v[80:83]
    v_mfma_f32_16x16x32_bf16 v[56:59], v[112:115], a[72:75], v[56:59]
    v_mfma_f32_16x16x32_bf16 v[84:87], v[112:115], a[152:155], v[84:87]
    s_add_u32 m0, s28, 40960
    s_add_u32 s63, s89, 0
    buffer_load_dwordx4 v4, s[8:11], s63 offen sc1 lds
    s_waitcnt vmcnt(5)
    s_waitcnt lgkmcnt(0)
    v_mfma_f32_16x16x32_bf16 v[32:35], v[116:119], a[76:79], v[32:35]
    v_mfma_f32_16x16x32_bf16 v[60:63], v[116:119], a[156:159], v[60:63]
    v_mfma_f32_16x16x32_bf16 v[36:39], v[120:123], a[76:79], v[36:39]
    v_mfma_f32_16x16x32_bf16 v[64:67], v[120:123], a[156:159], v[64:67]
    v_mfma_f32_16x16x32_bf16 v[40:43], v[124:127], a[76:79], v[40:43]
    v_mfma_f32_16x16x32_bf16 v[68:71], v[124:127], a[156:159], v[68:71]
    v_mfma_f32_16x16x32_bf16 v[44:47], v[128:131], a[76:79], v[44:47]
    s_add_u32 m0, s28, 45056
    s_add_u32 s63, s89, 4096
    buffer_load_dwordx4 v4, s[8:11], s63 offen sc1 lds
    v_mfma_f32_16x16x32_bf16 v[72:75], v[128:131], a[156:159], v[72:75]
    v_mfma_f32_16x16x32_bf16 v[48:51], v[132:135], a[76:79], v[48:51]
    v_mfma_f32_16x16x32_bf16 v[76:79], v[132:135], a[156:159], v[76:79]
    v_mfma_f32_16x16x32_bf16 v[52:55], v[136:139], a[76:79], v[52:55]
    v_mfma_f32_16x16x32_bf16 v[80:83], v[136:139], a[156:159], v[80:83]
    v_mfma_f32_16x16x32_bf16 v[56:59], v[140:143], a[76:79], v[56:59]
    v_mfma_f32_16x16x32_bf16 v[84:87], v[140:143], a[156:159], v[84:87]
    s_sub_u32 s59, s3, 0
    s_min_u32 s59, s59, 1
    s_lshl_b32 s59, s59, 10
    s_sub_u32 s63, s89, s28
    s_add_u32 s63, s63, s59
    s_add_u32 s63, s63, 8192
    s_add_u32 s59, s59, 49152
    s_sub_u32 m0, s59, 153600
    s_cmp_ge_u32 s59, 153600
    s_cselect_b32 m0, m0, s59
    s_nop 0
    buffer_load_dwordx4 v4, s[8:11], s63 offen sc1 lds
    s_barrier
    s_waitcnt vmcnt(3)
    v_pk_fma_f32 v[32:33], v[144:145], v[186:187], v[32:33] op_sel_hi:[1,0,1]
    v_pk_fma_f32 v[34:35], v[146:147], v[186:187], v[34:35] op_sel_hi:[1,0,1]
    v_pk_fma_f32 v[36:37], v[148:149], v[186:187], v[36:37] op_sel_hi:[1,0,1]
    v_pk_fma_f32 v[38:39], v[150:151], v[186:187], v[38:39] op_sel_hi:[1,0,1]
    v_pk_fma_f32 v[40:41], v[152:153], v[186:187], v[40:41] op_sel_hi:[1,0,1]
    v_pk_fma_f32 v[42:43], v[154:155], v[186:187], v[42:43] op_sel_hi:[1,0,1]
    v_pk_fma_f32 v[44:45], v[156:157], v[186:187], v[44:45] op_sel_hi:[1,0,1]
    v_pk_mul_f32 v[100:101], v[32:33], v[32:33]
    v_pk_mul_f32 v[104:105], v[34:35], v[34:35]
    v_pk_mul_f32 v[108:109], v[36:37], v[36:37]
    v_pk_mul_f32 v[112:113], v[38:39], v[38:39]
    v_pk_mul_f32 v[116:117], v[40:41], v[40:41]
    v_pk_mul_f32 v[120:121], v[42:43], v[42:43]
    v_pk_mul_f32 v[124:125], v[44:45], v[44:45]
    v_pk_fma_f32 v[100:101], v[100:101], v[188:189], v[186:187] op_sel:[0,0,1] op_sel_hi:[1,0,1]
    v_pk_fma_f32 v[104:105], v[104:105], v[188:189], v[186:187] op_sel:[0,0,1] op_sel_hi:[1,0,1]
    v_pk_fma_f32 v[108:109], v[108:109], v[188:189], v[186:187] op_sel:[0,0,1] op_sel_hi:[1,0,1]
    v_pk_fma_f32 v[112:113], v[112:113], v[188:189], v[186:187] op_sel:[0,0,1] op_sel_hi:[1,0,1]
    v_pk_fma_f32 v[116:117], v[116:117], v[188:189], v[186:187] op_sel:[0,0,1] op_sel_hi:[1,0,1]
    v_pk_fma_f32 v[120:121], v[120:121], v[188:189], v[186:187] op_sel:[0,0,1] op_sel_hi:[1,0,1]
    v_pk_fma_f32 v[124:125], v[124:125], v[188:189], v[186:187] op_sel:[0,0,1] op_sel_hi:[1,0,1]
    v_pk_mul_f32 v[100:101], v[100:101], v[32:33]
    s_add_u32 m0, s28, 51200
    s_add_u32 s63, s89, 10240
    buffer_load_dwordx4 v4, s[8:11], s63 offen sc1 lds
    v_pk_mul_f32 v[104:105], v[104:105], v[34:35]
    v_pk_mul_f32 v[108:109], v[108:109], v[36:37]
    v_pk_mul_f32 v[112:113], v[112:113], v[38:39]
    v_pk_mul_f32 v[116:117], v[116:117], v[40:41]
    v_pk_mul_f32 v[120:121], v[120:121], v[42:43]
    v_pk_mul_f32 v[124:125], v[124:125], v[44:45]
    v_exp_f32 v102, v100
    v_exp_f32 v103, v101
    v_exp_f32 v106, v104
    v_exp_f32 v107, v105
    v_exp_f32 v110, v108
    v_exp_f32 v111, v109
    v_exp_f32 v114, v112
    v_exp_f32 v115, v113
    v_exp_f32 v118, v116
    s_add_u32 m0, s28, 55296
    s_add_u32 s63, s89, 14336
    buffer_load_dwordx4 v4, s[8:11], s63 offen sc1 lds
    v_exp_f32 v119, v117
    v_exp_f32 v122, v120
    v_exp_f32 v123, v121
    v_exp_f32 v126, v124
    v_exp_f32 v127, v125
    v_pk_fma_f32 v[102:103], v[102:103], v[188:189], v[188:189] op_sel:[0,1,1] op_sel_hi:[1,1,1]
    v_pk_fma_f32 v[106:107], v[106:107], v[188:189], v[188:189] op_sel:[0,1,1] op_sel_hi:[1,1,1]
    v_pk_fma_f32 v[110:111], v[110:111], v[188:189], v[188:189] op_sel:[0,1,1] op_sel_hi:[1,1,1]
    v_pk_fma_f32 v[114:115], v[114:115], v[188:189], v[188:189] op_sel:[0,1,1] op_sel_hi:[1,1,1]
    v_pk_fma_f32 v[118:119], v[118:119], v[188:189], v[188:189] op_sel:[0,1,1] op_sel_hi:[1,1,1]
    v_pk_fma_f32 v[122:123], v[122:123], v[188:189], v[188:189] op_sel:[0,1,1] op_sel_hi:[1,1,1]
    v_pk_fma_f32 v[126:127], v[126:127], v[188:189], v[188:189] op_sel:[0,1,1] op_sel_hi:[1,1,1]
    v_rcp_f32 v100, v102
    v_rcp_f32 v101, v103
    v_rcp_f32 v104, v106
    s_add_u32 m0, s28, 59392
    s_add_u32 s63, s89, 18432
    buffer_load_dwordx4 v4, s[8:11], s63 offen sc1 lds
    v_rcp_f32 v105, v107
    v_rcp_f32 v108, v110
    v_rcp_f32 v109, v111
    v_rcp_f32 v112, v114
    v_rcp_f32 v113, v115
    v_rcp_f32 v116, v118
    v_rcp_f32 v117, v119
    v_rcp_f32 v120, v122
    v_rcp_f32 v121, v123
    v_rcp_f32 v124, v126
    v_rcp_f32 v125, v127
    v_pk_mul_f32 v[32:33], v[32:33], v[100:101]
    s_add_u32 m0, s28, 63488
    s_add_u32 s63, s89, 22528
    buffer_load_dwordx4 v4, s[8:11], s63 offen sc1 lds
    v_pk_mul_f32 v[34:35], v[34:35], v[104:105]
    v_pk_mul_f32 v[36:37], v[36:37], v[108:109]
    v_pk_mul_f32 v[38:39], v[38:39], v[112:113]
    v_pk_mul_f32 v[40:41], v[40:41], v[116:117]
    v_pk_mul_f32 v[42:43], v[42:43], v[120:121]
    v_pk_mul_f32 v[44:45], v[44:45], v[124:125]
    v_pk_fma_f32 v[46:47], v[158:159], v[186:187], v[46:47] op_sel_hi:[1,0,1]
    v_pk_fma_f32 v[48:49], v[160:161], v[186:187], v[48:49] op_sel_hi:[1,0,1]
    v_pk_fma_f32 v[50:51], v[162:163], v[186:187], v[50:51] op_sel_hi:[1,0,1]
    v_pk_fma_f32 v[52:53], v[164:165], v[186:187], v[52:53] op_sel_hi:[1,0,1]
    v_pk_fma_f32 v[54:55], v[166:167], v[186:187], v[54:55] op_sel_hi:[1,0,1]
    v_pk_fma_f32 v[56:57], v[168:169], v[186:187], v[56:57] op_sel_hi:[1,0,1]
    v_pk_fma_f32 v[58:59], v[170:171], v[186:187], v[58:59] op_sel_hi:[1,0,1]
    v_pk_mul_f32 v[100:101], v[46:47], v[46:47]
    v_pk_mul_f32 v[104:105], v[48:49], v[48:49]
    v_pk_mul_f32 v[108:109], v[50:51], v[50:51]
    v_pk_mul_f32 v[112:113], v[52:53], v[52:53]
    v_pk_mul_f32 v[116:117], v[54:55], v[54:55]
    v_pk_mul_f32 v[120:121], v[56:57], v[56:57]
    v_pk_mul_f32 v[124:125], v[58:59], v[58:59]
    v_pk_fma_f32 v[100:101], v[100:101], v[188:189], v[186:187] op_sel:[0,0,1] op_sel_hi:[1,0,1]
    v_pk_fma_f32 v[104:105], v[104:105], v[188:189], v[186:187] op_sel:[0,0,1] op_sel_hi:[1,0,1]
    v_pk_fma_f32 v[108:109], v[108:109], v[188:189], v[186:187] op_sel:[0,0,1] op_sel_hi:[1,0,1]
    s_add_u32 m0, s28, 67584
    s_add_u32 s63, s89, 26624
    buffer_load_dwordx4 v4, s[8:11], s63 offen sc1 lds
    v_pk_fma_f32 v[112:113], v[112:113], v[188:189], v[186:187] op_sel:[0,0,1] op_sel_hi:[1,0,1]
    v_pk_fma_f32 v[116:117], v[116:117], v[188:189], v[186:187] op_sel:[0,0,1] op_sel_hi:[1,0,1]
    v_pk_fma_f32 v[120:121], v[120:121], v[188:189], v[186:187] op_sel:[0,0,1] op_sel_hi:[1,0,1]
    v_pk_fma_f32 v[124:125], v[124:125], v[188:189], v[186:187] op_sel:[0,0,1] op_sel_hi:[1,0,1]
    v_pk_mul_f32 v[100:101], v[100:101], v[46:47]
    v_pk_mul_f32 v[104:105], v[104:105], v[48:49]
    v_pk_mul_f32 v[108:109], v[108:109], v[50:51]
    v_pk_mul_f32 v[112:113], v[112:113], v[52:53]
    v_pk_mul_f32 v[116:117], v[116:117], v[54:55]
    v_pk_mul_f32 v[120:121], v[120:121], v[56:57]
    v_pk_mul_f32 v[124:125], v[124:125], v[58:59]
    v_exp_f32 v102, v100
    v_exp_f32 v103, v101
    v_exp_f32 v106, v104
    v_exp_f32 v107, v105
    v_exp_f32 v110, v108
    v_exp_f32 v111, v109
    s_add_u32 m0, s28, 71680
    s_add_u32 s63, s89, 30720
    buffer_load_dwordx4 v4, s[8:11], s63 offen sc1 lds
    v_exp_f32 v114, v112
    v_exp_f32 v115, v113
    v_exp_f32 v118, v116
    v_exp_f32 v119, v117
    v_exp_f32 v122, v120
    v_exp_f32 v123, v121
    v_exp_f32 v126, v124
    v_exp_f32 v127, v125
    v_pk_fma_f32 v[102:103], v[102:103], v[188:189], v[188:189] op_sel:[0,1,1] op_sel_hi:[1,1,1]
    v_pk_fma_f32 v[106:107], v[106:107], v[188:189], v[188:189] op_sel:[0,1,1] op_sel_hi:[1,1,1]
    v_pk_fma_f32 v[110:111], v[110:111], v[188:189], v[188:189] op_sel:[0,1,1] op_sel_hi:[1,1,1]
    v_pk_fma_f32 v[114:115], v[114:115], v[188:189], v[188:189] op_sel:[0,1,1] op_sel_hi:[1,1,1]
    v_pk_fma_f32 v[118:119], v[118:119], v[188:189], v[188:189] op_sel:[0,1,1] op_sel_hi:[1,1,1]
    v_pk_fma_f32 v[122:123], v[122:123], v[188:189], v[188:189] op_sel:[0,1,1] op_sel_hi:[1,1,1]
    v_pk_fma_f32 v[126:127], v[126:127], v[188:189], v[188:189] op_sel:[0,1,1] op_sel_hi:[1,1,1]
    s_add_u32 m0, s28, 75776
    s_add_u32 s63, s89, 34816
    buffer_load_dwordx4 v4, s[8:11], s63 offen sc1 lds
    v_rcp_f32 v100, v102
    v_rcp_f32 v101, v103
    v_rcp_f32 v104, v106
    v_rcp_f32 v105, v107
    v_rcp_f32 v108, v110
    v_rcp_f32 v109, v111
    v_rcp_f32 v112, v114
    v_rcp_f32 v113, v115
    v_rcp_f32 v116, v118
    v_rcp_f32 v117, v119
    v_rcp_f32 v120, v122
    v_rcp_f32 v121, v123
    s_add_u32 m0, s28, 79872
    s_add_u32 s63, s89, 38912
    buffer_load_dwordx4 v4, s[8:11], s63 offen sc1 lds
    v_rcp_f32 v124, v126
    v_rcp_f32 v125, v127
    v_pk_mul_f32 v[46:47], v[46:47], v[100:101]
    v_pk_mul_f32 v[48:49], v[48:49], v[104:105]
    v_pk_mul_f32 v[50:51], v[50:51], v[108:109]
    v_pk_mul_f32 v[52:53], v[52:53], v[112:113]
    v_pk_mul_f32 v[54:55], v[54:55], v[116:117]
    v_pk_mul_f32 v[56:57], v[56:57], v[120:121]
    v_pk_mul_f32 v[58:59], v[58:59], v[124:125]
    v_cvt_pk_bf16_f32 v200, v32, v33
    v_cvt_pk_bf16_f32 v201, v34, v35
    v_cvt_pk_bf16_f32 v202, v36, v37
    v_cvt_pk_bf16_f32 v203, v38, v39
    v_cvt_pk_bf16_f32 v204, v40, v41
    v_cvt_pk_bf16_f32 v205, v42, v43
    v_cvt_pk_bf16_f32 v206, v44, v45
    v_cvt_pk_bf16_f32 v207, v46, v47
    v_cvt_pk_bf16_f32 v208, v48, v49
    v_cvt_pk_bf16_f32 v209, v50, v51
    v_cvt_pk_bf16_f32 v210, v52, v53
    v_cvt_pk_bf16_f32 v211, v54, v55
    s_add_u32 m0, s28, 83968
    s_add_u32 s63, s89, 43008
    buffer_load_dwordx4 v4, s[8:11], s63 offen sc1 lds
    v_cvt_pk_bf16_f32 v212, v56, v57
    v_cvt_pk_bf16_f32 v213, v58, v59
    v_permlane16_swap_b32 v200, v202
    v_permlane16_swap_b32 v201, v203
    v_permlane16_swap_b32 v204, v206
    v_permlane16_swap_b32 v205, v207
    v_permlane16_swap_b32 v208, v210
    v_permlane16_swap_b32 v209, v211
    v_permlane16_swap_b32 v212, v214
    v_permlane16_swap_b32 v213, v215
    v_mov_b32 v232, s24
    v_mov_b32 v233, s25
    v_cndmask_b32 v232, v232, v233, s[48:49]
    v_add_u32 v232, v232, v194
    buffer_store_dwordx4 v[200:203], v232, s[8:11], 0 offen sc1
    v_mov_b32 v232, s25
    v_mov_b32 v233, s26
    v_cndmask_b32 v232, v232, v233, s[48:49]
    v_add_u32 v232, v232, v194
    buffer_store_dwordx4 v[204:207], v232, s[8:11], 0 offen sc1
    v_mov_b32 v232, s26
    v_mov_b32 v233, s27
    v_cndmask_b32 v232, v232, v233, s[48:49]
    v_add_u32 v232, v232, v194
    buffer_store_dwordx4 v[208:211], v232, s[8:11], 0 offen sc1
    s_cmp_lg_u32 s45, 0
    s_cselect_b32 s33, s27, 0x7f000000
    v_add_u32 v232, s33, v195
    buffer_store_dwordx4 v[212:215], v232, s[8:11], 0 offen sc1
    v_pk_fma_f32 v[60:61], v[144:145], v[190:191], v[60:61] op_sel_hi:[1,0,1]
    v_pk_fma_f32 v[62:63], v[146:147], v[190:191], v[62:63] op_sel_hi:[1,0,1]
    v_pk_fma_f32 v[64:65], v[148:149], v[190:191], v[64:65] op_sel_hi:[1,0,1]
    v_pk_fma_f32 v[66:67], v[150:151], v[190:191], v[66:67] op_sel_hi:[1,0,1]
    v_pk_fma_f32 v[68:69], v[152:153], v[190:191], v[68:69] op_sel_hi:[1,0,1]
    v_pk_fma_f32 v[70:71], v[154:155], v[190:191], v[70:71] op_sel_hi:[1,0,1]
    v_pk_fma_f32 v[72:73], v[156:157], v[190:191], v[72:73] op_sel_hi:[1,0,1]
    v_pk_mul_f32 v[100:101], v[60:61], v[60:61]
    v_pk_mul_f32 v[104:105], v[62:63], v[62:63]
    v_pk_mul_f32 v[108:109], v[64:65], v[64:65]
    v_pk_mul_f32 v[112:113], v[66:67], v[66:67]
    v_pk_mul_f32 v[116:117], v[68:69], v[68:69]
    v_pk_mul_f32 v[120:121], v[70:71], v[70:71]
    v_pk_mul_f32 v[124:125], v[72:73], v[72:73]
    v_pk_fma_f32 v[100:101], v[100:101], v[192:193], v[190:191] op_sel:[0,0,1] op_sel_hi:[1,0,1]
    v_pk_fma_f32 v[104:105], v[104:105], v[192:193], v[190:191] op_sel:[0,0,1] op_sel_hi:[1,0,1]
    v_pk_fma_f32 v[108:109], v[108:109], v[192:193], v[190:191] op_sel:[0,0,1] op_sel_hi:[1,0,1]
    v_pk_fma_f32 v[112:113], v[112:113], v[192:193], v[190:191] op_sel:[0,0,1] op_sel_hi:[1,0,1]
    v_pk_fma_f32 v[116:117], v[116:117], v[192:193], v[190:191] op_sel:[0,0,1] op_sel_hi:[1,0,1]
    v_pk_fma_f32 v[120:121], v[120:121], v[192:193], v[190:191] op_sel:[0,0,1] op_sel_hi:[1,0,1]
    v_pk_fma_f32 v[124:125], v[124:125], v[192:193], v[190:191] op_sel:[0,0,1] op_sel_hi:[1,0,1]
    v_pk_mul_f32 v[100:101], v[100:101], v[60:61]
    v_pk_mul_f32 v[104:105], v[104:105], v[62:63]
    s_add_u32 m0, s28, 88064
    s_add_u32 s63, s89, 47104
    buffer_load_dwordx4 v4, s[8:11], s63 offen sc1 lds
    v_pk_mul_f32 v[108:109], v[108:109], v[64:65]
    v_pk_mul_f32 v[112:113], v[112:113], v[66:67]
    v_pk_mul_f32 v[116:117], v[116:117], v[68:69]
    v_pk_mul_f32 v[120:121], v[120:121], v[70:71]
    v_pk_mul_f32 v[124:125], v[124:125], v[72:73]
    v_exp_f32 v102, v100
    v_exp_f32 v103, v101
    v_exp_f32 v106, v104
    v_exp_f32 v107, v105
    v_exp_f32 v110, v108
    v_exp_f32 v111, v109
    v_exp_f32 v114, v112
    v_exp_f32 v115, v113
    v_exp_f32 v118, v116
    s_add_u32 m0, s28, 92160
    s_add_u32 s63, s89, 51200
    buffer_load_dwordx4 v4, s[8:11], s63 offen sc1 lds
    v_exp_f32 v119, v117
    v_exp_f32 v122, v120
    v_exp_f32 v123, v121
    v_exp_f32 v126, v124
    v_exp_f32 v127, v125
    v_pk_fma_f32 v[102:103], v[102:103], v[192:193], v[192:193] op_sel:[0,1,1] op_sel_hi:[1,1,1]
    v_pk_fma_f32 v[106:107], v[106:107], v[192:193], v[192:193] op_sel:[0,1,1] op_sel_hi:[1,1,1]
    v_pk_fma_f32 v[110:111], v[110:111], v[192:193], v[192:193] op_sel:[0,1,1] op_sel_hi:[1,1,1]
    v_pk_fma_f32 v[114:115], v[114:115], v[192:193], v[192:193] op_sel:[0,1,1] op_sel_hi:[1,1,1]
    v_pk_fma_f32 v[118:119], v[118:119], v[192:193], v[192:193] op_sel:[0,1,1] op_sel_hi:[1,1,1]
    v_pk_fma_f32 v[122:123], v[122:123], v[192:193], v[192:193] op_sel:[0,1,1] op_sel_hi:[1,1,1]
    v_pk_fma_f32 v[126:127], v[126:127], v[192:193], v[192:193] op_sel:[0,1,1] op_sel_hi:[1,1,1]
    v_rcp_f32 v100, v102
    v_rcp_f32 v101, v103
    v_rcp_f32 v104, v106
    s_add_u32 m0, s28, 96256
    s_add_u32 s63, s89, 55296
    buffer_load_dwordx4 v4, s[8:11], s63 offen sc1 lds
    v_rcp_f32 v105, v107
    v_rcp_f32 v108, v110
    v_rcp_f32 v109, v111
    v_rcp_f32 v112, v114
    v_rcp_f32 v113, v115
    v_rcp_f32 v116, v118
    v_rcp_f32 v117, v119
    v_rcp_f32 v120, v122
    v_rcp_f32 v121, v123
    v_rcp_f32 v124, v126
    v_rcp_f32 v125, v127
    v_pk_mul_f32 v[60:61], v[60:61], v[100:101]
    s_add_u32 m0, s28, 100352
    s_add_u32 s63, s89, 59392
    buffer_load_dwordx4 v4, s[8:11], s63 offen sc1 lds
    v_pk_mul_f32 v[62:63], v[62:63], v[104:105]
    v_pk_mul_f32 v[64:65], v[64:65], v[108:109]
    v_pk_mul_f32 v[66:67], v[66:67], v[112:113]
    v_pk_mul_f32 v[68:69], v[68:69], v[116:117]
    v_pk_mul_f32 v[70:71], v[70:71], v[120:121]
    v_pk_mul_f32 v[72:73], v[72:73], v[124:125]
    v_pk_fma_f32 v[74:75], v[158:159], v[190:191], v[74:75] op_sel_hi:[1,0,1]
    v_pk_fma_f32 v[76:77], v[160:161], v[190:191], v[76:77] op_sel_hi:[1,0,1]
    v_pk_fma_f32 v[78:79], v[162:163], v[190:191], v[78:79] op_sel_hi:[1,0,1]
    v_pk_fma_f32 v[80:81], v[164:165], v[190:191], v[80:81] op_sel_hi:[1,0,1]
    v_pk_fma_f32 v[82:83], v[166:167], v[190:191], v[82:83] op_sel_hi:[1,0,1]
    v_pk_fma_f32 v[84:85], v[168:169], v[190:191], v[84:85] op_sel_hi:[1,0,1]
    v_pk_fma_f32 v[86:87], v[170:171], v[190:191], v[86:87] op_sel_hi:[1,0,1]
    v_pk_mul_f32 v[100:101], v[74:75], v[74:75]
    v_pk_mul_f32 v[104:105], v[76:77], v[76:77]
    v_pk_mul_f32 v[108:109], v[78:79], v[78:79]
    v_pk_mul_f32 v[112:113], v[80:81], v[80:81]
    v_pk_mul_f32 v[116:117], v[82:83], v[82:83]
    v_pk_mul_f32 v[120:121], v[84:85], v[84:85]
    v_pk_mul_f32 v[124:125], v[86:87], v[86:87]
    v_pk_fma_f32 v[100:101], v[100:101], v[192:193], v[190:191] op_sel:[0,0,1] op_sel_hi:[1,0,1]
    v_pk_fma_f32 v[104:105], v[104:105], v[192:193], v[190:191] op_sel:[0,0,1] op_sel_hi:[1,0,1]
    v_pk_fma_f32 v[108:109], v[108:109], v[192:193], v[190:191] op_sel:[0,0,1] op_sel_hi:[1,0,1]
    s_add_u32 m0, s28, 104448
    s_add_u32 s63, s89, 63488
    buffer_load_dwordx4 v4, s[8:11], s63 offen sc1 lds
    v_pk_fma_f32 v[112:113], v[112:113], v[192:193], v[190:191] op_sel:[0,0,1] op_sel_hi:[1,0,1]
    v_pk_fma_f32 v[116:117], v[116:117], v[192:193], v[190:191] op_sel:[0,0,1] op_sel_hi:[1,0,1]
    v_pk_fma_f32 v[120:121], v[120:121], v[192:193], v[190:191] op_sel:[0,0,1] op_sel_hi:[1,0,1]
    v_pk_fma_f32 v[124:125], v[124:125], v[192:193], v[190:191] op_sel:[0,0,1] op_sel_hi:[1,0,1]
    v_pk_mul_f32 v[100:101], v[100:101], v[74:75]
    v_pk_mul_f32 v[104:105], v[104:105], v[76:77]
    v_pk_mul_f32 v[108:109], v[108:109], v[78:79]
    v_pk_mul_f32 v[112:113], v[112:113], v[80:81]
    v_pk_mul_f32 v[116:117], v[116:117], v[82:83]
    v_pk_mul_f32 v[120:121], v[120:121], v[84:85]
    v_pk_mul_f32 v[124:125], v[124:125], v[86:87]
    v_exp_f32 v102, v100
    v_exp_f32 v103, v101
    v_exp_f32 v106, v104
    v_exp_f32 v107, v105
    v_exp_f32 v110, v108
    v_exp_f32 v111, v109
    s_add_u32 m0, s28, 108544
    s_add_u32 s63, s89, 67584
    buffer_load_dwordx4 v4, s[8:11], s63 offen sc1 lds
    v_exp_f32 v114, v112
    v_exp_f32 v115, v113
    v_exp_f32 v118, v116
    v_exp_f32 v119, v117
    v_exp_f32 v122, v120
    v_exp_f32 v123, v121
    v_exp_f32 v126, v124
    v_exp_f32 v127, v125
    v_pk_fma_f32 v[102:103], v[102:103], v[192:193], v[192:193] op_sel:[0,1,1] op_sel_hi:[1,1,1]
    v_pk_fma_f32 v[106:107], v[106:107], v[192:193], v[192:193] op_sel:[0,1,1] op_sel_hi:[1,1,1]
    v_pk_fma_f32 v[110:111], v[110:111], v[192:193], v[192:193] op_sel:[0,1,1] op_sel_hi:[1,1,1]
    v_pk_fma_f32 v[114:115], v[114:115], v[192:193], v[192:193] op_sel:[0,1,1] op_sel_hi:[1,1,1]
    v_pk_fma_f32 v[118:119], v[118:119], v[192:193], v[192:193] op_sel:[0,1,1] op_sel_hi:[1,1,1]
    v_pk_fma_f32 v[122:123], v[122:123], v[192:193], v[192:193] op_sel:[0,1,1] op_sel_hi:[1,1,1]
    v_pk_fma_f32 v[126:127], v[126:127], v[192:193], v[192:193] op_sel:[0,1,1] op_sel_hi:[1,1,1]
    s_add_u32 m0, s28, 112640
    s_add_u32 s63, s89, 71680
    buffer_load_dwordx4 v4, s[8:11], s63 offen sc1 lds
    v_rcp_f32 v100, v102
    v_rcp_f32 v101, v103
    v_rcp_f32 v104, v106
    v_rcp_f32 v105, v107
    v_rcp_f32 v108, v110
    v_rcp_f32 v109, v111
    v_rcp_f32 v112, v114
    v_rcp_f32 v113, v115
    v_rcp_f32 v116, v118
    v_rcp_f32 v117, v119
    v_rcp_f32 v120, v122
    v_rcp_f32 v121, v123
    s_add_u32 m0, s28, 116736
    s_add_u32 s63, s89, 75776
    buffer_load_dwordx4 v4, s[8:11], s63 offen sc1 lds
    v_rcp_f32 v124, v126
    v_rcp_f32 v125, v127
    v_pk_mul_f32 v[74:75], v[74:75], v[100:101]
    v_pk_mul_f32 v[76:77], v[76:77], v[104:105]
    v_pk_mul_f32 v[78:79], v[78:79], v[108:109]
    v_pk_mul_f32 v[80:81], v[80:81], v[112:113]
    v_pk_mul_f32 v[82:83], v[82:83], v[116:117]
    v_pk_mul_f32 v[84:85], v[84:85], v[120:121]
    v_pk_mul_f32 v[86:87], v[86:87], v[124:125]
    v_cvt_pk_bf16_f32 v216, v60, v61
    v_cvt_pk_bf16_f32 v217, v62, v63
    v_cvt_pk_bf16_f32 v218, v64, v65
    v_cvt_pk_bf16_f32 v219, v66, v67
    v_cvt_pk_bf16_f32 v220, v68, v69
    v_cvt_pk_bf16_f32 v221, v70, v71
    v_cvt_pk_bf16_f32 v222, v72, v73
    v_cvt_pk_bf16_f32 v223, v74, v75
    v_cvt_pk_bf16_f32 v224, v76, v77
    v_cvt_pk_bf16_f32 v225, v78, v79
    v_cvt_pk_bf16_f32 v226, v80, v81
    v_cvt_pk_bf16_f32 v227, v82, v83
    s_add_u32 m0, s28, 120832
    s_add_u32 s63, s89, 79872
    buffer_load_dwordx4 v4, s[8:11], s63 offen sc1 lds
    v_cvt_pk_bf16_f32 v228, v84, v85
    v_cvt_pk_bf16_f32 v229, v86, v87
    v_permlane16_swap_b32 v216, v218
    v_permlane16_swap_b32 v217, v219
    v_permlane16_swap_b32 v220, v222
    v_permlane16_swap_b32 v221, v223
    v_permlane16_swap_b32 v224, v226
    v_permlane16_swap_b32 v225, v227
    v_permlane16_swap_b32 v228, v230
    v_permlane16_swap_b32 v229, v231
    v_mov_b32 v232, s12
    v_mov_b32 v233, s13
    v_cndmask_b32 v232, v232, v233, s[48:49]
    v_add_u32 v232, v232, v194
    buffer_store_dwordx4 v[216:219], v232, s[8:11], 0 offen sc1
    v_mov_b32 v232, s13
    v_mov_b32 v233, s14
    v_cndmask_b32 v232, v232, v233, s[48:49]
    v_add_u32 v232, v232, v194
    buffer_store_dwordx4 v[220:223], v232, s[8:11], 0 offen sc1
    v_mov_b32 v232, s14
    v_mov_b32 v233, s15
    v_cndmask_b32 v232, v232, v233, s[48:49]
    v_add_u32 v232, v232, v194
    buffer_store_dwordx4 v[224:227], v232, s[8:11], 0 offen sc1
    s_cmp_lg_u32 s45, 0
    s_cselect_b32 s33, s15, 0x7f000000
    v_add_u32 v232, s33, v195
    buffer_store_dwordx4 v[228:231], v232, s[8:11], 0 offen sc1
    s_waitcnt vmcnt(0)
    s_barrier
    s_cmp_lg_u32 s3, 0
    s_cbranch_scc1 L_sig_59
    s_lshl_b32 s32, s95, 2
    s_add_u32 s32, s32, 0x194c800
    v_lshlrev_b32 v240, 10, v1
    v_mov_b32 v241, s7
    s_mov_b64 exec, 1
    buffer_store_dword v241, v240, s[8:11], s32 offen sc1
    s_mov_b64 exec, -1
L_sig_59:
    s_add_u32 m0, s28, 124928
    s_add_u32 s63, s89, 83968
    buffer_load_dwordx4 v4, s[8:11], s63 offen sc1 lds
    s_add_u32 m0, s28, 129024
    s_add_u32 s63, s89, 88064
    buffer_load_dwordx4 v4, s[8:11], s63 offen sc1 lds
    s_add_u32 m0, s28, 133120
    s_add_u32 s63, s89, 92160
    buffer_load_dwordx4 v4, s[8:11], s63 offen sc1 lds
    s_add_u32 m0, s28, 137216
    s_add_u32 s63, s89, 96256
    buffer_load_dwordx4 v4, s[8:11], s63 offen sc1 lds
    s_add_u32 m0, s28, 141312
    s_add_u32 s63, s89, 100352
    buffer_load_dwordx4 v4, s[8:11], s63 offen sc1 lds
    s_add_u32 m0, s28, 145408
    s_add_u32 s63, s89, 104448
    buffer_load_dwordx4 v4, s[8:11], s63 offen sc1 lds
    s_add_u32 m0, s28, 149504
    s_add_u32 s63, s89, 108544
    buffer_load_dwordx4 v4, s[8:11], s63 offen sc1 lds
    s_add_u32 m0, s28, 0
    s_add_u32 s63, s89, 112640
    buffer_load_dwordx4 v4, s[8:11], s63 offen sc1 lds
    s_add_u32 m0, s28, 4096
    s_add_u32 s63, s89, 116736
    buffer_load_dwordx4 v4, s[8:11], s63 offen sc1 lds
    s_add_u32 m0, s28, 8192
    s_add_u32 s63, s89, 120832
    buffer_load_dwordx4 v4, s[8:11], s63 offen sc1 lds
    s_add_u32 m0, s28, 12288
    s_add_u32 s63, s89, 124928
    buffer_load_dwordx4 v4, s[8:11], s63 offen sc1 lds
    s_add_u32 m0, s28, 16384
    s_add_u32 s63, s89, 129024
    buffer_load_dwordx4 v4, s[8:11], s63 offen sc1 lds
    s_add_u32 m0, s28, 20480
    s_add_u32 s63, s89, 133120
    buffer_load_dwordx4 v4, s[8:11], s63 offen sc1 lds
    s_add_u32 m0, s28, 24576
    s_add_u32 s63, s89, 137216
    buffer_load_dwordx4 v4, s[8:11], s63 offen sc1 lds
    s_add_u32 m0, s28, 28672
    s_add_u32 s63, s89, 141312
    buffer_load_dwordx4 v4, s[8:11], s63 offen sc1 lds
    s_add_u32 m0, s28, 32768
    s_add_u32 s63, s89, 145408
    buffer_load_dwordx4 v4, s[8:11], s63 offen sc1 lds
    s_add_u32 m0, s28, 36864
    s_add_u32 s63, s89, 149504
    buffer_load_dwordx4 v4, s[8:11], s63 offen sc1 lds
    s_lshr_b32 s40, s4, 1
    s_lshl_b32 s40, s40, 4
    s_mov_b32 s41, 16
    s_mul_i32 s42, s6, 20480
    s_add_u32 s42, s42, 0x0
    s_mul_i32 s43, s6, 20480
    s_add_u32 s43, s43, 0x500000
    s_mul_i32 s44, s6, 14336
    s_add_u32 s44, s44, 0xc80000
    s_mov_b32 s12, s86
    s_and_b32 s13, s87, 0xffff
    s_mov_b32 s14, 0x280000
    s_mov_b32 s15, 0x20000
    s_lshl_b32 s34, s6, 4
    v_add_u32 v236, s34, v2
    v_mul_u32_u24 v236, 1280, v236
    v_lshl_add_u32 v236, v3, 3, v236
    s_mul_i32 s50, s5, 160
    s_cmp_lg_u32 s3, 0
    s_cbranch_scc1 L_pskip_60
    s_sub_u32 s33, s41, 1
    v_min_u32 v240, s33, v1
    v_add_u32 v240, s40, v240
    v_lshlrev_b32 v240, 2, v240
    s_mov_b32 s32, 0x194c800
    s_mov_b32 s31, 0
L_ploop_61:
    buffer_load_dword v244, v240, s[8:11], s32 offen sc1
    s_waitcnt vmcnt(0)
    v_cmp_ne_u32 vcc, s7, v244
    s_add_u32 s31, s31, 1
    s_cmp_ge_u32 s31, 40000
    s_cbranch_scc1 L_pdone_62
    s_cbranch_vccnz L_ploop_61
L_pdone_62:
L_pskip_60:
    s_waitcnt vmcnt(0)
    s_barrier
    s_add_u32 s35, s42, 0
    buffer_load_dwordx4 a[0:3], v4, s[8:11], s35 offen sc1
    s_add_u32 s35, s42, 1024
    buffer_load_dwordx4 a[4:7], v4, s[8:11], s35 offen sc1
    s_add_u32 s35, s42, 2048
    buffer_load_dwordx4 a[8:11], v4, s[8:11], s35 offen sc1
    s_add_u32 s35, s42, 3072
    buffer_load_dwordx4 a[12:15], v4, s[8:11], s35 offen sc1
    s_add_u32 s35, s42, 4096
    buffer_load_dwordx4 a[16:19], v4, s[8:11], s35 offen sc1
    s_add_u32 s35, s42, 5120
    buffer_load_dwordx4 a[20:23], v4, s[8:11], s35 offen sc1
    s_add_u32 s35, s42, 6144
    buffer_load_dwordx4 a[24:27], v4, s[8:11], s35 offen sc1
    s_add_u32 s35, s42, 7168
    buffer_load_dwordx4 a[28:31], v4, s[8:11], s35 offen sc1
    s_add_u32 s35, s42, 8192
    buffer_load_dwordx4 a[32:35], v4, s[8:11], s35 offen sc1
    s_add_u32 s35, s42, 9216
    buffer_load_dwordx4 a[36:39], v4, s[8:11], s35 offen sc1
    ds_read_b128 v[72:75], v4 offset:40960
    ds_read_b128 v[76:79], v4 offset:41984
    ds_read_b128 v[80:83], v4 offset:43008
    ds_read_b128 v[84:87], v4 offset:44032
    ds_read_b128 v[88:91], v4 offset:45056
    ds_read_b128 v[92:95], v4 offset:46080
    ds_read_b128 v[96:99], v4 offset:47104
    ds_read_b128 v[100:103], v4 offset:48128
    ds_read_b128 v[104:107], v4 offset:49152
    ds_read_b128 v[108:111], v4 offset:50176
    s_waitcnt vmcnt(9)
    s_waitcnt lgkmcnt(5)
    v_mfma_f32_16x16x32_bf16 v[32:35], v[72:75], a[0:3], 0
    ds_read_b128 v[112:115], v4 offset:51200
    v_mfma_f32_16x16x32_bf16 v[36:39], v[76:79], a[0:3], 0
    ds_read_b128 v[116:119], v4 offset:52224
    s_add_u32 s35, s42, 10240
    buffer_load_dwordx4 a[40:43], v4, s[8:11], s35 offen sc1
    v_mfma_f32_16x16x32_bf16 v[40:43], v[80:83], a[0:3], 0
    ds_read_b128 v[120:123], v4 offset:53248
    v_mfma_f32_16x16x32_bf16 v[44:47], v[84:87], a[0:3], 0
    ds_read_b128 v[124:127], v4 offset:54272
    v_mfma_f32_16x16x32_bf16 v[48:51], v[88:91], a[0:3], 0
    ds_read_b128 v[128:131], v4 offset:55296
    s_waitcnt vmcnt(9)
    s_waitcnt lgkmcnt(5)
    v_mfma_f32_16x16x32_bf16 v[32:35], v[92:95], a[4:7], v[32:35]
    ds_read_b128 v[72:75], v4 offset:56320
    v_mfma_f32_16x16x32_bf16 v[36:39], v[96:99], a[4:7], v[36:39]
    ds_read_b128 v[76:79], v4 offset:57344
    s_add_u32 s35, s42, 11264
    buffer_load_dwordx4 a[44:47], v4, s[8:11], s35 offen sc1
    v_mfma_f32_16x16x32_bf16 v[40:43], v[100:103], a[4:7], v[40:43]
    ds_read_b128 v[80:83], v4 offset:58368
    v_mfma_f32_16x16x32_bf16 v[44:47], v[104:107], a[4:7], v[44:47]
    ds_read_b128 v[84:87], v4 offset:59392
    v_mfma_f32_16x16x32_bf16 v[48:51], v[108:111], a[4:7], v[48:51]
    ds_read_b128 v[88:91], v4 offset:60416
    s_waitcnt vmcnt(9)
    s_waitcnt lgkmcnt(5)
    v_mfma_f32_16x16x32_bf16 v[32:35], v[112:115], a[8:11], v[32:35]
    ds_read_b128 v[92:95], v4 offset:61440
    v_mfma_f32_16x16x32_bf16 v[36:39], v[116:119], a[8:11], v[36:39]
    ds_read_b128 v[96:99], v4 offset:62464
    s_add_u32 s35, s42, 12288
    buffer_load_dwordx4 a[48:51], v4, s[8:11], s35 offen sc1
    v_mfma_f32_16x16x32_bf16 v[40:43], v[120:123], a[8:11], v[40:43]
    ds_read_b128 v[100:103], v4 offset:63488
    v_mfma_f32_16x16x32_bf16 v[44:47], v[124:127], a[8:11], v[44:47]
    ds_read_b128 v[104:107], v4 offset:64512
    v_mfma_f32_16x16x32_bf16 v[48:51], v[128:131], a[8:11], v[48:51]
    ds_read_b128 v[108:111], v5 offset:0
    s_waitcnt vmcnt(9)
    s_waitcnt lgkmcnt(5)
    v_mfma_f32_16x16x32_bf16 v[32:35], v[72:75], a[12:15], v[32:35]
    ds_read_b128 v[112:115], v5 offset:1024
    v_mfma_f32_16x16x32_bf16 v[36:39], v[76:79], a[12:15], v[36:39]
    ds_read_b128 v[116:119], v5 offset:2048
    s_add_u32 s35, s42, 13312
    buffer_load_dwordx4 a[52:55], v4, s[8:11], s35 offen sc1
    v_mfma_f32_16x16x32_bf16 v[40:43], v[80:83], a[12:15], v[40:43]
    ds_read_b128 v[120:123], v5 offset:3072
    v_mfma_f32_16x16x32_bf16 v[44:47], v[84:87], a[12:15], v[44:47]
    ds_read_b128 v[124:127], v5 offset:4096
    v_mfma_f32_16x16x32_bf16 v[48:51], v[88:91], a[12:15], v[48:51]
    ds_read_b128 v[128:131], v5 offset:5120
    s_waitcnt vmcnt(9)
    s_waitcnt lgkmcnt(5)
    v_mfma_f32_16x16x32_bf16 v[32:35], v[92:95], a[16:19], v[32:35]
    ds_read_b128 v[72:75], v5 offset:6144
    v_mfma_f32_16x16x32_bf16 v[36:39], v[96:99], a[16:19], v[36:39]
    ds_read_b128 v[76:79], v5 offset:7168
    s_add_u32 s35, s42, 14336
    buffer_load_dwordx4 a[56:59], v4, s[8:11], s35 offen sc1
    v_mfma_f32_16x16x32_bf16 v[40:43], v[100:103], a[16:19], v[40:43]
    ds_read_b128 v[80:83], v5 offset:8192
    v_mfma_f32_16x16x32_bf16 v[44:47], v[104:107], a[16:19], v[44:47]
    ds_read_b128 v[84:87], v5 offset:9216
    v_mfma_f32_16x16x32_bf16 v[48:51], v[108:111], a[16:19], v[48:51]
    ds_read_b128 v[88:91], v5 offset:10240
    s_waitcnt vmcnt(9)
    s_waitcnt lgkmcnt(5)
    v_mfma_f32_16x16x32_bf16 v[32:35], v[112:115], a[20:23], v[32:35]
    ds_read_b128 v[92:95], v5 offset:11264
    v_mfma_f32_16x16x32_bf16 v[36:39], v[116:119], a[20:23], v[36:39]
    ds_read_b128 v[96:99], v5 offset:12288
    s_add_u32 s35, s42, 15360
    buffer_load_dwordx4 a[60:63], v4, s[8:11], s35 offen sc1
    v_mfma_f32_16x16x32_bf16 v[40:43], v[120:123], a[20:23], v[40:43]
    ds_read_b128 v[100:103], v5 offset:13312
    v_mfma_f32_16x16x32_bf16 v[44:47], v[124:127], a[20:23], v[44:47]
    ds_read_b128 v[104:107], v5 offset:14336
    v_mfma_f32_16x16x32_bf16 v[48:51], v[128:131], a[20:23], v[48:51]
    ds_read_b128 v[108:111], v5 offset:15360
    s_waitcnt vmcnt(9)
    s_waitcnt lgkmcnt(5)
    v_mfma_f32_16x16x32_bf16 v[32:35], v[72:75], a[24:27], v[32:35]
    ds_read_b128 v[112:115], v5 offset:16384
    v_mfma_f32_16x16x32_bf16 v[36:39], v[76:79], a[24:27], v[36:39]
    ds_read_b128 v[116:119], v5 offset:17408
    s_add_u32 s35, s42, 16384
    buffer_load_dwordx4 a[64:67], v4, s[8:11], s35 offen sc1
    v_mfma_f32_16x16x32_bf16 v[40:43], v[80:83], a[24:27], v[40:43]
    ds_read_b128 v[120:123], v5 offset:18432
    v_mfma_f32_16x16x32_bf16 v[44:47], v[84:87], a[24:27], v[44:47]
    ds_read_b128 v[124:127], v5 offset:19456
    v_mfma_f32_16x16x32_bf16 v[48:51], v[88:91], a[24:27], v[48:51]
    ds_read_b128 v[128:131], v5 offset:20480
    s_waitcnt vmcnt(9)
    s_waitcnt lgkmcnt(5)
    v_mfma_f32_16x16x32_bf16 v[32:35], v[92:95], a[28:31], v[32:35]
    ds_read_b128 v[72:75], v5 offset:21504
    v_mfma_f32_16x16x32_bf16 v[36:39], v[96:99], a[28:31], v[36:39]
    ds_read_b128 v[76:79], v5 offset:22528
    s_add_u32 s35, s42, 17408
    buffer_load_dwordx4 a[68:71], v4, s[8:11], s35 offen sc1
    v_mfma_f32_16x16x32_bf16 v[40:43], v[100:103], a[28:31], v[40:43]
    ds_read_b128 v[80:83], v5 offset:23552
    v_mfma_f32_16x16x32_bf16 v[44:47], v[104:107], a[28:31], v[44:47]
    ds_read_b128 v[84:87], v5 offset:24576
    v_mfma_f32_16x16x32_bf16 v[48:51], v[108:111], a[28:31], v[48:51]
    ds_read_b128 v[88:91], v5 offset:25600
    s_barrier
    s_waitcnt vmcnt(9)
    s_waitcnt lgkmcnt(5)
    v_mfma_f32_16x16x32_bf16 v[32:35], v[112:115], a[32:35], v[32:35]
    ds_read_b128 v[92:95], v5 offset:26624
    v_mfma_f32_16x16x32_bf16 v[36:39], v[116:119], a[32:35], v[36:39]
    ds_read_b128 v[96:99], v5 offset:27648
    s_add_u32 s35, s42, 18432
    buffer_load_dwordx4 a[72:75], v4, s[8:11], s35 offen sc1
    v_mfma_f32_16x16x32_bf16 v[40:43], v[120:123], a[32:35], v[40:43]
    ds_read_b128 v[100:103], v5 offset:28672
    v_mfma_f32_16x16x32_bf16 v[44:47], v[124:127], a[32:35], v[44:47]
    ds_read_b128 v[104:107], v5 offset:29696
    v_mfma_f32_16x16x32_bf16 v[48:51], v[128:131], a[32:35], v[48:51]
    ds_read_b128 v[108:111], v5 offset:30720
    s_add_u32 m0, s28, 40960
    s_add_u32 s63, s89, 153600
    buffer_load_dwordx4 v4, s[8:11], s63 offen sc1 lds
    s_waitcnt vmcnt(10)
    s_waitcnt lgkmcnt(5)
    v_mfma_f32_16x16x32_bf16 v[32:35], v[72:75], a[36:39], v[32:35]
    ds_read_b128 v[112:115], v5 offset:31744
    v_mfma_f32_16x16x32_bf16 v[36:39], v[76:79], a[36:39], v[36:39]
    ds_read_b128 v[116:119], v5 offset:32768
    s_add_u32 s35, s42, 19456
    buffer_load_dwordx4 a[76:79], v4, s[8:11], s35 offen sc1
    v_mfma_f32_16x16x32_bf16 v[40:43], v[80:83], a[36:39], v[40:43]
    ds_read_b128 v[120:123], v5 offset:33792
    v_mfma_f32_16x16x32_bf16 v[44:47], v[84:87], a[36:39], v[44:47]
    ds_read_b128 v[124:127], v5 offset:34816
    v_mfma_f32_16x16x32_bf16 v[48:51], v[88:91], a[36:39], v[48:51]
    ds_read_b128 v[128:131], v5 offset:35840
    s_add_u32 m0, s28, 45056
    s_add_u32 s63, s89, 157696
    buffer_load_dwordx4 v4, s[8:11], s63 offen sc1 lds
    s_waitcnt vmcnt(11)
    s_waitcnt lgkmcnt(5)
    v_mfma_f32_16x16x32_bf16 v[32:35], v[92:95], a[40:43], v[32:35]
    ds_read_b128 v[72:75], v5 offset:36864
    v_mfma_f32_16x16x32_bf16 v[36:39], v[96:99], a[40:43], v[36:39]
    ds_read_b128 v[76:79], v5 offset:37888
    s_add_u32 s35, s43, 0
    buffer_load_dwordx4 a[80:83], v4, s[8:11], s35 offen sc1
    v_mfma_f32_16x16x32_bf16 v[40:43], v[100:103], a[40:43], v[40:43]
    ds_read_b128 v[80:83], v5 offset:38912
    v_mfma_f32_16x16x32_bf16 v[44:47], v[104:107], a[40:43], v[44:47]
    ds_read_b128 v[84:87], v5 offset:39936
    v_mfma_f32_16x16x32_bf16 v[48:51], v[108:111], a[40:43], v[48:51]
    ds_read_b128 v[88:91], v5 offset:40960
    s_add_u32 m0, s28, 49152
    s_add_u32 s63, s89, 161792
    buffer_load_dwordx4 v4, s[8:11], s63 offen sc1 lds
    s_waitcnt vmcnt(12)
    s_waitcnt lgkmcnt(5)
    v_mfma_f32_16x16x32_bf16 v[32:35], v[112:115], a[44:47], v[32:35]
    ds_read_b128 v[92:95], v5 offset:41984
    v_mfma_f32_16x16x32_bf16 v[36:39], v[116:119], a[44:47], v[36:39]
    ds_read_b128 v[96:99], v5 offset:43008
    s_add_u32 s35, s43, 1024
    buffer_load_dwordx4 a[84:87], v4, s[8:11], s35 offen sc1
    v_mfma_f32_16x16x32_bf16 v[40:43], v[120:123], a[44:47], v[40:43]
    ds_read_b128 v[100:103], v5 offset:44032
    v_mfma_f32_16x16x32_bf16 v[44:47], v[124:127], a[44:47], v[44:47]
    ds_read_b128 v[104:107], v5 offset:45056
    v_mfma_f32_16x16x32_bf16 v[48:51], v[128:131], a[44:47], v[48:51]
    ds_read_b128 v[108:111], v5 offset:46080
    s_add_u32 m0, s28, 53248
    s_add_u32 s63, s89, 165888
    buffer_load_dwordx4 v4, s[8:11], s63 offen sc1 lds
    s_waitcnt vmcnt(13)
    s_waitcnt lgkmcnt(5)
    v_mfma_f32_16x16x32_bf16 v[32:35], v[72:75], a[48:51], v[32:35]
    ds_read_b128 v[112:115], v5 offset:47104
    v_mfma_f32_16x16x32_bf16 v[36:39], v[76:79], a[48:51], v[36:39]
    ds_read_b128 v[116:119], v5 offset:48128
    s_add_u32 s35, s43, 2048
    buffer_load_dwordx4 a[88:91], v4, s[8:11], s35 offen sc1
    v_mfma_f32_16x16x32_bf16 v[40:43], v[80:83], a[48:51], v[40:43]
    ds_read_b128 v[120:123], v5 offset:49152
    v_mfma_f32_16x16x32_bf16 v[44:47], v[84:87], a[48:51], v[44:47]
    ds_read_b128 v[124:127], v5 offset:50176
    v_mfma_f32_16x16x32_bf16 v[48:51], v[88:91], a[48:51], v[48:51]
    ds_read_b128 v[128:131], v5 offset:51200
    s_add_u32 m0, s28, 57344
    s_add_u32 s63, s89, 169984
    buffer_load_dwordx4 v4, s[8:11], s63 offen sc1 lds
    s_waitcnt vmcnt(14)
    s_waitcnt lgkmcnt(5)
    v_mfma_f32_16x16x32_bf16 v[32:35], v[92:95], a[52:55], v[32:35]
    ds_read_b128 v[72:75], v5 offset:52224
    v_mfma_f32_16x16x32_bf16 v[36:39], v[96:99], a[52:55], v[36:39]
    ds_read_b128 v[76:79], v5 offset:53248
    s_add_u32 s35, s43, 3072
    buffer_load_dwordx4 a[92:95], v4, s[8:11], s35 offen sc1
    v_mfma_f32_16x16x32_bf16 v[40:43], v[100:103], a[52:55], v[40:43]
    ds_read_b128 v[80:83], v5 offset:54272
    v_mfma_f32_16x16x32_bf16 v[44:47], v[104:107], a[52:55], v[44:47]
    ds_read_b128 v[84:87], v5 offset:55296
    v_mfma_f32_16x16x32_bf16 v[48:51], v[108:111], a[52:55], v[48:51]
    ds_read_b128 v[88:91], v5 offset:56320
    s_add_u32 m0, s28, 61440
    s_add_u32 s63, s89, 174080
    buffer_load_dwordx4 v4, s[8:11], s63 offen sc1 lds
    s_waitcnt vmcnt(15)
    s_waitcnt lgkmcnt(5)
    v_mfma_f32_16x16x32_bf16 v[32:35], v[112:115], a[56:59], v[32:35]
    ds_read_b128 v[92:95], v5 offset:57344
    v_mfma_f32_16x16x32_bf16 v[36:39], v[116:119], a[56:59], v[36:39]
    ds_read_b128 v[96:99], v5 offset:58368
    s_add_u32 s35, s43, 4096
    buffer_load_dwordx4 a[96:99], v4, s[8:11], s35 offen sc1
    v_mfma_f32_16x16x32_bf16 v[40:43], v[120:123], a[56:59], v[40:43]
    ds_read_b128 v[100:103], v5 offset:59392
    v_mfma_f32_16x16x32_bf16 v[44:47], v[124:127], a[56:59], v[44:47]
    ds_read_b128 v[104:107], v5 offset:60416
    v_mfma_f32_16x16x32_bf16 v[48:51], v[128:131], a[56:59], v[48:51]
    ds_read_b128 v[108:111], v5 offset:61440
    s_add_u32 m0, s28, 65536
    s_add_u32 s63, s89, 178176
    buffer_load_dwordx4 v4, s[8:11], s63 offen sc1 lds
    s_waitcnt vmcnt(16)
    s_waitcnt lgkmcnt(5)
    v_mfma_f32_16x16x32_bf16 v[32:35], v[72:75], a[60:63], v[32:35]
    ds_read_b128 v[112:115], v5 offset:62464
    v_mfma_f32_16x16x32_bf16 v[36:39], v[76:79], a[60:63], v[36:39]
    ds_read_b128 v[116:119], v5 offset:63488
    s_add_u32 s35, s43, 5120
    buffer_load_dwordx4 a[100:103], v4, s[8:11], s35 offen sc1
    v_mfma_f32_16x16x32_bf16 v[40:43], v[80:83], a[60:63], v[40:43]
    ds_read_b128 v[120:123], v5 offset:64512
    v_mfma_f32_16x16x32_bf16 v[44:47], v[84:87], a[60:63], v[44:47]
    ds_read_b128 v[124:127], v6 offset:0
    v_mfma_f32_16x16x32_bf16 v[48:51], v[88:91], a[60:63], v[48:51]
    ds_read_b128 v[128:131], v6 offset:1024
    s_add_u32 m0, s28, 69632
    s_add_u32 s63, s89, 182272
    buffer_load_dwordx4 v4, s[8:11], s63 offen sc1 lds
    s_barrier
    s_waitcnt vmcnt(17)
    s_waitcnt lgkmcnt(5)
    v_mfma_f32_16x16x32_bf16 v[32:35], v[92:95], a[64:67], v[32:35]
    ds_read_b128 v[72:75], v6 offset:2048
    v_mfma_f32_16x16x32_bf16 v[36:39], v[96:99], a[64:67], v[36:39]
    ds_read_b128 v[76:79], v6 offset:3072
    s_add_u32 s35, s43, 6144
    buffer_load_dwordx4 a[104:107], v4, s[8:11], s35 offen sc1
    v_mfma_f32_16x16x32_bf16 v[40:43], v[100:103], a[64:67], v[40:43]
    ds_read_b128 v[80:83], v6 offset:4096
    v_mfma_f32_16x16x32_bf16 v[44:47], v[104:107], a[64:67], v[44:47]
    ds_read_b128 v[84:87], v6 offset:5120
    v_mfma_f32_16x16x32_bf16 v[48:51], v[108:111], a[64:67], v[48:51]
    ds_read_b128 v[88:91], v6 offset:6144
    s_add_u32 m0, s28, 73728
    s_add_u32 s63, s89, 186368
    buffer_load_dwordx4 v4, s[8:11], s63 offen sc1 lds
    s_waitcnt vmcnt(18)
    s_waitcnt lgkmcnt(5)
    v_mfma_f32_16x16x32_bf16 v[32:35], v[112:115], a[68:71], v[32:35]
    ds_read_b128 v[92:95], v6 offset:7168
    v_mfma_f32_16x16x32_bf16 v[36:39], v[116:119], a[68:71], v[36:39]
    ds_read_b128 v[96:99], v6 offset:8192
    s_add_u32 s35, s43, 7168
    buffer_load_dwordx4 a[108:111], v4, s[8:11], s35 offen sc1
    v_mfma_f32_16x16x32_bf16 v[40:43], v[120:123], a[68:71], v[40:43]
    ds_read_b128 v[100:103], v6 offset:9216
    v_mfma_f32_16x16x32_bf16 v[44:47], v[124:127], a[68:71], v[44:47]
    ds_read_b128 v[104:107], v6 offset:10240
    v_mfma_f32_16x16x32_bf16 v[48:51], v[128:131], a[68:71], v[48:51]
    ds_read_b128 v[108:111], v6 offset:11264
    s_add_u32 m0, s28, 77824
    s_add_u32 s63, s89, 190464
    buffer_load_dwordx4 v4, s[8:11], s63 offen sc1 lds
    s_waitcnt vmcnt(19)
    s_waitcnt lgkmcnt(5)
    v_mfma_f32_16x16x32_bf16 v[32:35], v[72:75], a[72:75], v[32:35]
    ds_read_b128 v[112:115], v6 offset:12288
    v_mfma_f32_16x16x32_bf16 v[36:39], v[76:79], a[72:75], v[36:39]
    ds_read_b128 v[116:119], v6 offset:13312
    s_add_u32 s35, s43, 8192
    buffer_load_dwordx4 a[112:115], v4, s[8:11], s35 offen sc1
    v_mfma_f32_16x16x32_bf16 v[40:43], v[80:83], a[72:75], v[40:43]
    ds_read_b128 v[120:123], v6 offset:14336
    v_mfma_f32_16x16x32_bf16 v[44:47], v[84:87], a[72:75], v[44:47]
    ds_read_b128 v[124:127], v6 offset:15360
    v_mfma_f32_16x16x32_bf16 v[48:51], v[88:91], a[72:75], v[48:51]
    ds_read_b128 v[128:131], v6 offset:16384
    s_add_u32 m0, s28, 81920
    s_add_u32 s63, s89, 194560
    buffer_load_dwordx4 v4, s[8:11], s63 offen sc1 lds
    s_waitcnt vmcnt(19)
    s_waitcnt lgkmcnt(5)
    v_mfma_f32_16x16x32_bf16 v[32:35], v[92:95], a[76:79], v[32:35]
    ds_read_b128 v[72:75], v6 offset:17408
    v_mfma_f32_16x16x32_bf16 v[36:39], v[96:99], a[76:79], v[36:39]
    ds_read_b128 v[76:79], v6 offset:18432
    s_add_u32 s35, s43, 9216
    buffer_load_dwordx4 a[116:119], v4, s[8:11], s35 offen sc1
    v_mfma_f32_16x16x32_bf16 v[40:43], v[100:103], a[76:79], v[40:43]
    ds_read_b128 v[80:83], v6 offset:19456
    v_mfma_f32_16x16x32_bf16 v[44:47], v[104:107], a[76:79], v[44:47]
    ds_read_b128 v[84:87], v6 offset:20480
    v_mfma_f32_16x16x32_bf16 v[48:51], v[108:111], a[76:79], v[48:51]
    ds_read_b128 v[88:91], v6 offset:21504
    s_add_u32 m0, s28, 86016
    s_add_u32 s63, s89, 198656
    buffer_load_dwordx4 v4, s[8:11], s63 offen sc1 lds
    s_waitcnt vmcnt(19)
    s_waitcnt lgkmcnt(5)
    v_mfma_f32_16x16x32_bf16 v[32:35], v[112:115], a[80:83], v[32:35]
    ds_read_b128 v[92:95], v4 offset:0
    v_mfma_f32_16x16x32_bf16 v[36:39], v[116:119], a[80:83], v[36:39]
    ds_read_b128 v[96:99], v4 offset:1024
    s_add_u32 s35, s43, 10240
    buffer_load_dwordx4 a[120:123], v4, s[8:11], s35 offen sc1
    v_mfma_f32_16x16x32_bf16 v[40:43], v[120:123], a[80:83], v[40:43]
    ds_read_b128 v[100:103], v4 offset:2048
    v_mfma_f32_16x16x32_bf16 v[44:47], v[124:127], a[80:83], v[44:47]
    ds_read_b128 v[104:107], v4 offset:3072
    v_mfma_f32_16x16x32_bf16 v[48:51], v[128:131], a[80:83], v[48:51]
    ds_read_b128 v[108:111], v4 offset:4096
    s_add_u32 m0, s28, 90112
    s_add_u32 s63, s89, 202752
    buffer_load_dwordx4 v4, s[8:11], s63 offen sc1 lds
    s_waitcnt vmcnt(19)
    s_waitcnt lgkmcnt(5)
    v_mfma_f32_16x16x32_bf16 v[32:35], v[72:75], a[84:87], v[32:35]
    ds_read_b128 v[112:115], v4 offset:5120
    v_mfma_f32_16x16x32_bf16 v[36:39], v[76:79], a[84:87], v[36:39]
    ds_read_b128 v[116:119], v4 offset:6144
    s_add_u32 s35, s43, 11264
    buffer_load_dwordx4 a[124:127], v4, s[8:11], s35 offen sc1
    v_mfma_f32_16x16x32_bf16 v[40:43], v[80:83], a[84:87], v[40:43]
    ds_read_b128 v[120:123], v4 offset:7168
    v_mfma_f32_16x16x32_bf16 v[44:47], v[84:87], a[84:87], v[44:47]
    ds_read_b128 v[124:127], v4 offset:8192
    v_mfma_f32_16x16x32_bf16 v[48:51], v[88:91], a[84:87], v[48:51]
    ds_read_b128 v[128:131], v4 offset:9216
    s_add_u32 m0, s28, 94208
    s_add_u32 s63, s89, 206848
    buffer_load_dwordx4 v4, s[8:11], s63 offen sc1 lds
    s_waitcnt vmcnt(19)
    s_waitcnt lgkmcnt(5)
    v_mfma_f32_16x16x32_bf16 v[32:35], v[92:95], a[88:91], v[32:35]
    ds_read_b128 v[72:75], v4 offset:10240
    v_mfma_f32_16x16x32_bf16 v[36:39], v[96:99], a[88:91], v[36:39]
    ds_read_b128 v[76:79], v4 offset:11264
    s_add_u32 s35, s43, 12288
    buffer_load_dwordx4 a[128:131], v4, s[8:11], s35 offen sc1
    v_mfma_f32_16x16x32_bf16 v[40:43], v[100:103], a[88:91], v[40:43]
    ds_read_b128 v[80:83], v4 offset:12288
    v_mfma_f32_16x16x32_bf16 v[44:47], v[104:107], a[88:91], v[44:47]
    ds_read_b128 v[84:87], v4 offset:13312
    v_mfma_f32_16x16x32_bf16 v[48:51], v[108:111], a[88:91], v[48:51]
    ds_read_b128 v[88:91], v4 offset:14336
    s_add_u32 m0, s28, 98304
    s_add_u32 s63, s89, 210944
    buffer_load_dwordx4 v4, s[8:11], s63 offen sc1 lds
    s_waitcnt vmcnt(19)
    s_waitcnt lgkmcnt(5)
    v_mfma_f32_16x16x32_bf16 v[32:35], v[112:115], a[92:95], v[32:35]
    ds_read_b128 v[92:95], v4 offset:15360
    v_mfma_f32_16x16x32_bf16 v[36:39], v[116:119], a[92:95], v[36:39]
    ds_read_b128 v[96:99], v4 offset:16384
    s_add_u32 s35, s43, 13312
    buffer_load_dwordx4 a[132:135], v4, s[8:11], s35 offen sc1
    v_mfma_f32_16x16x32_bf16 v[40:43], v[120:123], a[92:95], v[40:43]
    ds_read_b128 v[100:103], v4 offset:17408
    v_mfma_f32_16x16x32_bf16 v[44:47], v[124:127], a[92:95], v[44:47]
    ds_read_b128 v[104:107], v4 offset:18432
    v_mfma_f32_16x16x32_bf16 v[48:51], v[128:131], a[92:95], v[48:51]
    ds_read_b128 v[108:111], v4 offset:19456
    s_add_u32 m0, s28, 102400
    s_add_u32 s63, s89, 215040
    buffer_load_dwordx4 v4, s[8:11], s63 offen sc1 lds
    s_barrier
    s_waitcnt vmcnt(19)
    s_waitcnt lgkmcnt(5)
    v_mfma_f32_16x16x32_bf16 v[32:35], v[72:75], a[96:99], v[32:35]
    ds_read_b128 v[112:115], v4 offset:20480
    v_mfma_f32_16x16x32_bf16 v[36:39], v[76:79], a[96:99], v[36:39]
    ds_read_b128 v[116:119], v4 offset:21504
    s_add_u32 s35, s43, 14336
    buffer_load_dwordx4 a[136:139], v4, s[8:11], s35 offen sc1
    v_mfma_f32_16x16x32_bf16 v[40:43], v[80:83], a[96:99], v[40:43]
    ds_read_b128 v[120:123], v4 offset:22528
    v_mfma_f32_16x16x32_bf16 v[44:47], v[84:87], a[96:99], v[44:47]
    ds_read_b128 v[124:127], v4 offset:23552
    v_mfma_f32_16x16x32_bf16 v[48:51], v[88:91], a[96:99], v[48:51]
    ds_read_b128 v[128:131], v4 offset:24576
    s_add_u32 m0, s28, 106496
    s_add_u32 s63, s89, 219136
    buffer_load_dwordx4 v4, s[8:11], s63 offen sc1 lds
    s_waitcnt vmcnt(19)
    s_waitcnt lgkmcnt(5)
    v_mfma_f32_16x16x32_bf16 v[32:35], v[92:95], a[100:103], v[32:35]
    ds_read_b128 v[72:75], v4 offset:25600
    v_mfma_f32_16x16x32_bf16 v[36:39], v[96:99], a[100:103], v[36:39]
    ds_read_b128 v[76:79], v4 offset:26624
    s_add_u32 s35, s43, 15360
    buffer_load_dwordx4 a[140:143], v4, s[8:11], s35 offen sc1
    v_mfma_f32_16x16x32_bf16 v[40:43], v[100:103], a[100:103], v[40:43]
    ds_read_b128 v[80:83], v4 offset:27648
    v_mfma_f32_16x16x32_bf16 v[44:47], v[104:107], a[100:103], v[44:47]
    ds_read_b128 v[84:87], v4 offset:28672
    v_mfma_f32_16x16x32_bf16 v[48:51], v[108:111], a[100:103], v[48:51]
    ds_read_b128 v[88:91], v4 offset:29696
    s_add_u32 m0, s28, 110592
    s_add_u32 s63, s89, 223232
    buffer_load_dwordx4 v4, s[8:11], s63 offen sc1 lds
    s_waitcnt vmcnt(19)
    s_waitcnt lgkmcnt(5)
    v_mfma_f32_16x16x32_bf16 v[32:35], v[112:115], a[104:107], v[32:35]
    ds_read_b128 v[92:95], v4 offset:30720
    v_mfma_f32_16x16x32_bf16 v[36:39], v[116:119], a[104:107], v[36:39]
    ds_read_b128 v[96:99], v4 offset:31744
    s_add_u32 s35, s43, 16384
    buffer_load_dwordx4 a[144:147], v4, s[8:11], s35 offen sc1
    v_mfma_f32_16x16x32_bf16 v[40:43], v[120:123], a[104:107], v[40:43]
    ds_read_b128 v[100:103], v4 offset:32768
    v_mfma_f32_16x16x32_bf16 v[44:47], v[124:127], a[104:107], v[44:47]
    ds_read_b128 v[104:107], v4 offset:33792
    v_mfma_f32_16x16x32_bf16 v[48:51], v[128:131], a[104:107], v[48:51]
    ds_read_b128 v[108:111], v4 offset:34816
    s_add_u32 m0, s28, 114688
    s_add_u32 s63, s89, 227328
    buffer_load_dwordx4 v4, s[8:11], s63 offen sc1 lds
    s_waitcnt vmcnt(19)
    s_waitcnt lgkmcnt(5)
    v_mfma_f32_16x16x32_bf16 v[32:35], v[72:75], a[108:111], v[32:35]
    ds_read_b128 v[112:115], v4 offset:35840
    v_mfma_f32_16x16x32_bf16 v[36:39], v[76:79], a[108:111], v[36:39]
    ds_read_b128 v[116:119], v4 offset:36864
    s_add_u32 s35, s43, 17408
    buffer_load_dwordx4 a[148:151], v4, s[8:11], s35 offen sc1
    v_mfma_f32_16x16x32_bf16 v[40:43], v[80:83], a[108:111], v[40:43]
    ds_read_b128 v[120:123], v4 offset:37888
    v_mfma_f32_16x16x32_bf16 v[44:47], v[84:87], a[108:111], v[44:47]
    ds_read_b128 v[124:127], v4 offset:38912
    v_mfma_f32_16x16x32_bf16 v[48:51], v[88:91], a[108:111], v[48:51]
    ds_read_b128 v[128:131], v4 offset:39936
    s_add_u32 m0, s28, 118784
    s_add_u32 s63, s89, 231424
    buffer_load_dwordx4 v4, s[8:11], s63 offen sc1 lds
    s_waitcnt vmcnt(20)
    s_barrier
    s_waitcnt vmcnt(19)
    s_waitcnt lgkmcnt(5)
    v_mfma_f32_16x16x32_bf16 v[32:35], v[92:95], a[112:115], v[32:35]
    ds_read_b128 v[72:75], v4 offset:40960
    v_mfma_f32_16x16x32_bf16 v[36:39], v[96:99], a[112:115], v[36:39]
    ds_read_b128 v[76:79], v4 offset:41984
    s_add_u32 s35, s43, 18432
    buffer_load_dwordx4 a[152:155], v4, s[8:11], s35 offen sc1
    v_mfma_f32_16x16x32_bf16 v[40:43], v[100:103], a[112:115], v[40:43]
    ds_read_b128 v[80:83], v4 offset:43008
    v_mfma_f32_16x16x32_bf16 v[44:47], v[104:107], a[112:115], v[44:47]
    ds_read_b128 v[84:87], v4 offset:44032
    v_mfma_f32_16x16x32_bf16 v[48:51], v[108:111], a[112:115], v[48:51]
    ds_read_b128 v[88:91], v4 offset:45056
    s_add_u32 m0, s28, 122880
    s_add_u32 s63, s89, 235520
    buffer_load_dwordx4 v4, s[8:11], s63 offen sc1 lds
    s_waitcnt vmcnt(19)
    s_waitcnt lgkmcnt(5)
    v_mfma_f32_16x16x32_bf16 v[32:35], v[112:115], a[116:119], v[32:35]
    ds_read_b128 v[92:95], v4 offset:46080
    v_mfma_f32_16x16x32_bf16 v[36:39], v[116:119], a[116:119], v[36:39]
    ds_read_b128 v[96:99], v4 offset:47104
    s_add_u32 s35, s43, 19456
    buffer_load_dwordx4 a[156:159], v4, s[8:11], s35 offen sc1
    v_mfma_f32_16x16x32_bf16 v[40:43], v[120:123], a[116:119], v[40:43]
    ds_read_b128 v[100:103], v4 offset:48128
    v_mfma_f32_16x16x32_bf16 v[44:47], v[124:127], a[116:119], v[44:47]
    ds_read_b128 v[104:107], v4 offset:49152
    v_mfma_f32_16x16x32_bf16 v[48:51], v[128:131], a[116:119], v[48:51]
    ds_read_b128 v[108:111], v4 offset:50176
    s_add_u32 m0, s28, 126976
    s_add_u32 s63, s89, 239616
    buffer_load_dwordx4 v4, s[8:11], s63 offen sc1 lds
    s_waitcnt vmcnt(19)
    s_waitcnt lgkmcnt(5)
    v_mfma_f32_16x16x32_bf16 v[32:35], v[72:75], a[120:123], v[32:35]
    ds_read_b128 v[112:115], v4 offset:51200
    v_mfma_f32_16x16x32_bf16 v[36:39], v[76:79], a[120:123], v[36:39]
    ds_read_b128 v[116:119], v4 offset:52224
    s_add_u32 s35, s44, 0
    buffer_load_dwordx4 a[160:163], v4, s[8:11], s35 offen sc1
    v_mfma_f32_16x16x32_bf16 v[40:43], v[80:83], a[120:123], v[40:43]
    ds_read_b128 v[120:123], v4 offset:53248
    v_mfma_f32_16x16x32_bf16 v[44:47], v[84:87], a[120:123], v[44:47]
    ds_read_b128 v[124:127], v4 offset:54272
    v_mfma_f32_16x16x32_bf16 v[48:51], v[88:91], a[120:123], v[48:51]
    ds_read_b128 v[128:131], v4 offset:55296
    s_add_u32 m0, s28, 131072
    s_add_u32 s63, s89, 243712
    buffer_load_dwordx4 v4, s[8:11], s63 offen sc1 lds
    s_waitcnt vmcnt(19)
    s_waitcnt lgkmcnt(5)
    v_mfma_f32_16x16x32_bf16 v[32:35], v[92:95], a[124:127], v[32:35]
    ds_read_b128 v[72:75], v4 offset:56320
    v_mfma_f32_16x16x32_bf16 v[36:39], v[96:99], a[124:127], v[36:39]
    ds_read_b128 v[76:79], v4 offset:57344
    s_add_u32 s35, s44, 1024
    buffer_load_dwordx4 a[164:167], v4, s[8:11], s35 offen sc1
    v_mfma_f32_16x16x32_bf16 v[40:43], v[100:103], a[124:127], v[40:43]
    ds_read_b128 v[80:83], v4 offset:58368
    v_mfma_f32_16x16x32_bf16 v[44:47], v[104:107], a[124:127], v[44:47]
    ds_read_b128 v[84:87], v4 offset:59392
    v_mfma_f32_16x16x32_bf16 v[48:51], v[108:111], a[124:127], v[48:51]
    ds_read_b128 v[88:91], v4 offset:60416
    s_add_u32 m0, s28, 135168
    s_add_u32 s63, s89, 247808
    buffer_load_dwordx4 v4, s[8:11], s63 offen sc1 lds
    s_waitcnt vmcnt(19)
    s_waitcnt lgkmcnt(5)
    v_mfma_f32_16x16x32_bf16 v[32:35], v[112:115], a[128:131], v[32:35]
    ds_read_b128 v[92:95], v4 offset:61440
    v_mfma_f32_16x16x32_bf16 v[36:39], v[116:119], a[128:131], v[36:39]
    ds_read_b128 v[96:99], v4 offset:62464
    s_add_u32 s35, s44, 2048
    buffer_load_dwordx4 a[168:171], v4, s[8:11], s35 offen sc1
    v_mfma_f32_16x16x32_bf16 v[40:43], v[120:123], a[128:131], v[40:43]
    ds_read_b128 v[100:103], v4 offset:63488
    v_mfma_f32_16x16x32_bf16 v[44:47], v[124:127], a[128:131], v[44:47]
    ds_read_b128 v[104:107], v4 offset:64512
    v_mfma_f32_16x16x32_bf16 v[48:51], v[128:131], a[128:131], v[48:51]
    ds_read_b128 v[108:111], v5 offset:0
    s_add_u32 m0, s28, 139264
    s_add_u32 s63, s89, 251904
    buffer_load_dwordx4 v4, s[8:11], s63 offen sc1 lds
    s_waitcnt vmcnt(19)
    s_waitcnt lgkmcnt(5)
    v_mfma_f32_16x16x32_bf16 v[32:35], v[72:75], a[132:135], v[32:35]
    ds_read_b128 v[112:115], v5 offset:1024
    v_mfma_f32_16x16x32_bf16 v[36:39], v[76:79], a[132:135], v[36:39]
    ds_read_b128 v[116:119], v5 offset:2048
    s_add_u32 s35, s44, 3072
    buffer_load_dwordx4 a[172:175], v4, s[8:11], s35 offen sc1
    v_mfma_f32_16x16x32_bf16 v[40:43], v[80:83], a[132:135], v[40:43]
    ds_read_b128 v[120:123], v5 offset:3072
    v_mfma_f32_16x16x32_bf16 v[44:47], v[84:87], a[132:135], v[44:47]
    ds_read_b128 v[124:127], v5 offset:4096
    v_mfma_f32_16x16x32_bf16 v[48:51], v[88:91], a[132:135], v[48:51]
    ds_read_b128 v[128:131], v5 offset:5120
    s_add_u32 m0, s28, 143360
    s_add_u32 s63, s89, 256000
    buffer_load_dwordx4 v4, s[8:11], s63 offen sc1 lds
    s_waitcnt vmcnt(19)
    s_waitcnt lgkmcnt(5)
    v_mfma_f32_16x16x32_bf16 v[32:35], v[92:95], a[136:139], v[32:35]
    ds_read_b128 v[72:75], v5 offset:6144
    v_mfma_f32_16x16x32_bf16 v[36:39], v[96:99], a[136:139], v[36:39]
    ds_read_b128 v[76:79], v5 offset:7168
    s_add_u32 s35, s44, 4096
    buffer_load_dwordx4 a[176:179], v4, s[8:11], s35 offen sc1
    v_mfma_f32_16x16x32_bf16 v[40:43], v[100:103], a[136:139], v[40:43]
    ds_read_b128 v[80:83], v5 offset:8192
    v_mfma_f32_16x16x32_bf16 v[44:47], v[104:107], a[136:139], v[44:47]
    ds_read_b128 v[84:87], v5 offset:9216
    v_mfma_f32_16x16x32_bf16 v[48:51], v[108:111], a[136:139], v[48:51]
    ds_read_b128 v[88:91], v5 offset:10240
    s_add_u32 m0, s28, 147456
    s_add_u32 s63, s89, 260096
    buffer_load_dwordx4 v4, s[8:11], s63 offen sc1 lds
    s_waitcnt vmcnt(19)
    s_waitcnt lgkmcnt(5)
    v_mfma_f32_16x16x32_bf16 v[32:35], v[112:115], a[140:143], v[32:35]
    ds_read_b128 v[92:95], v5 offset:11264
    v_mfma_f32_16x16x32_bf16 v[36:39], v[116:119], a[140:143], v[36:39]
    ds_read_b128 v[96:99], v5 offset:12288
    s_add_u32 s35, s44, 5120
    buffer_load_dwordx4 a[180:183], v4, s[8:11], s35 offen sc1
    v_mfma_f32_16x16x32_bf16 v[40:43], v[120:123], a[140:143], v[40:43]
    ds_read_b128 v[100:103], v5 offset:13312
    v_mfma_f32_16x16x32_bf16 v[44:47], v[124:127], a[140:143], v[44:47]
    ds_read_b128 v[104:107], v5 offset:14336
    v_mfma_f32_16x16x32_bf16 v[48:51], v[128:131], a[140:143], v[48:51]
    ds_read_b128 v[108:111], v5 offset:15360
    s_sub_u32 s59, s3, 0
    s_min_u32 s59, s59, 3
    s_lshl_b32 s59, s59, 10
    s_sub_u32 s63, s89, s28
    s_add_u32 s63, s63, s59
    s_add_u32 s63, s63, 264192
    s_add_u32 s59, s59, 151552
    s_sub_u32 m0, s59, 153600
    s_cmp_ge_u32 s59, 153600
    s_cselect_b32 m0, m0, s59
    s_nop 0
    buffer_load_dwordx4 v4, s[8:11], s63 offen sc1 lds
    s_waitcnt vmcnt(16)
    s_barrier
    s_waitcnt vmcnt(19)
    s_waitcnt lgkmcnt(5)
    v_mfma_f32_16x16x32_bf16 v[32:35], v[72:75], a[144:147], v[32:35]
    ds_read_b128 v[112:115], v5 offset:16384
    v_mfma_f32_16x16x32_bf16 v[36:39], v[76:79], a[144:147], v[36:39]
    ds_read_b128 v[116:119], v5 offset:17408
    s_add_u32 s35, s44, 6144
    buffer_load_dwordx4 a[184:187], v4, s[8:11], s35 offen sc1
    v_mfma_f32_16x16x32_bf16 v[40:43], v[80:83], a[144:147], v[40:43]
    ds_read_b128 v[120:123], v5 offset:18432
    v_mfma_f32_16x16x32_bf16 v[44:47], v[84:87], a[144:147], v[44:47]
    ds_read_b128 v[124:127], v5 offset:19456
    v_mfma_f32_16x16x32_bf16 v[48:51], v[88:91], a[144:147], v[48:51]
    ds_read_b128 v[128:131], v5 offset:20480
    s_add_u32 m0, s28, 2048
    s_add_u32 s63, s89, 268288
    buffer_load_dwordx4 v4, s[8:11], s63 offen sc1 lds
    s_waitcnt vmcnt(19)
    s_waitcnt lgkmcnt(5)
    v_mfma_f32_16x16x32_bf16 v[32:35], v[92:95], a[148:151], v[32:35]
    ds_read_b128 v[72:75], v5 offset:21504
    v_mfma_f32_16x16x32_bf16 v[36:39], v[96:99], a[148:151], v[36:39]
    ds_read_b128 v[76:79], v5 offset:22528
    s_add_u32 s35, s44, 7168
    buffer_load_dwordx4 a[188:191], v4, s[8:11], s35 offen sc1
    v_mfma_f32_16x16x32_bf16 v[40:43], v[100:103], a[148:151], v[40:43]
    ds_read_b128 v[80:83], v5 offset:23552
    v_mfma_f32_16x16x32_bf16 v[44:47], v[104:107], a[148:151], v[44:47]
    ds_read_b128 v[84:87], v5 offset:24576
    v_mfma_f32_16x16x32_bf16 v[48:51], v[108:111], a[148:151], v[48:51]
    ds_read_b128 v[88:91], v5 offset:25600
    s_add_u32 m0, s28, 6144
    s_add_u32 s63, s89, 272384
    buffer_load_dwordx4 v4, s[8:11], s63 offen sc1 lds
    s_waitcnt vmcnt(19)
    s_waitcnt lgkmcnt(5)
    v_mfma_f32_16x16x32_bf16 v[32:35], v[112:115], a[152:155], v[32:35]
    ds_read_b128 v[92:95], v5 offset:26624
    v_mfma_f32_16x16x32_bf16 v[36:39], v[116:119], a[152:155], v[36:39]
    ds_read_b128 v[96:99], v5 offset:27648
    s_add_u32 s35, s44, 8192
    buffer_load_dwordx4 a[192:195], v4, s[8:11], s35 offen sc1
    v_mfma_f32_16x16x32_bf16 v[40:43], v[120:123], a[152:155], v[40:43]
    ds_read_b128 v[100:103], v5 offset:28672
    v_mfma_f32_16x16x32_bf16 v[44:47], v[124:127], a[152:155], v[44:47]
    ds_read_b128 v[104:107], v5 offset:29696
    v_mfma_f32_16x16x32_bf16 v[48:51], v[128:131], a[152:155], v[48:51]
    ds_read_b128 v[108:111], v5 offset:30720
    s_waitcnt vmcnt(18)
    s_waitcnt lgkmcnt(5)
    v_mfma_f32_16x16x32_bf16 v[32:35], v[72:75], a[156:159], v[32:35]
    ds_read_b128 v[112:115], v5 offset:31744
    v_mfma_f32_16x16x32_bf16 v[36:39], v[76:79], a[156:159], v[36:39]
    ds_read_b128 v[116:119], v5 offset:32768
    s_add_u32 s35, s44, 9216
    buffer_load_dwordx4 a[196:199], v4, s[8:11], s35 offen sc1
    v_mfma_f32_16x16x32_bf16 v[40:43], v[80:83], a[156:159], v[40:43]
    ds_read_b128 v[120:123], v5 offset:33792
    v_mfma_f32_16x16x32_bf16 v[44:47], v[84:87], a[156:159], v[44:47]
    ds_read_b128 v[124:127], v5 offset:34816
    v_mfma_f32_16x16x32_bf16 v[48:51], v[88:91], a[156:159], v[48:51]
    ds_read_b128 v[128:131], v5 offset:35840
    s_waitcnt vmcnt(17)
    s_waitcnt lgkmcnt(5)
    v_mfma_f32_16x16x32_bf16 v[32:35], v[92:95], a[160:163], v[32:35]
    ds_read_b128 v[72:75], v5 offset:36864
    v_mfma_f32_16x16x32_bf16 v[36:39], v[96:99], a[160:163], v[36:39]
    ds_read_b128 v[76:79], v5 offset:37888
    s_add_u32 s35, s44, 10240
    buffer_load_dwordx4 a[200:203], v4, s[8:11], s35 offen sc1
    v_mfma_f32_16x16x32_bf16 v[40:43], v[100:103], a[160:163], v[40:43]
    ds_read_b128 v[80:83], v5 offset:38912
    v_mfma_f32_16x16x32_bf16 v[44:47], v[104:107], a[160:163], v[44:47]
    ds_read_b128 v[84:87], v5 offset:39936
    v_mfma_f32_16x16x32_bf16 v[48:51], v[108:111], a[160:163], v[48:51]
    ds_read_b128 v[88:91], v5 offset:40960
    s_waitcnt vmcnt(16)
    s_waitcnt lgkmcnt(5)
    v_mfma_f32_16x16x32_bf16 v[32:35], v[112:115], a[164:167], v[32:35]
    ds_read_b128 v[92:95], v5 offset:41984
    v_mfma_f32_16x16x32_bf16 v[36:39], v[116:119], a[164:167], v[36:39]
    ds_read_b128 v[96:99], v5 offset:43008
    s_add_u32 s35, s44, 11264
    buffer_load_dwordx4 a[204:207], v4, s[8:11], s35 offen sc1
    v_mfma_f32_16x16x32_bf16 v[40:43], v[120:123], a[164:167], v[40:43]
    ds_read_b128 v[100:103], v5 offset:44032
    v_mfma_f32_16x16x32_bf16 v[44:47], v[124:127], a[164:167], v[44:47]
    ds_read_b128 v[104:107], v5 offset:45056
    v_mfma_f32_16x16x32_bf16 v[48:51], v[128:131], a[164:167], v[48:51]
    ds_read_b128 v[108:111], v5 offset:46080
    s_waitcnt vmcnt(15)
    s_waitcnt lgkmcnt(5)
    v_mfma_f32_16x16x32_bf16 v[32:35], v[72:75], a[168:171], v[32:35]
    ds_read_b128 v[112:115], v5 offset:47104
    v_mfma_f32_16x16x32_bf16 v[36:39], v[76:79], a[168:171], v[36:39]
    ds_read_b128 v[116:119], v5 offset:48128
    s_add_u32 s35, s44, 12288
    buffer_load_dwordx4 a[208:211], v4, s[8:11], s35 offen sc1
    v_mfma_f32_16x16x32_bf16 v[40:43], v[80:83], a[168:171], v[40:43]
    ds_read_b128 v[120:123], v5 offset:49152
    v_mfma_f32_16x16x32_bf16 v[44:47], v[84:87], a[168:171], v[44:47]
    ds_read_b128 v[124:127], v5 offset:50176
    v_mfma_f32_16x16x32_bf16 v[48:51], v[88:91], a[168:171], v[48:51]
    ds_read_b128 v[128:131], v5 offset:51200
    s_waitcnt vmcnt(14)
    s_waitcnt lgkmcnt(5)
    v_mfma_f32_16x16x32_bf16 v[32:35], v[92:95], a[172:175], v[32:35]
    ds_read_b128 v[72:75], v5 offset:52224
    v_mfma_f32_16x16x32_bf16 v[36:39], v[96:99], a[172:175], v[36:39]
    ds_read_b128 v[76:79], v5 offset:53248
    s_add_u32 s35, s44, 13312
    buffer_load_dwordx4 a[212:215], v4, s[8:11], s35 offen sc1
    v_mfma_f32_16x16x32_bf16 v[40:43], v[100:103], a[172:175], v[40:43]
    ds_read_b128 v[80:83], v5 offset:54272
    v_mfma_f32_16x16x32_bf16 v[44:47], v[104:107], a[172:175], v[44:47]
    ds_read_b128 v[84:87], v5 offset:55296
    v_mfma_f32_16x16x32_bf16 v[48:51], v[108:111], a[172:175], v[48:51]
    ds_read_b128 v[88:91], v5 offset:56320
    s_waitcnt vmcnt(6)
    s_barrier
    s_waitcnt vmcnt(13)
    s_waitcnt lgkmcnt(5)
    v_mfma_f32_16x16x32_bf16 v[32:35], v[112:115], a[176:179], v[32:35]
    ds_read_b128 v[92:95], v5 offset:57344
    v_mfma_f32_16x16x32_bf16 v[36:39], v[116:119], a[176:179], v[36:39]
    ds_read_b128 v[96:99], v5 offset:58368
    v_mfma_f32_16x16x32_bf16 v[40:43], v[120:123], a[176:179], v[40:43]
    ds_read_b128 v[100:103], v5 offset:59392
    v_mfma_f32_16x16x32_bf16 v[44:47], v[124:127], a[176:179], v[44:47]
    ds_read_b128 v[104:107], v5 offset:60416
    v_mfma_f32_16x16x32_bf16 v[48:51], v[128:131], a[176:179], v[48:51]
    ds_read_b128 v[108:111], v5 offset:61440
    s_waitcnt vmcnt(11)
    s_waitcnt lgkmcnt(5)
    v_mfma_f32_16x16x32_bf16 v[32:35], v[72:75], a[180:183], v[32:35]
    ds_read_b128 v[112:115], v5 offset:62464
    v_mfma_f32_16x16x32_bf16 v[36:39], v[76:79], a[180:183], v[36:39]
    ds_read_b128 v[116:119], v5 offset:63488
    v_mfma_f32_16x16x32_bf16 v[40:43], v[80:83], a[180:183], v[40:43]
    ds_read_b128 v[120:123], v5 offset:64512
    v_mfma_f32_16x16x32_bf16 v[44:47], v[84:87], a[180:183], v[44:47]
    ds_read_b128 v[124:127], v6 offset:0
    v_mfma_f32_16x16x32_bf16 v[48:51], v[88:91], a[180:183], v[48:51]
    ds_read_b128 v[128:131], v6 offset:1024
    s_waitcnt vmcnt(9)
    s_waitcnt lgkmcnt(5)
    v_mfma_f32_16x16x32_bf16 v[32:35], v[92:95], a[184:187], v[32:35]
    ds_read_b128 v[72:75], v6 offset:2048
    v_mfma_f32_16x16x32_bf16 v[36:39], v[96:99], a[184:187], v[36:39]
    ds_read_b128 v[76:79], v6 offset:3072
    v_mfma_f32_16x16x32_bf16 v[40:43], v[100:103], a[184:187], v[40:43]
    ds_read_b128 v[80:83], v6 offset:4096
    v_mfma_f32_16x16x32_bf16 v[44:47], v[104:107], a[184:187], v[44:47]
    ds_read_b128 v[84:87], v6 offset:5120
    v_mfma_f32_16x16x32_bf16 v[48:51], v[108:111], a[184:187], v[48:51]
    ds_read_b128 v[88:91], v6 offset:6144
    s_waitcnt vmcnt(7)
    s_waitcnt lgkmcnt(5)
    v_mfma_f32_16x16x32_bf16 v[32:35], v[112:115], a[188:191], v[32:35]
    ds_read_b128 v[92:95], v6 offset:7168
    v_mfma_f32_16x16x32_bf16 v[36:39], v[116:119], a[188:191], v[36:39]
    ds_read_b128 v[96:99], v6 offset:8192
    v_mfma_f32_16x16x32_bf16 v[40:43], v[120:123], a[188:191], v[40:43]
    ds_read_b128 v[100:103], v6 offset:9216
    v_mfma_f32_16x16x32_bf16 v[44:47], v[124:127], a[188:191], v[44:47]
    ds_read_b128 v[104:107], v6 offset:10240
    v_mfma_f32_16x16x32_bf16 v[48:51], v[128:131], a[188:191], v[48:51]
    ds_read_b128 v[108:111], v6 offset:11264
    s_waitcnt vmcnt(5)
    s_waitcnt lgkmcnt(5)
    v_mfma_f32_16x16x32_bf16 v[32:35], v[72:75], a[192:195], v[32:35]
    ds_read_b128 v[112:115], v6 offset:12288
    v_mfma_f32_16x16x32_bf16 v[36:39], v[76:79], a[192:195], v[36:39]
    ds_read_b128 v[116:119], v6 offset:13312
    v_mfma_f32_16x16x32_bf16 v[40:43], v[80:83], a[192:195], v[40:43]
    ds_read_b128 v[120:123], v6 offset:14336
    v_mfma_f32_16x16x32_bf16 v[44:47], v[84:87], a[192:195], v[44:47]
    ds_read_b128 v[124:127], v6 offset:15360
    v_mfma_f32_16x16x32_bf16 v[48:51], v[88:91], a[192:195], v[48:51]
    ds_read_b128 v[128:131], v6 offset:16384
    s_waitcnt vmcnt(4)
    s_waitcnt lgkmcnt(5)
    v_mfma_f32_16x16x32_bf16 v[32:35], v[92:95], a[196:199], v[32:35]
    ds_read_b128 v[72:75], v6 offset:17408
    v_mfma_f32_16x16x32_bf16 v[36:39], v[96:99], a[196:199], v[36:39]
    ds_read_b128 v[76:79], v6 offset:18432
    v_mfma_f32_16x16x32_bf16 v[40:43], v[100:103], a[196:199], v[40:43]
    ds_read_b128 v[80:83], v6 offset:19456
    v_mfma_f32_16x16x32_bf16 v[44:47], v[104:107], a[196:199], v[44:47]
    ds_read_b128 v[84:87], v6 offset:20480
    v_mfma_f32_16x16x32_bf16 v[48:51], v[108:111], a[196:199], v[48:51]
    ds_read_b128 v[88:91], v6 offset:21504
    s_waitcnt vmcnt(3)
    s_waitcnt lgkmcnt(5)
    v_mfma_f32_16x16x32_bf16 v[32:35], v[112:115], a[200:203], v[32:35]
    ds_read_b128 v[92:95], v4 offset:0
    v_mfma_f32_16x16x32_bf16 v[36:39], v[116:119], a[200:203], v[36:39]
    ds_read_b128 v[96:99], v4 offset:1024
    v_mfma_f32_16x16x32_bf16 v[40:43], v[120:123], a[200:203], v[40:43]
    ds_read_b128 v[100:103], v4 offset:2048
    v_mfma_f32_16x16x32_bf16 v[44:47], v[124:127], a[200:203], v[44:47]
    ds_read_b128 v[104:107], v4 offset:3072
    v_mfma_f32_16x16x32_bf16 v[48:51], v[128:131], a[200:203], v[48:51]
    ds_read_b128 v[108:111], v4 offset:4096
    s_waitcnt vmcnt(2)
    s_waitcnt lgkmcnt(5)
    v_mfma_f32_16x16x32_bf16 v[32:35], v[72:75], a[204:207], v[32:35]
    ds_read_b128 v[112:115], v4 offset:5120
    v_mfma_f32_16x16x32_bf16 v[36:39], v[76:79], a[204:207], v[36:39]
    ds_read_b128 v[116:119], v4 offset:6144
    v_mfma_f32_16x16x32_bf16 v[40:43], v[80:83], a[204:207], v[40:43]
    ds_read_b128 v[120:123], v4 offset:7168
    v_mfma_f32_16x16x32_bf16 v[44:47], v[84:87], a[204:207], v[44:47]
    ds_read_b128 v[124:127], v4 offset:8192
    v_mfma_f32_16x16x32_bf16 v[48:51], v[88:91], a[204:207], v[48:51]
    ds_read_b128 v[128:131], v4 offset:9216
    s_waitcnt vmcnt(1)
    s_waitcnt lgkmcnt(5)
    v_mfma_f32_16x16x32_bf16 v[32:35], v[92:95], a[208:211], v[32:35]
    v_mfma_f32_16x16x32_bf16 v[36:39], v[96:99], a[208:211], v[36:39]
    v_mfma_f32_16x16x32_bf16 v[40:43], v[100:103], a[208:211], v[40:43]
    v_mfma_f32_16x16x32_bf16 v[44:47], v[104:107], a[208:211], v[44:47]
    v_mfma_f32_16x16x32_bf16 v[48:51], v[108:111], a[208:211], v[48:51]
    s_waitcnt vmcnt(0)
    s_waitcnt lgkmcnt(0)
    v_mfma_f32_16x16x32_bf16 v[32:35], v[112:115], a[212:215], v[32:35]
    v_mfma_f32_16x16x32_bf16 v[36:39], v[116:119], a[212:215], v[36:39]
    v_mfma_f32_16x16x32_bf16 v[40:43], v[120:123], a[212:215], v[40:43]
    v_mfma_f32_16x16x32_bf16 v[44:47], v[124:127], a[212:215], v[44:47]
    v_mfma_f32_16x16x32_bf16 v[48:51], v[128:131], a[212:215], v[48:51]
    s_nop 3
    v_pk_add_f32 v[32:33], v[32:33], v[10:11]
    v_pk_add_f32 v[34:35], v[34:35], v[12:13]
    v_cvt_pk_bf16_f32 v160, v32, v33
    v_cvt_pk_bf16_f32 v161, v34, v35
    buffer_store_dwordx2 v[160:161], v236, s[12:15], s50 offen offset:0
    v_pk_add_f32 v[36:37], v[36:37], v[14:15]
    v_pk_add_f32 v[38:39], v[38:39], v[16:17]
    v_cvt_pk_bf16_f32 v162, v36, v37
    v_cvt_pk_bf16_f32 v163, v38, v39
    buffer_store_dwordx2 v[162:163], v236, s[12:15], s50 offen offset:32
    v_pk_add_f32 v[40:41], v[40:41], v[18:19]
    v_pk_add_f32 v[42:43], v[42:43], v[20:21]
    v_cvt_pk_bf16_f32 v164, v40, v41
    v_cvt_pk_bf16_f32 v165, v42, v43
    buffer_store_dwordx2 v[164:165], v236, s[12:15], s50 offen offset:64
    v_pk_add_f32 v[44:45], v[44:45], v[22:23]
    v_pk_add_f32 v[46:47], v[46:47], v[24:25]
    v_cvt_pk_bf16_f32 v166, v44, v45
    v_cvt_pk_bf16_f32 v167, v46, v47
    buffer_store_dwordx2 v[166:167], v236, s[12:15], s50 offen offset:96
    v_pk_add_f32 v[48:49], v[48:49], v[26:27]
    v_pk_add_f32 v[50:51], v[50:51], v[28:29]
    v_cvt_pk_bf16_f32 v168, v48, v49
    v_cvt_pk_bf16_f32 v169, v50, v51
    buffer_store_dwordx2 v[168:169], v236, s[12:15], s50 offen offset:128
L_end:
    s_endpgm
.section .rodata,"a"
.p2align 6
.amdhsa_kernel sequential_preLN__ssm_conv_h3__mixer_s_mlp__prompt_kernel
  .amdhsa_next_free_vgpr 512
  .amdhsa_next_free_sgpr 102
  .amdhsa_accum_offset 256
  .amdhsa_group_segment_fixed_size 0
  .amdhsa_kernarg_size 112
  .amdhsa_user_sgpr_count 2
  .amdhsa_user_sgpr_kernarg_segment_ptr 1
  .amdhsa_system_sgpr_workgroup_id_x 1
.end_amdhsa_kernel
```
